```python
import torch

def _softmax(x, axis=-1):
    return torch.softmax(x, dim=axis)
def _gelu(x):
    return torch.nn.functional.gelu(x, approximate="tanh")
def _silu(x):
    return torch.nn.functional.silu(x)
def _sigmoid(x):
    return torch.sigmoid(x)
def _layernorm(x, axis=-1, eps=1e-5):
    m = x.mean(dim=axis, keepdim=True)
    v = x.var(dim=axis, keepdim=True, unbiased=False)
    return (x - m) / torch.sqrt(v + eps)
def _scatter_add(tgt, idx, src, axis=0):
    return tgt.clone().index_add_(axis, idx, src)
def _segment_sum(src, seg, n):
    out = torch.zeros((n,) + src.shape[1:], dtype=src.dtype)
    return out.index_add_(0, seg, src)
def _pad(x, pw):
    flat = tuple(v for pair in reversed(pw) for v in pair)
    return torch.nn.functional.pad(x, flat)

kernel_name = 'gated_mix__softmax_full_mha__mixer_s_mlp__prompt'

def setup_inputs():

    _w = (lambda a: (lambda t: t.to(torch.bfloat16) if t.is_floating_point() else t)(torch.as_tensor(a)))
    def _A_setup():
        B, S, D = 1, 2048, 576
        return {
            "x": _w((lambda *s: torch.randn(*s, dtype=torch.bfloat16) * 0.05)(B, S, D)),
            "wqkv": _w((lambda *s: torch.randn(*s, dtype=torch.bfloat16) * 1.6)(D, 3 * D)),
            "wo": _w((lambda *s: torch.randn(*s, dtype=torch.bfloat16) * 0.1)(D, D)),
        }
    _A_in = _A_setup()

    def _B_setup():
        B, S, D, F = 1, 2048, 576, 4608
        return {
            "x":  _w((lambda *s: torch.randn(*s, dtype=torch.bfloat16) * 0.05)(B, S, D)),
            "w1": _w((lambda *s: torch.randn(*s, dtype=torch.bfloat16) * 3.2)(D, D) * (D ** -0.5)),
            "w2": _w((lambda *s: torch.randn(*s, dtype=torch.bfloat16) * 3.2)(D, D) * (D ** -0.5)),
            "w3": _w((lambda *s: torch.randn(*s, dtype=torch.bfloat16) * 3.2)(D, F) * (D ** -0.5)),
            "w4": _w((lambda *s: torch.randn(*s, dtype=torch.bfloat16) * 3.2)(F, D) * (F ** -0.5)),
        }
    _B_in = _B_setup()

    return {
        "A_x": _A_in["x"],
        "A_wqkv": _A_in["wqkv"],
        "A_wo": _A_in["wo"],
        "B_x": _B_in["x"],
        "B_w1": _B_in["w1"],
        "B_w2": _B_in["w2"],
        "B_w3": _B_in["w3"],
        "B_w4": _B_in["w4"],
        "gate_w": _w((lambda *s: torch.randn(*s, dtype=torch.bfloat16) * 0.05)(576) * 16.0),
    }

def reference(A_x, A_wqkv, A_wo, B_x, B_w1, B_w2, B_w3, B_w4, gate_w):
    def _A_ref(x, wqkv, wo):
        B, S, D = x.shape
        H = 32; Dh = D // H
        qkv = (lambda x, *d: x.permute(*d))((x @ wqkv).reshape(B, S, 3, H, Dh), 2, 0, 3, 1, 4)
        q, k, v = qkv[0], qkv[1], qkv[2]
        scale = Dh ** -0.5
        scores = torch.einsum("bhqd,bhkd->bhqk", q, k) * scale
        p = _softmax(scores, axis=-1)
        o = torch.einsum("bhqk,bhkd->bhqd", p, v)
        return (lambda x, *d: x.permute(*d))(o, 0, 2, 1, 3).reshape(B, S, D) @ wo

    def _B_ref(x, w1, w2, w3, w4):
        B, S, D = x.shape
        h = _gelu(_layernorm(x, axis=-1) @ w1)
        c = D // 4
        g0 = _pad(h[:, :, 0*c:1*c], ((0, 0), (1, 0), (0, 0)))[:, :S, :]
        g1 = _pad(h[:, :, 1*c:2*c], ((0, 0), (0, 1), (0, 0)))[:, 1:, :]
        g2 = _pad(h[:, :, 2*c:3*c], ((0, 0), (2, 0), (0, 0)))[:, :S, :]
        g3 = _pad(h[:, :, 3*c:   ], ((0, 0), (0, 2), (0, 0)))[:, 2:, :]
        hs = torch.concatenate([g0, g1, g2, g3], axis=-1) @ w2
        x1 = x + hs
        h2 = _gelu(_layernorm(x1, axis=-1) @ w3) @ w4
        return x1 + h2

    x = A_x
    g = _sigmoid((x * gate_w).sum(-1, keepdims=True))
    a = _A_ref(x, A_wqkv, A_wo)
    b = _B_ref(x, B_w1, B_w2, B_w3, B_w4)
    return g * a + (1 - g) * b
```

```asm
; @launch grid=(256,1,1) block=(256,1,1) lds=154624
.amdgcn_target "amdgcn-amd-amdhsa--gfx950"
.text
.globl gated_mix__softmax_full_mha__mixer_s_mlp__prompt_kernel
.p2align 8
.type gated_mix__softmax_full_mha__mixer_s_mlp__prompt_kernel,@function
gated_mix__softmax_full_mha__mixer_s_mlp__prompt_kernel:
    s_cmp_ge_u32 s2, 256
    s_cbranch_scc1 L3_exit
    s_load_dwordx2 s[4:5], s[0:1], 88
    s_load_dwordx4 s[52:55], s[0:1], 0
    s_load_dwordx2 s[58:59], s[0:1], 32
    s_load_dwordx2 s[60:61], s[0:1], 64
    s_load_dwordx2 s[56:57], s[0:1], 80
    s_and_b32 s6, s2, 7
    s_lshr_b32 s7, s2, 3
    v_lshrrev_b32 v1, 6, v0
    v_and_b32 v0, 63, v0
    v_readfirstlane_b32 s8, v1
    s_and_b32 s9, s6, 3
    s_lshl_b32 s9, s9, 2
    s_and_b32 s3, s7, 3
    s_add_u32 s9, s9, s3
    s_lshr_b32 s11, s6, 2
    s_lshl_b32 s11, s11, 1
    s_bfe_u32 s3, s7, 0x10002
    s_add_u32 s11, s11, s3
    s_lshr_b32 s3, s7, 3
    s_lshl_b32 s10, s3, 2
    s_add_u32 s10, s10, s11
    v_lshlrev_b32 v1, 4, v0
    s_waitcnt lgkmcnt(0)
    s_mov_b32 s12, s4
    s_and_b32 s13, s5, 0xffff
    s_mov_b32 s14, 39624704
    s_mov_b32 s15, 0x20000
    s_cmp_eq_u32 s2, 0
    s_cbranch_scc0 K_nocnt
    s_cmp_eq_u32 s8, 3
    s_cbranch_scc0 K_nocnt
    v_lshlrev_b32 v2, 7, v0
    v_mov_b32 v3, 0
    s_mov_b32 s69, 39608320
    buffer_store_dword v3, v2, s[12:15], s69 offen sc1
    s_add_u32 s69, s69, 8192
    buffer_store_dword v3, v2, s[12:15], s69 offen sc1
K_nocnt:
    s_cmp_eq_u32 s3, 3
    s_cselect_b32 s64, s58, s54
    s_cselect_b32 s65, s59, s55
    s_movk_i32 s28, 3456
    s_cselect_b32 s28, 1152, s28
    s_mov_b32 s67, 36864
    s_mov_b32 s68, 4294856704
    s_cselect_b32 s66, s11, s10
    s_mov_b32 s16, s52
    s_and_b32 s17, s53, 0xffff
    s_mov_b32 s18, 2359296
    s_mov_b32 s19, 0x20000
    s_mov_b32 s20, s64
    s_and_b32 s21, s65, 0xffff
    s_mul_i32 s22, s28, 576
    s_mov_b32 s23, 0x20000
    s_mov_b32 s24, s60
    s_and_b32 s25, s61, 0xffff
    s_mov_b32 s26, 1152
    s_mov_b32 s27, 0x20000
    s_lshl_b32 s29, s9, 2
    s_add_u32 s29, s29, s8
    s_mul_i32 s29, s29, 36864
    s_mul_i32 s30, s66, 288
    s_lshl_b32 s34, s28, 6
    s_and_b32 s69, s7, 3
    s_lshl_b32 s69, s69, 1
    s_lshr_b32 s39, s7, 2
    s_add_u32 s39, s39, s69
    s_cmp_ge_u32 s39, 9
    s_cselect_b32 s69, 9, 0
    s_sub_u32 s39, s39, s69
    s_and_b32 s69, s7, 3
    s_lshr_b32 s39, s7, 2
    s_add_u32 s39, s39, s69
    s_mul_i32 s69, s39, 86
    s_lshr_b32 s69, s69, 8
    s_mul_i32 s69, s69, 3
    s_sub_u32 s39, s39, s69
    s_mul_i32 s39, s39, 3
    s_mov_b32 s64, s39
    s_mov_b32 s65, s39
    s_lshl_b32 s69, s39, 7
    s_add_u32 s29, s29, s69
    s_mul_i32 s69, s39, s34
    s_add_u32 s30, s30, s69
    s_mul_i32 s60, s34, -8
    s_movk_i32 s61, 128
    v_lshrrev_b32 v21, 3, v0
    v_add_u32 v21, 0, v21
    v_lshrrev_b32 v22, 1, v21
    v_and_b32 v22, 7, v22
    v_and_b32 v23, 7, v0
    v_xor_b32 v22, v22, v23
    v_mul_u32_u24 v21, 1152, v21
    v_lshlrev_b32 v22, 4, v22
    v_add_u32 v21, v21, v22
    v_subrev_u32 v2, 0, v21
    v_lshrrev_b32 v21, 3, v0
    v_add_u32 v21, 8, v21
    v_lshrrev_b32 v22, 1, v21
    v_and_b32 v22, 7, v22
    v_and_b32 v23, 7, v0
    v_xor_b32 v22, v22, v23
    v_mul_u32_u24 v21, 1152, v21
    v_lshlrev_b32 v22, 4, v22
    v_add_u32 v21, v21, v22
    v_subrev_u32 v3, 1024, v21
    v_lshrrev_b32 v21, 3, v0
    v_add_u32 v21, 16, v21
    v_lshrrev_b32 v22, 1, v21
    v_and_b32 v22, 7, v22
    v_and_b32 v23, 7, v0
    v_xor_b32 v22, v22, v23
    v_mul_u32_u24 v21, 1152, v21
    v_lshlrev_b32 v22, 4, v22
    v_add_u32 v21, v21, v22
    v_subrev_u32 v4, 2048, v21
    v_lshrrev_b32 v21, 3, v0
    v_add_u32 v21, 24, v21
    v_lshrrev_b32 v22, 1, v21
    v_and_b32 v22, 7, v22
    v_and_b32 v23, 7, v0
    v_xor_b32 v22, v22, v23
    v_mul_u32_u24 v21, 1152, v21
    v_lshlrev_b32 v22, 4, v22
    v_add_u32 v21, v21, v22
    v_subrev_u32 v5, 3072, v21
    s_mul_i32 s36, s8, 320
    v_add_u32 v21, s36, v0
    v_add_u32 v21, 0, v21
    v_mul_u32_u24 v22, 3277, v21
    v_lshrrev_b32 v22, 16, v22
    v_mul_u32_u24 v23, 20, v22
    v_sub_u32 v23, v21, v23
    v_mul_lo_u32 v22, v22, s28
    v_cmp_lt_u32 vcc, 17, v23
    v_subrev_u32 v24, 2, v23
    s_nop 0
    v_cndmask_b32 v24, v23, v24, vcc
    v_lshlrev_b32 v24, 4, v24
    v_add_u32 v22, v22, v24
    v_and_b32 v24, 30, v23
    v_cmp_eq_u32 vcc, 16, v24
    v_mov_b32 v25, 0x40000000
    s_nop 0
    v_cndmask_b32 v6, v22, v25, vcc
    v_add_u32 v21, s36, v0
    v_add_u32 v21, 64, v21
    v_mul_u32_u24 v22, 3277, v21
    v_lshrrev_b32 v22, 16, v22
    v_mul_u32_u24 v23, 20, v22
    v_sub_u32 v23, v21, v23
    v_mul_lo_u32 v22, v22, s28
    v_cmp_lt_u32 vcc, 17, v23
    v_subrev_u32 v24, 2, v23
    s_nop 0
    v_cndmask_b32 v24, v23, v24, vcc
    v_lshlrev_b32 v24, 4, v24
    v_add_u32 v22, v22, v24
    v_subrev_u32 v22, 1024, v22
    v_and_b32 v24, 30, v23
    v_cmp_eq_u32 vcc, 16, v24
    v_mov_b32 v25, 0x40000000
    s_nop 0
    v_cndmask_b32 v7, v22, v25, vcc
    v_add_u32 v21, s36, v0
    v_add_u32 v21, 128, v21
    v_mul_u32_u24 v22, 3277, v21
    v_lshrrev_b32 v22, 16, v22
    v_mul_u32_u24 v23, 20, v22
    v_sub_u32 v23, v21, v23
    v_mul_lo_u32 v22, v22, s28
    v_cmp_lt_u32 vcc, 17, v23
    v_subrev_u32 v24, 2, v23
    s_nop 0
    v_cndmask_b32 v24, v23, v24, vcc
    v_lshlrev_b32 v24, 4, v24
    v_add_u32 v22, v22, v24
    v_subrev_u32 v22, 2048, v22
    v_and_b32 v24, 30, v23
    v_cmp_eq_u32 vcc, 16, v24
    v_mov_b32 v25, 0x40000000
    s_nop 0
    v_cndmask_b32 v8, v22, v25, vcc
    v_add_u32 v21, s36, v0
    v_add_u32 v21, 192, v21
    v_mul_u32_u24 v22, 3277, v21
    v_lshrrev_b32 v22, 16, v22
    v_mul_u32_u24 v23, 20, v22
    v_sub_u32 v23, v21, v23
    v_mul_lo_u32 v22, v22, s28
    v_cmp_lt_u32 vcc, 17, v23
    v_subrev_u32 v24, 2, v23
    s_nop 0
    v_cndmask_b32 v24, v23, v24, vcc
    v_lshlrev_b32 v24, 4, v24
    v_add_u32 v22, v22, v24
    v_subrev_u32 v22, 3072, v22
    v_and_b32 v24, 30, v23
    v_cmp_eq_u32 vcc, 16, v24
    v_mov_b32 v25, 0x40000000
    s_nop 0
    v_cndmask_b32 v9, v22, v25, vcc
    v_add_u32 v21, s36, v0
    v_add_u32 v21, 256, v21
    v_mul_u32_u24 v22, 3277, v21
    v_lshrrev_b32 v22, 16, v22
    v_mul_u32_u24 v23, 20, v22
    v_sub_u32 v23, v21, v23
    v_mul_lo_u32 v22, v22, s28
    v_cmp_lt_u32 vcc, 17, v23
    v_subrev_u32 v24, 2, v23
    s_nop 0
    v_cndmask_b32 v24, v23, v24, vcc
    v_lshlrev_b32 v24, 4, v24
    v_add_u32 v22, v22, v24
    v_and_b32 v24, 30, v23
    v_cmp_eq_u32 vcc, 16, v24
    v_mov_b32 v25, 0x40000000
    s_nop 0
    v_cndmask_b32 v10, v22, v25, vcc
    v_and_b32 v21, 31, v0
    v_lshrrev_b32 v22, 5, v0
    v_lshrrev_b32 v23, 1, v21
    v_and_b32 v23, 7, v23
    v_xor_b32 v23, v23, v22
    v_lshlrev_b32 v23, 4, v23
    v_lshlrev_b32 v24, 7, v21
    v_add_u32 v23, v23, v24
    s_lshl_b32 s31, s8, 12
    v_add_u32 v11, s31, v23
    v_xor_b32 v12, 32, v11
    v_xor_b32 v13, 64, v11
    v_xor_b32 v14, 96, v11
    s_mul_i32 s36, s8, 5120
    s_add_u32 s36, s36, 16384
    s_mov_b32 s40, 0x3f803f80
    s_cmp_eq_u32 s3, 2
    s_cbranch_scc1 L1_v
    s_cmp_eq_u32 s3, 3
    s_cbranch_scc1 L1_h
    s_cmp_eq_u32 s10, 0
    s_cbranch_scc0 L1_qk
    s_mov_b32 m0, 147456
    s_nop 0
    buffer_load_dwordx4 v1, s[24:27], 0 offen lds
    buffer_load_dwordx4 v1, s[24:27], 0 offen offset:1024 lds
    s_mov_b32 s35, 0
    s_mov_b32 s38, 0
    s_add_u32 m0, s35, s31
    s_nop 0
    buffer_load_dwordx4 v2, s[16:19], s29 offen lds
    buffer_load_dwordx4 v3, s[16:19], s29 offen offset:1024 lds
    buffer_load_dwordx4 v4, s[16:19], s29 offen offset:2048 lds
    buffer_load_dwordx4 v5, s[16:19], s29 offen offset:3072 lds
    s_add_u32 s39, s39, 1
    s_cmp_eq_u32 s39, 9
    s_cselect_b32 s39, 0, s39
    s_cselect_b32 s69, 4294966272, s61
    s_add_u32 s29, s29, s69
    s_add_u32 s35, s35, 36864
    s_cmp_eq_u32 s35, 147456
    s_cselect_b32 s35, 0, s35
    s_add_u32 m0, s38, s36
    s_nop 0
    buffer_load_dwordx4 v6, s[20:23], s30 offen lds
    buffer_load_dwordx4 v7, s[20:23], s30 offen offset:1024 lds
    buffer_load_dwordx4 v8, s[20:23], s30 offen offset:2048 lds
    buffer_load_dwordx4 v9, s[20:23], s30 offen offset:3072 lds
    s_add_u32 m0, m0, 4096
    s_nop 0
    buffer_load_dwordx4 v10, s[20:23], s30 offen lds
    s_add_u32 s64, s64, 1
    s_cmp_eq_u32 s64, 9
    s_cselect_b32 s64, 0, s64
    s_cselect_b32 s69, s60, s34
    s_add_u32 s30, s30, s69
    s_add_u32 s38, s38, 36864
    s_cmp_eq_u32 s38, 147456
    s_cselect_b32 s38, 0, s38
    s_add_u32 m0, s35, s31
    s_nop 0
    buffer_load_dwordx4 v2, s[16:19], s29 offen lds
    buffer_load_dwordx4 v3, s[16:19], s29 offen offset:1024 lds
    buffer_load_dwordx4 v4, s[16:19], s29 offen offset:2048 lds
    buffer_load_dwordx4 v5, s[16:19], s29 offen offset:3072 lds
    s_add_u32 s39, s39, 1
    s_cmp_eq_u32 s39, 9
    s_cselect_b32 s39, 0, s39
    s_cselect_b32 s69, 4294966272, s61
    s_add_u32 s29, s29, s69
    s_add_u32 s35, s35, 36864
    s_cmp_eq_u32 s35, 147456
    s_cselect_b32 s35, 0, s35
    s_add_u32 m0, s38, s36
    s_nop 0
    buffer_load_dwordx4 v6, s[20:23], s30 offen lds
    buffer_load_dwordx4 v7, s[20:23], s30 offen offset:1024 lds
    buffer_load_dwordx4 v8, s[20:23], s30 offen offset:2048 lds
    buffer_load_dwordx4 v9, s[20:23], s30 offen offset:3072 lds
    s_add_u32 m0, m0, 4096
    s_nop 0
    buffer_load_dwordx4 v10, s[20:23], s30 offen lds
    s_add_u32 s64, s64, 1
    s_cmp_eq_u32 s64, 9
    s_cselect_b32 s64, 0, s64
    s_cselect_b32 s69, s60, s34
    s_add_u32 s30, s30, s69
    s_add_u32 s38, s38, 36864
    s_cmp_eq_u32 s38, 147456
    s_cselect_b32 s38, 0, s38
    s_add_u32 m0, s35, s31
    s_nop 0
    buffer_load_dwordx4 v2, s[16:19], s29 offen lds
    buffer_load_dwordx4 v3, s[16:19], s29 offen offset:1024 lds
    buffer_load_dwordx4 v4, s[16:19], s29 offen offset:2048 lds
    buffer_load_dwordx4 v5, s[16:19], s29 offen offset:3072 lds
    s_add_u32 s39, s39, 1
    s_cmp_eq_u32 s39, 9
    s_cselect_b32 s39, 0, s39
    s_cselect_b32 s69, 4294966272, s61
    s_add_u32 s29, s29, s69
    s_add_u32 s35, s35, 36864
    s_cmp_eq_u32 s35, 147456
    s_cselect_b32 s35, 0, s35
    v_lshrrev_b32 v21, 5, v0
    v_bfe_u32 v22, v0, 4, 1
    v_bfe_u32 v23, v0, 2, 2
    v_and_b32 v24, 3, v0
    v_and_b32 v25, 1, v0
    v_lshlrev_b32 v25, 1, v25
    v_bfe_u32 v26, v0, 1, 1
    v_or_b32 v25, v25, v26
    v_lshlrev_b32 v26, 3, v21
    v_add_u32 v26, v26, v23
    v_mul_u32_u24 v26, 320, v26
    v_add_u32 v26, 16384, v26
    v_lshlrev_b32 v27, 3, v25
    v_add_u32 v27, v27, v26
    v_mul_u32_u24 v28, 288, v22
    v_add_u32 v15, v27, v28
    v_lshlrev_b32 v28, 5, v22
    v_add_u32 v27, v27, v28
    v_add_u32 v16, 40, v27
    v_add_u32 v17, 112, v27
    v_add_u32 v18, 184, v27
    v_mul_u32_u24 v28, 72, v24
    v_add_u32 v28, v28, v26
    v_add_u32 v19, 32, v28
    v_lshrrev_b32 v21, 5, v0
    v_lshlrev_b32 v21, 4, v21
    v_add_u32 v20, 147456, v21
    s_lshl_b32 s69, s65, 7
    v_add_u32 v20, s69, v20
    v_mov_b32 v112, 0
    v_mov_b32 v113, 0
    v_mov_b32 v114, 0
    v_mov_b32 v115, 0
    s_nop 1
    v_mfma_f32_32x32x16_bf16 v[32:47], v[112:115], v[112:115], 0
    v_mfma_f32_32x32x16_bf16 v[48:63], v[112:115], v[112:115], 0
    v_mfma_f32_32x32x16_bf16 v[64:79], v[112:115], v[112:115], 0
    v_mfma_f32_32x32x16_bf16 v[80:95], v[112:115], v[112:115], 0
    v_mfma_f32_32x32x16_bf16 v[96:111], v[112:115], v[112:115], 0
    v_mfma_f32_32x32x16_bf16 v[224:239], v[112:115], v[112:115], 0
    s_cmp_eq_u32 s3, 0
    s_cselect_b32 s41, 0x3eae1a93, 1.0
    s_mov_b32 s42, 2359296
    s_cselect_b32 s42, 0, s42
    s_mov_b32 s43, 4456448
    s_cselect_b32 s43, 2097152, s43
    s_mov_b32 s32, 0
    s_waitcnt vmcnt(13)
    s_barrier
    s_cmp_eq_u32 s2, 0
    s_cbranch_scc0 K_noflag
    s_cmp_eq_u32 s8, 3
    s_cbranch_scc0 K_noflag
    s_mov_b64 exec, 1
    v_mov_b32 v30, 0
    v_mov_b32 v31, 1
    global_store_dword v30, v31, s[56:57] sc1
    s_mov_b64 exec, -1
K_noflag:
    ds_read_b128 v[112:115], v11
    ds_read_b128 v[208:211], v20 offset:0
    ds_read_b64_tr_b16 v[128:129], v15 offset:0
    ds_read_b64_tr_b16 v[130:131], v15 offset:1280
    ds_read_b64_tr_b16 v[132:133], v16 offset:0
    ds_read_b64_tr_b16 v[134:135], v16 offset:1280
    ds_read_b64_tr_b16 v[136:137], v17 offset:0
    ds_read_b64_tr_b16 v[138:139], v17 offset:1280
    ds_read_b64_tr_b16 v[140:141], v18 offset:0
    ds_read_b64_tr_b16 v[142:143], v18 offset:1280
    ds_read_b64_tr_b16 v[144:145], v19 offset:0
    ds_read_b64_tr_b16 v[146:147], v19 offset:1280
    ds_read_b128 v[116:119], v12
    ds_read_b128 v[212:215], v20 offset:32
    ds_read_b64_tr_b16 v[148:149], v15 offset:5120
    ds_read_b64_tr_b16 v[150:151], v15 offset:6400
    ds_read_b64_tr_b16 v[152:153], v16 offset:5120
    ds_read_b64_tr_b16 v[154:155], v16 offset:6400
    ds_read_b64_tr_b16 v[156:157], v17 offset:5120
    ds_read_b64_tr_b16 v[158:159], v17 offset:6400
    ds_read_b64_tr_b16 v[160:161], v18 offset:5120
    ds_read_b64_tr_b16 v[162:163], v18 offset:6400
    ds_read_b64_tr_b16 v[164:165], v19 offset:5120
    ds_read_b64_tr_b16 v[166:167], v19 offset:6400
.p2align 6
L1_loop_q0:
    s_waitcnt lgkmcnt(12)
    v_mfma_f32_32x32x16_bf16 v[32:47], v[128:131], v[112:115], v[32:47]
    ds_read_b128 v[120:123], v13
    ds_read_b128 v[216:219], v20 offset:64
    ds_read_b64_tr_b16 v[168:169], v15 offset:10240
    s_add_u32 m0, s38, s36
    s_nop 0
    buffer_load_dwordx4 v6, s[20:23], s30 offen lds
    v_mfma_f32_32x32x16_bf16 v[48:63], v[132:135], v[112:115], v[48:63]
    ds_read_b64_tr_b16 v[170:171], v15 offset:11520
    ds_read_b64_tr_b16 v[172:173], v16 offset:10240
    ds_read_b64_tr_b16 v[174:175], v16 offset:11520
    v_mfma_f32_32x32x16_bf16 v[64:79], v[136:139], v[112:115], v[64:79]
    ds_read_b64_tr_b16 v[176:177], v17 offset:10240
    ds_read_b64_tr_b16 v[178:179], v17 offset:11520
    ds_read_b64_tr_b16 v[180:181], v18 offset:10240
    buffer_load_dwordx4 v7, s[20:23], s30 offen offset:1024 lds
    v_mfma_f32_32x32x16_bf16 v[80:95], v[140:143], v[112:115], v[80:95]
    ds_read_b64_tr_b16 v[182:183], v18 offset:11520
    ds_read_b64_tr_b16 v[184:185], v19 offset:10240
    ds_read_b64_tr_b16 v[186:187], v19 offset:11520
    v_mfma_f32_32x32x16_bf16 v[96:111], v[144:147], v[112:115], v[96:111]
    buffer_load_dwordx4 v8, s[20:23], s30 offen offset:2048 lds
    v_mfma_f32_32x32x16_bf16 v[224:239], v[208:211], v[112:115], v[224:239]
    s_waitcnt lgkmcnt(12)
    v_mfma_f32_32x32x16_bf16 v[32:47], v[148:151], v[116:119], v[32:47]
    ds_read_b128 v[124:127], v14
    ds_read_b128 v[220:223], v20 offset:96
    ds_read_b64_tr_b16 v[188:189], v15 offset:15360
    v_mfma_f32_32x32x16_bf16 v[48:63], v[152:155], v[116:119], v[48:63]
    ds_read_b64_tr_b16 v[190:191], v15 offset:16640
    ds_read_b64_tr_b16 v[192:193], v16 offset:15360
    ds_read_b64_tr_b16 v[194:195], v16 offset:16640
    buffer_load_dwordx4 v9, s[20:23], s30 offen offset:3072 lds
    v_mfma_f32_32x32x16_bf16 v[64:79], v[156:159], v[116:119], v[64:79]
    ds_read_b64_tr_b16 v[196:197], v17 offset:15360
    ds_read_b64_tr_b16 v[198:199], v17 offset:16640
    ds_read_b64_tr_b16 v[200:201], v18 offset:15360
    v_mfma_f32_32x32x16_bf16 v[80:95], v[160:163], v[116:119], v[80:95]
    ds_read_b64_tr_b16 v[202:203], v18 offset:16640
    ds_read_b64_tr_b16 v[204:205], v19 offset:15360
    ds_read_b64_tr_b16 v[206:207], v19 offset:16640
    s_add_u32 m0, m0, 4096
    s_nop 0
    buffer_load_dwordx4 v10, s[20:23], s30 offen lds
    s_add_u32 s64, s64, 1
    s_cmp_eq_u32 s64, 9
    s_cselect_b32 s64, 0, s64
    s_cselect_b32 s69, s60, s34
    s_add_u32 s30, s30, s69
    s_add_u32 s38, s38, 36864
    s_cmp_eq_u32 s38, 147456
    s_cselect_b32 s38, 0, s38
    v_mfma_f32_32x32x16_bf16 v[96:111], v[164:167], v[116:119], v[96:111]
    v_mfma_f32_32x32x16_bf16 v[224:239], v[212:215], v[116:119], v[224:239]
    s_add_u32 s37, s32, 1
    s_and_b32 s33, s37, 3
    s_cmp_eq_u32 s33, 0
    s_cselect_b32 s33, s68, s67
    v_add_u32 v11, s33, v11
    v_add_u32 v12, s33, v12
    v_add_u32 v13, s33, v13
    v_add_u32 v14, s33, v14
    v_add_u32 v15, s33, v15
    v_add_u32 v16, s33, v16
    v_add_u32 v17, s33, v17
    v_add_u32 v18, s33, v18
    v_add_u32 v19, s33, v19
    s_add_u32 s65, s65, 1
    s_cmp_eq_u32 s65, 9
    s_cselect_b32 s65, 0, s65
    s_cselect_b32 s66, 4294966272, s61
    v_add_u32 v20, s66, v20
    s_waitcnt lgkmcnt(12)
    v_mfma_f32_32x32x16_bf16 v[32:47], v[168:171], v[120:123], v[32:47]
    s_waitcnt vmcnt(9)
    s_barrier
    s_cmp_lt_u32 s32, 6
    s_cselect_b32 s29, s29, 0x40000000
    s_cselect_b32 s30, s30, 0x40000000
    ds_read_b128 v[112:115], v11
    ds_read_b128 v[208:211], v20 offset:0
    ds_read_b64_tr_b16 v[128:129], v15 offset:0
    v_mfma_f32_32x32x16_bf16 v[48:63], v[172:175], v[120:123], v[48:63]
    ds_read_b64_tr_b16 v[130:131], v15 offset:1280
    ds_read_b64_tr_b16 v[132:133], v16 offset:0
    ds_read_b64_tr_b16 v[134:135], v16 offset:1280
    v_mfma_f32_32x32x16_bf16 v[64:79], v[176:179], v[120:123], v[64:79]
    ds_read_b64_tr_b16 v[136:137], v17 offset:0
    ds_read_b64_tr_b16 v[138:139], v17 offset:1280
    ds_read_b64_tr_b16 v[140:141], v18 offset:0
    s_add_u32 m0, s35, s31
    s_nop 0
    buffer_load_dwordx4 v2, s[16:19], s29 offen lds
    v_mfma_f32_32x32x16_bf16 v[80:95], v[180:183], v[120:123], v[80:95]
    ds_read_b64_tr_b16 v[142:143], v18 offset:1280
    ds_read_b64_tr_b16 v[144:145], v19 offset:0
    ds_read_b64_tr_b16 v[146:147], v19 offset:1280
    v_mfma_f32_32x32x16_bf16 v[96:111], v[184:187], v[120:123], v[96:111]
    buffer_load_dwordx4 v3, s[16:19], s29 offen offset:1024 lds
    v_mfma_f32_32x32x16_bf16 v[224:239], v[216:219], v[120:123], v[224:239]
    s_waitcnt lgkmcnt(12)
    v_mfma_f32_32x32x16_bf16 v[32:47], v[188:191], v[124:127], v[32:47]
    ds_read_b128 v[116:119], v12
    ds_read_b128 v[212:215], v20 offset:32
    ds_read_b64_tr_b16 v[148:149], v15 offset:5120
    v_mfma_f32_32x32x16_bf16 v[48:63], v[192:195], v[124:127], v[48:63]
    ds_read_b64_tr_b16 v[150:151], v15 offset:6400
    ds_read_b64_tr_b16 v[152:153], v16 offset:5120
    ds_read_b64_tr_b16 v[154:155], v16 offset:6400
    buffer_load_dwordx4 v4, s[16:19], s29 offen offset:2048 lds
    v_mfma_f32_32x32x16_bf16 v[64:79], v[196:199], v[124:127], v[64:79]
    ds_read_b64_tr_b16 v[156:157], v17 offset:5120
    ds_read_b64_tr_b16 v[158:159], v17 offset:6400
    ds_read_b64_tr_b16 v[160:161], v18 offset:5120
    v_mfma_f32_32x32x16_bf16 v[80:95], v[200:203], v[124:127], v[80:95]
    ds_read_b64_tr_b16 v[162:163], v18 offset:6400
    ds_read_b64_tr_b16 v[164:165], v19 offset:5120
    ds_read_b64_tr_b16 v[166:167], v19 offset:6400
    buffer_load_dwordx4 v5, s[16:19], s29 offen offset:3072 lds
    s_add_u32 s39, s39, 1
    s_cmp_eq_u32 s39, 9
    s_cselect_b32 s39, 0, s39
    s_cselect_b32 s69, 4294966272, s61
    s_add_u32 s29, s29, s69
    s_add_u32 s35, s35, 36864
    s_cmp_eq_u32 s35, 147456
    s_cselect_b32 s35, 0, s35
    v_mfma_f32_32x32x16_bf16 v[96:111], v[204:207], v[124:127], v[96:111]
    v_mfma_f32_32x32x16_bf16 v[224:239], v[220:223], v[124:127], v[224:239]
    s_add_u32 s32, s32, 1
    s_cmp_lt_u32 s32, 9
    s_cbranch_scc1 L1_loop_q0
    s_waitcnt lgkmcnt(0)
    s_nop 7
    s_lshl_b32 s44, s9, 2
    s_add_u32 s44, s44, s8
    s_lshl_b32 s45, s11, 3
    s_lshl_b32 s46, s45, 16
    s_lshl_b32 s47, s44, 10
    s_add_u32 s46, s46, s47
    s_add_u32 s46, s46, s42
    v_mul_f32 v32, s41, v32
    v_mul_f32 v33, s41, v33
    v_mul_f32 v34, s41, v34
    v_mul_f32 v35, s41, v35
    v_mul_f32 v36, s41, v36
    v_mul_f32 v37, s41, v37
    v_mul_f32 v38, s41, v38
    v_mul_f32 v39, s41, v39
    v_mul_f32 v40, s41, v40
    v_mul_f32 v41, s41, v41
    v_mul_f32 v42, s41, v42
    v_mul_f32 v43, s41, v43
    v_mul_f32 v44, s41, v44
    v_mul_f32 v45, s41, v45
    v_mul_f32 v46, s41, v46
    v_mul_f32 v47, s41, v47
    v_cvt_pk_bf16_f32 v112, v32, v33
    v_cvt_pk_bf16_f32 v113, v34, v35
    v_cvt_pk_bf16_f32 v114, v36, v37
    v_cvt_pk_bf16_f32 v115, v38, v39
    s_add_u32 s47, s46, 0
    buffer_store_dwordx4 v[112:115], v1, s[12:15], s47 offen sc1
    v_cvt_pk_bf16_f32 v116, v40, v41
    v_cvt_pk_bf16_f32 v117, v42, v43
    v_cvt_pk_bf16_f32 v118, v44, v45
    v_cvt_pk_bf16_f32 v119, v46, v47
    s_add_u32 s47, s46, 458752
    buffer_store_dwordx4 v[116:119], v1, s[12:15], s47 offen sc1
    v_mul_f32 v48, s41, v48
    v_mul_f32 v49, s41, v49
    v_mul_f32 v50, s41, v50
    v_mul_f32 v51, s41, v51
    v_mul_f32 v52, s41, v52
    v_mul_f32 v53, s41, v53
    v_mul_f32 v54, s41, v54
    v_mul_f32 v55, s41, v55
    v_mul_f32 v56, s41, v56
    v_mul_f32 v57, s41, v57
    v_mul_f32 v58, s41, v58
    v_mul_f32 v59, s41, v59
    v_mul_f32 v60, s41, v60
    v_mul_f32 v61, s41, v61
    v_mul_f32 v62, s41, v62
    v_mul_f32 v63, s41, v63
    v_cvt_pk_bf16_f32 v120, v48, v49
    v_cvt_pk_bf16_f32 v121, v50, v51
    v_cvt_pk_bf16_f32 v122, v52, v53
    v_cvt_pk_bf16_f32 v123, v54, v55
    s_add_u32 s47, s46, 65536
    buffer_store_dwordx4 v[120:123], v1, s[12:15], s47 offen sc1
    v_cvt_pk_bf16_f32 v124, v56, v57
    v_cvt_pk_bf16_f32 v125, v58, v59
    v_cvt_pk_bf16_f32 v126, v60, v61
    v_cvt_pk_bf16_f32 v127, v62, v63
    s_add_u32 s47, s46, 131072
    buffer_store_dwordx4 v[124:127], v1, s[12:15], s47 offen sc1
    v_mul_f32 v64, s41, v64
    v_mul_f32 v65, s41, v65
    v_mul_f32 v66, s41, v66
    v_mul_f32 v67, s41, v67
    v_mul_f32 v68, s41, v68
    v_mul_f32 v69, s41, v69
    v_mul_f32 v70, s41, v70
    v_mul_f32 v71, s41, v71
    v_mul_f32 v72, s41, v72
    v_mul_f32 v73, s41, v73
    v_mul_f32 v74, s41, v74
    v_mul_f32 v75, s41, v75
    v_mul_f32 v76, s41, v76
    v_mul_f32 v77, s41, v77
    v_mul_f32 v78, s41, v78
    v_mul_f32 v79, s41, v79
    v_cvt_pk_bf16_f32 v112, v64, v65
    v_cvt_pk_bf16_f32 v113, v66, v67
    v_cvt_pk_bf16_f32 v114, v68, v69
    v_cvt_pk_bf16_f32 v115, v70, v71
    s_add_u32 s47, s46, 196608
    buffer_store_dwordx4 v[112:115], v1, s[12:15], s47 offen sc1
    v_cvt_pk_bf16_f32 v116, v72, v73
    v_cvt_pk_bf16_f32 v117, v74, v75
    v_cvt_pk_bf16_f32 v118, v76, v77
    v_cvt_pk_bf16_f32 v119, v78, v79
    s_add_u32 s47, s46, 262144
    buffer_store_dwordx4 v[116:119], v1, s[12:15], s47 offen sc1
    v_mul_f32 v80, s41, v80
    v_mul_f32 v81, s41, v81
    v_mul_f32 v82, s41, v82
    v_mul_f32 v83, s41, v83
    v_mul_f32 v84, s41, v84
    v_mul_f32 v85, s41, v85
    v_mul_f32 v86, s41, v86
    v_mul_f32 v87, s41, v87
    v_mul_f32 v88, s41, v88
    v_mul_f32 v89, s41, v89
    v_mul_f32 v90, s41, v90
    v_mul_f32 v91, s41, v91
    v_mul_f32 v92, s41, v92
    v_mul_f32 v93, s41, v93
    v_mul_f32 v94, s41, v94
    v_mul_f32 v95, s41, v95
    v_cvt_pk_bf16_f32 v120, v80, v81
    v_cvt_pk_bf16_f32 v121, v82, v83
    v_cvt_pk_bf16_f32 v122, v84, v85
    v_cvt_pk_bf16_f32 v123, v86, v87
    s_add_u32 s47, s46, 327680
    buffer_store_dwordx4 v[120:123], v1, s[12:15], s47 offen sc1
    v_cvt_pk_bf16_f32 v124, v88, v89
    v_cvt_pk_bf16_f32 v125, v90, v91
    v_cvt_pk_bf16_f32 v126, v92, v93
    v_cvt_pk_bf16_f32 v127, v94, v95
    s_add_u32 s47, s46, 393216
    buffer_store_dwordx4 v[124:127], v1, s[12:15], s47 offen sc1
    v_mul_f32 v96, s41, v96
    v_mul_f32 v97, s41, v97
    v_mul_f32 v98, s41, v98
    v_mul_f32 v99, s41, v99
    v_mul_f32 v100, s41, v100
    v_mul_f32 v101, s41, v101
    v_mul_f32 v102, s41, v102
    v_mul_f32 v103, s41, v103
    v_cvt_pk_bf16_f32 v128, v96, v97
    v_cvt_pk_bf16_f32 v129, v98, v99
    v_cvt_pk_bf16_f32 v130, v100, v101
    v_cvt_pk_bf16_f32 v131, v102, v103
    v_and_b32 v21, 31, v0
    v_lshlrev_b32 v21, 2, v21
    v_lshrrev_b32 v29, 5, v0
    v_lshlrev_b32 v29, 14, v29
    v_add_u32 v21, v21, v29
    s_lshl_b32 s46, s45, 13
    s_lshl_b32 s47, s44, 7
    s_add_u32 s46, s46, s47
    s_add_u32 s46, s46, s43
    s_add_u32 s47, s46, 0
    buffer_store_dword v128, v21, s[12:15], s47 offen sc1
    s_add_u32 s47, s46, 8192
    buffer_store_dword v129, v21, s[12:15], s47 offen sc1
    s_add_u32 s47, s46, 32768
    buffer_store_dword v130, v21, s[12:15], s47 offen sc1
    s_add_u32 s47, s46, 40960
    buffer_store_dword v131, v21, s[12:15], s47 offen sc1
    v_mul_f32 v23, 0xbfb8aa3b, v224
    v_exp_f32 v23, v23
    s_nop 0
    v_add_f32 v23, 1.0, v23
    v_rcp_f32 v23, v23
    v_and_b32 v21, 31, v0
    v_lshlrev_b32 v21, 2, v21
    s_lshl_b32 s47, s44, 7
    s_add_u32 s47, s47, 9568256
    s_mov_b64 exec, 0xffffffff
    buffer_store_dword v23, v21, s[12:15], s47 offen sc1
    s_mov_b64 exec, -1
    s_mul_i32 s48, s11, 128
    s_add_u32 s48, s48, 5760
    s_mov_b64 exec, -1
    s_load_dwordx2 s[46:47], s[0:1], 80
    s_add_u32 s34, s4, 39608320
    s_addc_u32 s35, s5, 0
    v_mov_b32 v248, 0
    v_mov_b32 v249, 0
    s_waitcnt vmcnt(13) lgkmcnt(0)
    s_barrier
    s_cmp_eq_u32 s8, 0
    s_cbranch_scc0 Lp1_712_a
    global_load_dword v249, v248, s[46:47] sc1
Lp1_712_a:
    s_mov_b32 s67, 1
    s_movk_i32 s68, 84
    s_mov_b32 s66, 0
    s_cmp_lt_u32 s7, 16
    s_cbranch_scc0 Lus_724_a
    s_lshr_b32 s64, s7, 3
    s_lshl_b32 s65, s6, 1
    s_add_u32 s64, s64, s65
    s_and_b32 s65, s7, 7
    s_cmp_ge_u32 s7, 8
    s_cbranch_scc0 Lus_724_z
    s_sub_u32 s68, s7, 8
    s_lshl_b32 s68, s68, 3
    s_add_u32 s68, s68, s6
    s_cmp_lt_u32 s68, 36
    s_cbranch_scc0 Lus_724_z
    s_mov_b32 s67, 3
    s_cmp_lt_u32 s68, 24
    s_cbranch_scc0 Lus_724_w
    s_mul_i32 s66, s68, 86
    s_lshr_b32 s66, s66, 8
    s_mul_i32 s69, s66, 6
    s_add_u32 s68, s68, s69
    s_add_u32 s68, s68, 6
    s_mul_i32 s66, s66, 128
    s_add_u32 s66, s66, 8320
    s_branch Lus_724_z
Lus_724_w:
    s_add_u32 s68, s68, 48
    s_movk_i32 s66, 3072
    s_branch Lus_724_z
Lus_724_a:
    s_cmp_lt_u32 s7, 24
    s_cbranch_scc1 Lus_724_v
    s_mov_b32 s67, 0
    s_branch Lus_724_z
Lus_724_v:
    s_sub_u32 s68, s7, 16
    s_lshl_b32 s68, s68, 3
    s_add_u32 s68, s68, s6
    s_cmp_lt_u32 s68, 16
    s_cbranch_scc0 Lus_724_b
    s_lshr_b32 s64, s68, 3
    s_lshl_b32 s65, s6, 1
    s_add_u32 s64, s64, s65
    s_mov_b32 s65, 8
    s_branch Lus_724_z
Lus_724_b:
    s_mov_b32 s67, 2
    s_sub_u32 s68, s68, 16
    s_mul_i32 s64, s68, 43
    s_lshr_b32 s64, s64, 8
    s_mul_i32 s65, s64, 3
    s_add_u32 s68, s68, s65
    s_mul_i32 s66, s64, 128
    s_add_u32 s66, s66, 2048
Lus_724_z:
    s_cmp_eq_u32 s67, 2
    s_cbranch_scc1 Lue_724_r
    s_load_dwordx2 s[24:25], s[0:1], 40
    v_lshrrev_b32 v5, 3, v0
    v_and_b32 v6, 7, v0
    v_bfe_u32 v7, v0, 4, 1
    v_lshlrev_b32 v7, 2, v7
    v_xor_b32 v6, v6, v7
    v_mul_u32_u24 v5, 1152, v5
    v_lshlrev_b32 v6, 4, v6
    v_add_u32 v2, v5, v6
    v_add_u32 v3, 8192, v2
    s_waitcnt lgkmcnt(0)
    s_mov_b32 s16, s24
    s_and_b32 s17, s25, 0xffff
    s_mov_b32 s18, 663552
    s_mov_b32 s19, 0x20000
    s_mul_i32 s28, s8, 18432
    s_lshl_b32 s29, s65, 7
    s_add_u32 s28, s28, s29
    s_mul_i32 s29, s8, 2048
    s_add_u32 m0, s29, 0
    s_add_u32 s31, s28, 0
    buffer_load_dwordx4 v2, s[16:19], s31 offen lds
    buffer_load_dwordx4 v3, s[16:19], s31 offen offset:1024 lds
    s_add_u32 m0, s29, 8192
    s_add_u32 s31, s28, 73728
    buffer_load_dwordx4 v2, s[16:19], s31 offen lds
    buffer_load_dwordx4 v3, s[16:19], s31 offen offset:1024 lds
    s_add_u32 m0, s29, 16384
    s_add_u32 s31, s28, 147456
    buffer_load_dwordx4 v2, s[16:19], s31 offen lds
    buffer_load_dwordx4 v3, s[16:19], s31 offen offset:1024 lds
    s_add_u32 m0, s29, 24576
    s_add_u32 s31, s28, 221184
    buffer_load_dwordx4 v2, s[16:19], s31 offen lds
    buffer_load_dwordx4 v3, s[16:19], s31 offen offset:1024 lds
    s_add_u32 m0, s29, 32768
    s_add_u32 s31, s28, 294912
    buffer_load_dwordx4 v2, s[16:19], s31 offen lds
    buffer_load_dwordx4 v3, s[16:19], s31 offen offset:1024 lds
    s_add_u32 m0, s29, 40960
    s_add_u32 s31, s28, 368640
    buffer_load_dwordx4 v2, s[16:19], s31 offen lds
    buffer_load_dwordx4 v3, s[16:19], s31 offen offset:1024 lds
    s_add_u32 m0, s29, 49152
    s_add_u32 s31, s28, 442368
    buffer_load_dwordx4 v2, s[16:19], s31 offen lds
    buffer_load_dwordx4 v3, s[16:19], s31 offen offset:1024 lds
    s_add_u32 m0, s29, 57344
    s_add_u32 s31, s28, 516096
    buffer_load_dwordx4 v2, s[16:19], s31 offen lds
    buffer_load_dwordx4 v3, s[16:19], s31 offen offset:1024 lds
    s_add_u32 m0, s29, 65536
    s_add_u32 s31, s28, 589824
    buffer_load_dwordx4 v2, s[16:19], s31 offen lds
    buffer_load_dwordx4 v3, s[16:19], s31 offen offset:1024 lds
    s_cmp_eq_u32 s67, 3
    s_cbranch_scc0 Lue_724_g
    s_mov_b32 s53, s68
    s_load_dwordx2 s[60:61], s[0:1], 48
    s_load_dwordx2 s[62:63], s[0:1], 16
    s_cmp_lt_u32 s53, 72
    s_cselect_b32 s59, 1, 0
    s_movk_i32 s58, 1152
    s_cselect_b32 s58, 9216, s58
    s_sub_u32 s56, s53, 72
    s_mul_i32 s55, s56, 86
    s_lshr_b32 s55, s55, 8
    s_mul_i32 s57, s55, 3
    s_sub_u32 s57, s56, s57
    s_mul_i32 s56, s55, 288
    s_lshl_b32 s54, s57, 7
    s_add_u32 s56, s56, s54
    s_lshl_b32 s54, s53, 7
    s_cmp_lt_u32 s53, 72
    s_cselect_b32 s56, s54, s56
    s_waitcnt lgkmcnt(0)
    s_cmp_lt_u32 s53, 72
    s_cselect_b32 s36, s60, s62
    s_cselect_b32 s37, s61, s63
    s_mov_b32 s38, 663552
    s_cselect_b32 s38, 5308416, s38
    s_cmp_lt_u32 s53, 84
    s_cselect_b32 s38, s38, 0
    s_and_b32 s37, s37, 0xffff
    s_mov_b32 s39, 0x20000
    v_lshrrev_b32 v17, 3, v0
    v_and_b32 v18, 7, v0
    v_bfe_u32 v19, v0, 4, 1
    v_mul_u32_u24 v19, s59, v19
    v_lshlrev_b32 v19, 2, v19
    v_xor_b32 v18, v18, v19
    v_mul_lo_u32 v17, v17, s58
    v_lshlrev_b32 v18, 4, v18
    v_add_u32 v16, v17, v18
    s_mul_i32 s57, s8, 144
    s_mul_i32 s57, s57, s58
    s_mul_i32 s54, s8, 18432
    s_lshl_b32 s58, s58, 3
    s_add_u32 m0, s54, 73728
    s_add_u32 s55, s56, s57
    buffer_load_dwordx4 v16, s[36:39], s55 offen lds
    s_add_u32 m0, s54, 74752
    s_add_u32 s55, s55, s58
    buffer_load_dwordx4 v16, s[36:39], s55 offen lds
    s_add_u32 m0, s54, 75776
    s_add_u32 s55, s55, s58
    buffer_load_dwordx4 v16, s[36:39], s55 offen lds
    s_add_u32 m0, s54, 76800
    s_add_u32 s55, s55, s58
    buffer_load_dwordx4 v16, s[36:39], s55 offen lds
    s_add_u32 m0, s54, 77824
    s_add_u32 s55, s55, s58
    buffer_load_dwordx4 v16, s[36:39], s55 offen lds
    s_add_u32 m0, s54, 78848
    s_add_u32 s55, s55, s58
    buffer_load_dwordx4 v16, s[36:39], s55 offen lds
    s_add_u32 m0, s54, 79872
    s_add_u32 s55, s55, s58
    buffer_load_dwordx4 v16, s[36:39], s55 offen lds
    s_add_u32 m0, s54, 80896
    s_add_u32 s55, s55, s58
    buffer_load_dwordx4 v16, s[36:39], s55 offen lds
    s_add_u32 m0, s54, 81920
    s_add_u32 s55, s55, s58
    buffer_load_dwordx4 v16, s[36:39], s55 offen lds
    s_add_u32 m0, s54, 82944
    s_add_u32 s55, s55, s58
    buffer_load_dwordx4 v16, s[36:39], s55 offen lds
    s_add_u32 m0, s54, 83968
    s_add_u32 s55, s55, s58
    buffer_load_dwordx4 v16, s[36:39], s55 offen lds
    s_add_u32 m0, s54, 84992
    s_add_u32 s55, s55, s58
    buffer_load_dwordx4 v16, s[36:39], s55 offen lds
    s_add_u32 m0, s54, 86016
    s_add_u32 s55, s55, s58
    buffer_load_dwordx4 v16, s[36:39], s55 offen lds
    s_add_u32 m0, s54, 87040
    s_add_u32 s55, s55, s58
    buffer_load_dwordx4 v16, s[36:39], s55 offen lds
    s_add_u32 m0, s54, 88064
    s_add_u32 s55, s55, s58
    buffer_load_dwordx4 v16, s[36:39], s55 offen lds
    s_add_u32 m0, s54, 89088
    s_add_u32 s55, s55, s58
    buffer_load_dwordx4 v16, s[36:39], s55 offen lds
    s_add_u32 m0, s54, 90112
    s_add_u32 s55, s55, s58
    buffer_load_dwordx4 v16, s[36:39], s55 offen lds
    s_add_u32 m0, s54, 91136
    s_add_u32 s55, s55, s58
    buffer_load_dwordx4 v16, s[36:39], s55 offen lds
    s_waitcnt vmcnt(36)
    s_branch Lue_724_z
Lue_724_g:
    s_waitcnt vmcnt(18)
    s_branch Lue_724_z
Lue_724_r:
    s_mov_b32 s53, s68
    s_load_dwordx2 s[60:61], s[0:1], 48
    s_load_dwordx2 s[62:63], s[0:1], 16
    s_cmp_lt_u32 s53, 72
    s_cselect_b32 s59, 1, 0
    s_movk_i32 s58, 1152
    s_cselect_b32 s58, 9216, s58
    s_sub_u32 s56, s53, 72
    s_mul_i32 s55, s56, 86
    s_lshr_b32 s55, s55, 8
    s_mul_i32 s57, s55, 3
    s_sub_u32 s57, s56, s57
    s_mul_i32 s56, s55, 288
    s_lshl_b32 s54, s57, 7
    s_add_u32 s56, s56, s54
    s_lshl_b32 s54, s53, 7
    s_cmp_lt_u32 s53, 72
    s_cselect_b32 s56, s54, s56
    s_waitcnt lgkmcnt(0)
    s_cmp_lt_u32 s53, 72
    s_cselect_b32 s36, s60, s62
    s_cselect_b32 s37, s61, s63
    s_mov_b32 s38, 663552
    s_cselect_b32 s38, 5308416, s38
    s_cmp_lt_u32 s53, 84
    s_cselect_b32 s38, s38, 0
    s_and_b32 s37, s37, 0xffff
    s_mov_b32 s39, 0x20000
    v_lshrrev_b32 v17, 3, v0
    v_and_b32 v18, 7, v0
    v_bfe_u32 v19, v0, 4, 1
    v_mul_u32_u24 v19, s59, v19
    v_lshlrev_b32 v19, 2, v19
    v_xor_b32 v18, v18, v19
    v_mul_lo_u32 v17, v17, s58
    v_lshlrev_b32 v18, 4, v18
    v_add_u32 v16, v17, v18
    s_mul_i32 s57, s8, 144
    s_mul_i32 s57, s57, s58
    s_mul_i32 s54, s8, 18432
    s_lshl_b32 s58, s58, 3
    s_add_u32 m0, s54, 73728
    s_add_u32 s55, s56, s57
    buffer_load_dwordx4 v16, s[36:39], s55 offen lds
    s_add_u32 m0, s54, 74752
    s_add_u32 s55, s55, s58
    buffer_load_dwordx4 v16, s[36:39], s55 offen lds
    s_add_u32 m0, s54, 75776
    s_add_u32 s55, s55, s58
    buffer_load_dwordx4 v16, s[36:39], s55 offen lds
    s_add_u32 m0, s54, 76800
    s_add_u32 s55, s55, s58
    buffer_load_dwordx4 v16, s[36:39], s55 offen lds
    s_add_u32 m0, s54, 77824
    s_add_u32 s55, s55, s58
    buffer_load_dwordx4 v16, s[36:39], s55 offen lds
    s_add_u32 m0, s54, 78848
    s_add_u32 s55, s55, s58
    buffer_load_dwordx4 v16, s[36:39], s55 offen lds
    s_add_u32 m0, s54, 79872
    s_add_u32 s55, s55, s58
    buffer_load_dwordx4 v16, s[36:39], s55 offen lds
    s_add_u32 m0, s54, 80896
    s_add_u32 s55, s55, s58
    buffer_load_dwordx4 v16, s[36:39], s55 offen lds
    s_add_u32 m0, s54, 81920
    s_add_u32 s55, s55, s58
    buffer_load_dwordx4 v16, s[36:39], s55 offen lds
    s_add_u32 m0, s54, 82944
    s_add_u32 s55, s55, s58
    buffer_load_dwordx4 v16, s[36:39], s55 offen lds
    s_add_u32 m0, s54, 83968
    s_add_u32 s55, s55, s58
    buffer_load_dwordx4 v16, s[36:39], s55 offen lds
    s_add_u32 m0, s54, 84992
    s_add_u32 s55, s55, s58
    buffer_load_dwordx4 v16, s[36:39], s55 offen lds
    s_add_u32 m0, s54, 86016
    s_add_u32 s55, s55, s58
    buffer_load_dwordx4 v16, s[36:39], s55 offen lds
    s_add_u32 m0, s54, 87040
    s_add_u32 s55, s55, s58
    buffer_load_dwordx4 v16, s[36:39], s55 offen lds
    s_add_u32 m0, s54, 88064
    s_add_u32 s55, s55, s58
    buffer_load_dwordx4 v16, s[36:39], s55 offen lds
    s_add_u32 m0, s54, 89088
    s_add_u32 s55, s55, s58
    buffer_load_dwordx4 v16, s[36:39], s55 offen lds
    s_add_u32 m0, s54, 90112
    s_add_u32 s55, s55, s58
    buffer_load_dwordx4 v16, s[36:39], s55 offen lds
    s_add_u32 m0, s54, 91136
    s_add_u32 s55, s55, s58
    buffer_load_dwordx4 v16, s[36:39], s55 offen lds
    s_waitcnt vmcnt(18)
Lue_724_z:
    s_barrier
    s_cmp_eq_u32 s8, 0
    s_cbranch_scc0 Lp1_712_z
    s_mov_b32 s50, 0x40000
Lp1_712_b:
    v_readfirstlane_b32 s52, v249
    s_cmp_lg_u32 s52, 0
    s_cbranch_scc1 Lp1_712_c
    global_load_dword v249, v248, s[46:47] sc1
    s_waitcnt vmcnt(0)
    s_sub_u32 s50, s50, 1
    s_cmp_lg_u32 s50, 0
    s_cbranch_scc1 Lp1_712_b
Lp1_712_c:
    s_mov_b64 exec, 1
    v_mov_b32 v251, 1
    v_mov_b32 v250, s48
    global_atomic_add v250, v251, s[34:35] sc1
    s_mov_b64 exec, -1
Lp1_712_z:
    s_branch K_pre
L1_qk:
    s_mov_b32 s35, 0
    s_mov_b32 s38, 0
    s_add_u32 m0, s35, s31
    s_nop 0
    buffer_load_dwordx4 v2, s[16:19], s29 offen lds
    buffer_load_dwordx4 v3, s[16:19], s29 offen offset:1024 lds
    buffer_load_dwordx4 v4, s[16:19], s29 offen offset:2048 lds
    buffer_load_dwordx4 v5, s[16:19], s29 offen offset:3072 lds
    s_add_u32 s39, s39, 1
    s_cmp_eq_u32 s39, 9
    s_cselect_b32 s39, 0, s39
    s_cselect_b32 s69, 4294966272, s61
    s_add_u32 s29, s29, s69
    s_add_u32 s35, s35, 36864
    s_cmp_eq_u32 s35, 147456
    s_cselect_b32 s35, 0, s35
    s_add_u32 m0, s38, s36
    s_nop 0
    buffer_load_dwordx4 v6, s[20:23], s30 offen lds
    buffer_load_dwordx4 v7, s[20:23], s30 offen offset:1024 lds
    buffer_load_dwordx4 v8, s[20:23], s30 offen offset:2048 lds
    buffer_load_dwordx4 v9, s[20:23], s30 offen offset:3072 lds
    s_add_u32 m0, m0, 4096
    s_nop 0
    buffer_load_dwordx4 v10, s[20:23], s30 offen lds
    s_add_u32 s64, s64, 1
    s_cmp_eq_u32 s64, 9
    s_cselect_b32 s64, 0, s64
    s_cselect_b32 s69, s60, s34
    s_add_u32 s30, s30, s69
    s_add_u32 s38, s38, 36864
    s_cmp_eq_u32 s38, 147456
    s_cselect_b32 s38, 0, s38
    s_add_u32 m0, s35, s31
    s_nop 0
    buffer_load_dwordx4 v2, s[16:19], s29 offen lds
    buffer_load_dwordx4 v3, s[16:19], s29 offen offset:1024 lds
    buffer_load_dwordx4 v4, s[16:19], s29 offen offset:2048 lds
    buffer_load_dwordx4 v5, s[16:19], s29 offen offset:3072 lds
    s_add_u32 s39, s39, 1
    s_cmp_eq_u32 s39, 9
    s_cselect_b32 s39, 0, s39
    s_cselect_b32 s69, 4294966272, s61
    s_add_u32 s29, s29, s69
    s_add_u32 s35, s35, 36864
    s_cmp_eq_u32 s35, 147456
    s_cselect_b32 s35, 0, s35
    s_add_u32 m0, s38, s36
    s_nop 0
    buffer_load_dwordx4 v6, s[20:23], s30 offen lds
    buffer_load_dwordx4 v7, s[20:23], s30 offen offset:1024 lds
    buffer_load_dwordx4 v8, s[20:23], s30 offen offset:2048 lds
    buffer_load_dwordx4 v9, s[20:23], s30 offen offset:3072 lds
    s_add_u32 m0, m0, 4096
    s_nop 0
    buffer_load_dwordx4 v10, s[20:23], s30 offen lds
    s_add_u32 s64, s64, 1
    s_cmp_eq_u32 s64, 9
    s_cselect_b32 s64, 0, s64
    s_cselect_b32 s69, s60, s34
    s_add_u32 s30, s30, s69
    s_add_u32 s38, s38, 36864
    s_cmp_eq_u32 s38, 147456
    s_cselect_b32 s38, 0, s38
    s_add_u32 m0, s35, s31
    s_nop 0
    buffer_load_dwordx4 v2, s[16:19], s29 offen lds
    buffer_load_dwordx4 v3, s[16:19], s29 offen offset:1024 lds
    buffer_load_dwordx4 v4, s[16:19], s29 offen offset:2048 lds
    buffer_load_dwordx4 v5, s[16:19], s29 offen offset:3072 lds
    s_add_u32 s39, s39, 1
    s_cmp_eq_u32 s39, 9
    s_cselect_b32 s39, 0, s39
    s_cselect_b32 s69, 4294966272, s61
    s_add_u32 s29, s29, s69
    s_add_u32 s35, s35, 36864
    s_cmp_eq_u32 s35, 147456
    s_cselect_b32 s35, 0, s35
    v_lshrrev_b32 v21, 5, v0
    v_bfe_u32 v22, v0, 4, 1
    v_bfe_u32 v23, v0, 2, 2
    v_and_b32 v24, 3, v0
    v_and_b32 v25, 1, v0
    v_lshlrev_b32 v25, 1, v25
    v_bfe_u32 v26, v0, 1, 1
    v_or_b32 v25, v25, v26
    v_lshlrev_b32 v26, 3, v21
    v_add_u32 v26, v26, v23
    v_mul_u32_u24 v26, 320, v26
    v_add_u32 v26, 16384, v26
    v_lshlrev_b32 v27, 3, v25
    v_add_u32 v27, v27, v26
    v_mul_u32_u24 v28, 288, v22
    v_add_u32 v15, v27, v28
    v_lshlrev_b32 v28, 5, v22
    v_add_u32 v27, v27, v28
    v_add_u32 v16, 40, v27
    v_add_u32 v17, 112, v27
    v_add_u32 v18, 184, v27
    v_mul_u32_u24 v28, 72, v24
    v_add_u32 v28, v28, v26
    v_add_u32 v19, 32, v28
    v_mov_b32 v112, 0
    v_mov_b32 v113, 0
    v_mov_b32 v114, 0
    v_mov_b32 v115, 0
    s_nop 1
    v_mfma_f32_32x32x16_bf16 v[32:47], v[112:115], v[112:115], 0
    v_mfma_f32_32x32x16_bf16 v[48:63], v[112:115], v[112:115], 0
    v_mfma_f32_32x32x16_bf16 v[64:79], v[112:115], v[112:115], 0
    v_mfma_f32_32x32x16_bf16 v[80:95], v[112:115], v[112:115], 0
    v_mfma_f32_32x32x16_bf16 v[96:111], v[112:115], v[112:115], 0
    s_cmp_eq_u32 s3, 0
    s_cselect_b32 s41, 0x3eae1a93, 1.0
    s_mov_b32 s42, 2359296
    s_cselect_b32 s42, 0, s42
    s_mov_b32 s43, 4456448
    s_cselect_b32 s43, 2097152, s43
    s_mov_b32 s32, 0
    s_waitcnt vmcnt(13)
    s_barrier
    ds_read_b128 v[112:115], v11
    ds_read_b64_tr_b16 v[128:129], v15 offset:0
    ds_read_b64_tr_b16 v[130:131], v15 offset:1280
    ds_read_b64_tr_b16 v[132:133], v16 offset:0
    ds_read_b64_tr_b16 v[134:135], v16 offset:1280
    ds_read_b64_tr_b16 v[136:137], v17 offset:0
    ds_read_b64_tr_b16 v[138:139], v17 offset:1280
    ds_read_b64_tr_b16 v[140:141], v18 offset:0
    ds_read_b64_tr_b16 v[142:143], v18 offset:1280
    ds_read_b64_tr_b16 v[144:145], v19 offset:0
    ds_read_b64_tr_b16 v[146:147], v19 offset:1280
    ds_read_b128 v[116:119], v12
    ds_read_b64_tr_b16 v[148:149], v15 offset:5120
    ds_read_b64_tr_b16 v[150:151], v15 offset:6400
    ds_read_b64_tr_b16 v[152:153], v16 offset:5120
    ds_read_b64_tr_b16 v[154:155], v16 offset:6400
    ds_read_b64_tr_b16 v[156:157], v17 offset:5120
    ds_read_b64_tr_b16 v[158:159], v17 offset:6400
    ds_read_b64_tr_b16 v[160:161], v18 offset:5120
    ds_read_b64_tr_b16 v[162:163], v18 offset:6400
    ds_read_b64_tr_b16 v[164:165], v19 offset:5120
    ds_read_b64_tr_b16 v[166:167], v19 offset:6400
.p2align 6
L1_loop_qk:
    s_waitcnt lgkmcnt(11)
    v_mfma_f32_32x32x16_bf16 v[32:47], v[128:131], v[112:115], v[32:47]
    ds_read_b128 v[120:123], v13
    ds_read_b64_tr_b16 v[168:169], v15 offset:10240
    ds_read_b64_tr_b16 v[170:171], v15 offset:11520
    s_add_u32 m0, s38, s36
    s_nop 0
    buffer_load_dwordx4 v6, s[20:23], s30 offen lds
    v_mfma_f32_32x32x16_bf16 v[48:63], v[132:135], v[112:115], v[48:63]
    ds_read_b64_tr_b16 v[172:173], v16 offset:10240
    ds_read_b64_tr_b16 v[174:175], v16 offset:11520
    ds_read_b64_tr_b16 v[176:177], v17 offset:10240
    v_mfma_f32_32x32x16_bf16 v[64:79], v[136:139], v[112:115], v[64:79]
    ds_read_b64_tr_b16 v[178:179], v17 offset:11520
    ds_read_b64_tr_b16 v[180:181], v18 offset:10240
    ds_read_b64_tr_b16 v[182:183], v18 offset:11520
    buffer_load_dwordx4 v7, s[20:23], s30 offen offset:1024 lds
    v_mfma_f32_32x32x16_bf16 v[80:95], v[140:143], v[112:115], v[80:95]
    ds_read_b64_tr_b16 v[184:185], v19 offset:10240
    ds_read_b64_tr_b16 v[186:187], v19 offset:11520
    v_mfma_f32_32x32x16_bf16 v[96:111], v[144:147], v[112:115], v[96:111]
    buffer_load_dwordx4 v8, s[20:23], s30 offen offset:2048 lds
    s_waitcnt lgkmcnt(11)
    v_mfma_f32_32x32x16_bf16 v[32:47], v[148:151], v[116:119], v[32:47]
    ds_read_b128 v[124:127], v14
    ds_read_b64_tr_b16 v[188:189], v15 offset:15360
    ds_read_b64_tr_b16 v[190:191], v15 offset:16640
    v_mfma_f32_32x32x16_bf16 v[48:63], v[152:155], v[116:119], v[48:63]
    ds_read_b64_tr_b16 v[192:193], v16 offset:15360
    ds_read_b64_tr_b16 v[194:195], v16 offset:16640
    ds_read_b64_tr_b16 v[196:197], v17 offset:15360
    buffer_load_dwordx4 v9, s[20:23], s30 offen offset:3072 lds
    v_mfma_f32_32x32x16_bf16 v[64:79], v[156:159], v[116:119], v[64:79]
    ds_read_b64_tr_b16 v[198:199], v17 offset:16640
    ds_read_b64_tr_b16 v[200:201], v18 offset:15360
    ds_read_b64_tr_b16 v[202:203], v18 offset:16640
    v_mfma_f32_32x32x16_bf16 v[80:95], v[160:163], v[116:119], v[80:95]
    ds_read_b64_tr_b16 v[204:205], v19 offset:15360
    ds_read_b64_tr_b16 v[206:207], v19 offset:16640
    s_add_u32 m0, m0, 4096
    s_nop 0
    buffer_load_dwordx4 v10, s[20:23], s30 offen lds
    s_add_u32 s64, s64, 1
    s_cmp_eq_u32 s64, 9
    s_cselect_b32 s64, 0, s64
    s_cselect_b32 s69, s60, s34
    s_add_u32 s30, s30, s69
    s_add_u32 s38, s38, 36864
    s_cmp_eq_u32 s38, 147456
    s_cselect_b32 s38, 0, s38
    v_mfma_f32_32x32x16_bf16 v[96:111], v[164:167], v[116:119], v[96:111]
    s_add_u32 s37, s32, 1
    s_and_b32 s33, s37, 3
    s_cmp_eq_u32 s33, 0
    s_cselect_b32 s33, s68, s67
    v_add_u32 v11, s33, v11
    v_add_u32 v12, s33, v12
    v_add_u32 v13, s33, v13
    v_add_u32 v14, s33, v14
    v_add_u32 v15, s33, v15
    v_add_u32 v16, s33, v16
    v_add_u32 v17, s33, v17
    v_add_u32 v18, s33, v18
    v_add_u32 v19, s33, v19
    s_waitcnt lgkmcnt(11)
    v_mfma_f32_32x32x16_bf16 v[32:47], v[168:171], v[120:123], v[32:47]
    s_waitcnt vmcnt(9)
    s_barrier
    s_cmp_lt_u32 s32, 6
    s_cselect_b32 s29, s29, 0x40000000
    s_cselect_b32 s30, s30, 0x40000000
    ds_read_b128 v[112:115], v11
    ds_read_b64_tr_b16 v[128:129], v15 offset:0
    ds_read_b64_tr_b16 v[130:131], v15 offset:1280
    v_mfma_f32_32x32x16_bf16 v[48:63], v[172:175], v[120:123], v[48:63]
    ds_read_b64_tr_b16 v[132:133], v16 offset:0
    ds_read_b64_tr_b16 v[134:135], v16 offset:1280
    ds_read_b64_tr_b16 v[136:137], v17 offset:0
    v_mfma_f32_32x32x16_bf16 v[64:79], v[176:179], v[120:123], v[64:79]
    ds_read_b64_tr_b16 v[138:139], v17 offset:1280
    ds_read_b64_tr_b16 v[140:141], v18 offset:0
    ds_read_b64_tr_b16 v[142:143], v18 offset:1280
    s_add_u32 m0, s35, s31
    s_nop 0
    buffer_load_dwordx4 v2, s[16:19], s29 offen lds
    v_mfma_f32_32x32x16_bf16 v[80:95], v[180:183], v[120:123], v[80:95]
    ds_read_b64_tr_b16 v[144:145], v19 offset:0
    ds_read_b64_tr_b16 v[146:147], v19 offset:1280
    v_mfma_f32_32x32x16_bf16 v[96:111], v[184:187], v[120:123], v[96:111]
    buffer_load_dwordx4 v3, s[16:19], s29 offen offset:1024 lds
    s_waitcnt lgkmcnt(11)
    v_mfma_f32_32x32x16_bf16 v[32:47], v[188:191], v[124:127], v[32:47]
    ds_read_b128 v[116:119], v12
    ds_read_b64_tr_b16 v[148:149], v15 offset:5120
    ds_read_b64_tr_b16 v[150:151], v15 offset:6400
    v_mfma_f32_32x32x16_bf16 v[48:63], v[192:195], v[124:127], v[48:63]
    ds_read_b64_tr_b16 v[152:153], v16 offset:5120
    ds_read_b64_tr_b16 v[154:155], v16 offset:6400
    ds_read_b64_tr_b16 v[156:157], v17 offset:5120
    buffer_load_dwordx4 v4, s[16:19], s29 offen offset:2048 lds
    v_mfma_f32_32x32x16_bf16 v[64:79], v[196:199], v[124:127], v[64:79]
    ds_read_b64_tr_b16 v[158:159], v17 offset:6400
    ds_read_b64_tr_b16 v[160:161], v18 offset:5120
    ds_read_b64_tr_b16 v[162:163], v18 offset:6400
    v_mfma_f32_32x32x16_bf16 v[80:95], v[200:203], v[124:127], v[80:95]
    ds_read_b64_tr_b16 v[164:165], v19 offset:5120
    ds_read_b64_tr_b16 v[166:167], v19 offset:6400
    buffer_load_dwordx4 v5, s[16:19], s29 offen offset:3072 lds
    s_add_u32 s39, s39, 1
    s_cmp_eq_u32 s39, 9
    s_cselect_b32 s39, 0, s39
    s_cselect_b32 s69, 4294966272, s61
    s_add_u32 s29, s29, s69
    s_add_u32 s35, s35, 36864
    s_cmp_eq_u32 s35, 147456
    s_cselect_b32 s35, 0, s35
    v_mfma_f32_32x32x16_bf16 v[96:111], v[204:207], v[124:127], v[96:111]
    s_add_u32 s32, s32, 1
    s_cmp_lt_u32 s32, 9
    s_cbranch_scc1 L1_loop_qk
    s_waitcnt lgkmcnt(0)
    s_nop 7
    s_lshl_b32 s44, s9, 2
    s_add_u32 s44, s44, s8
    s_lshl_b32 s45, s11, 3
    s_lshl_b32 s46, s45, 16
    s_lshl_b32 s47, s44, 10
    s_add_u32 s46, s46, s47
    s_add_u32 s46, s46, s42
    v_mul_f32 v32, s41, v32
    v_mul_f32 v33, s41, v33
    v_mul_f32 v34, s41, v34
    v_mul_f32 v35, s41, v35
    v_mul_f32 v36, s41, v36
    v_mul_f32 v37, s41, v37
    v_mul_f32 v38, s41, v38
    v_mul_f32 v39, s41, v39
    v_mul_f32 v40, s41, v40
    v_mul_f32 v41, s41, v41
    v_mul_f32 v42, s41, v42
    v_mul_f32 v43, s41, v43
    v_mul_f32 v44, s41, v44
    v_mul_f32 v45, s41, v45
    v_mul_f32 v46, s41, v46
    v_mul_f32 v47, s41, v47
    v_cvt_pk_bf16_f32 v112, v32, v33
    v_cvt_pk_bf16_f32 v113, v34, v35
    v_cvt_pk_bf16_f32 v114, v36, v37
    v_cvt_pk_bf16_f32 v115, v38, v39
    s_add_u32 s47, s46, 0
    buffer_store_dwordx4 v[112:115], v1, s[12:15], s47 offen sc1
    v_cvt_pk_bf16_f32 v116, v40, v41
    v_cvt_pk_bf16_f32 v117, v42, v43
    v_cvt_pk_bf16_f32 v118, v44, v45
    v_cvt_pk_bf16_f32 v119, v46, v47
    s_add_u32 s47, s46, 458752
    buffer_store_dwordx4 v[116:119], v1, s[12:15], s47 offen sc1
    v_mul_f32 v48, s41, v48
    v_mul_f32 v49, s41, v49
    v_mul_f32 v50, s41, v50
    v_mul_f32 v51, s41, v51
    v_mul_f32 v52, s41, v52
    v_mul_f32 v53, s41, v53
    v_mul_f32 v54, s41, v54
    v_mul_f32 v55, s41, v55
    v_mul_f32 v56, s41, v56
    v_mul_f32 v57, s41, v57
    v_mul_f32 v58, s41, v58
    v_mul_f32 v59, s41, v59
    v_mul_f32 v60, s41, v60
    v_mul_f32 v61, s41, v61
    v_mul_f32 v62, s41, v62
    v_mul_f32 v63, s41, v63
    v_cvt_pk_bf16_f32 v120, v48, v49
    v_cvt_pk_bf16_f32 v121, v50, v51
    v_cvt_pk_bf16_f32 v122, v52, v53
    v_cvt_pk_bf16_f32 v123, v54, v55
    s_add_u32 s47, s46, 65536
    buffer_store_dwordx4 v[120:123], v1, s[12:15], s47 offen sc1
    v_cvt_pk_bf16_f32 v124, v56, v57
    v_cvt_pk_bf16_f32 v125, v58, v59
    v_cvt_pk_bf16_f32 v126, v60, v61
    v_cvt_pk_bf16_f32 v127, v62, v63
    s_add_u32 s47, s46, 131072
    buffer_store_dwordx4 v[124:127], v1, s[12:15], s47 offen sc1
    v_mul_f32 v64, s41, v64
    v_mul_f32 v65, s41, v65
    v_mul_f32 v66, s41, v66
    v_mul_f32 v67, s41, v67
    v_mul_f32 v68, s41, v68
    v_mul_f32 v69, s41, v69
    v_mul_f32 v70, s41, v70
    v_mul_f32 v71, s41, v71
    v_mul_f32 v72, s41, v72
    v_mul_f32 v73, s41, v73
    v_mul_f32 v74, s41, v74
    v_mul_f32 v75, s41, v75
    v_mul_f32 v76, s41, v76
    v_mul_f32 v77, s41, v77
    v_mul_f32 v78, s41, v78
    v_mul_f32 v79, s41, v79
    v_cvt_pk_bf16_f32 v112, v64, v65
    v_cvt_pk_bf16_f32 v113, v66, v67
    v_cvt_pk_bf16_f32 v114, v68, v69
    v_cvt_pk_bf16_f32 v115, v70, v71
    s_add_u32 s47, s46, 196608
    buffer_store_dwordx4 v[112:115], v1, s[12:15], s47 offen sc1
    v_cvt_pk_bf16_f32 v116, v72, v73
    v_cvt_pk_bf16_f32 v117, v74, v75
    v_cvt_pk_bf16_f32 v118, v76, v77
    v_cvt_pk_bf16_f32 v119, v78, v79
    s_add_u32 s47, s46, 262144
    buffer_store_dwordx4 v[116:119], v1, s[12:15], s47 offen sc1
    v_mul_f32 v80, s41, v80
    v_mul_f32 v81, s41, v81
    v_mul_f32 v82, s41, v82
    v_mul_f32 v83, s41, v83
    v_mul_f32 v84, s41, v84
    v_mul_f32 v85, s41, v85
    v_mul_f32 v86, s41, v86
    v_mul_f32 v87, s41, v87
    v_mul_f32 v88, s41, v88
    v_mul_f32 v89, s41, v89
    v_mul_f32 v90, s41, v90
    v_mul_f32 v91, s41, v91
    v_mul_f32 v92, s41, v92
    v_mul_f32 v93, s41, v93
    v_mul_f32 v94, s41, v94
    v_mul_f32 v95, s41, v95
    v_cvt_pk_bf16_f32 v120, v80, v81
    v_cvt_pk_bf16_f32 v121, v82, v83
    v_cvt_pk_bf16_f32 v122, v84, v85
    v_cvt_pk_bf16_f32 v123, v86, v87
    s_add_u32 s47, s46, 327680
    buffer_store_dwordx4 v[120:123], v1, s[12:15], s47 offen sc1
    v_cvt_pk_bf16_f32 v124, v88, v89
    v_cvt_pk_bf16_f32 v125, v90, v91
    v_cvt_pk_bf16_f32 v126, v92, v93
    v_cvt_pk_bf16_f32 v127, v94, v95
    s_add_u32 s47, s46, 393216
    buffer_store_dwordx4 v[124:127], v1, s[12:15], s47 offen sc1
    v_mul_f32 v96, s41, v96
    v_mul_f32 v97, s41, v97
    v_mul_f32 v98, s41, v98
    v_mul_f32 v99, s41, v99
    v_mul_f32 v100, s41, v100
    v_mul_f32 v101, s41, v101
    v_mul_f32 v102, s41, v102
    v_mul_f32 v103, s41, v103
    v_cvt_pk_bf16_f32 v128, v96, v97
    v_cvt_pk_bf16_f32 v129, v98, v99
    v_cvt_pk_bf16_f32 v130, v100, v101
    v_cvt_pk_bf16_f32 v131, v102, v103
    v_and_b32 v21, 31, v0
    v_lshlrev_b32 v21, 2, v21
    v_lshrrev_b32 v29, 5, v0
    v_lshlrev_b32 v29, 14, v29
    v_add_u32 v21, v21, v29
    s_lshl_b32 s46, s45, 13
    s_lshl_b32 s47, s44, 7
    s_add_u32 s46, s46, s47
    s_add_u32 s46, s46, s43
    s_add_u32 s47, s46, 0
    buffer_store_dword v128, v21, s[12:15], s47 offen sc1
    s_add_u32 s47, s46, 8192
    buffer_store_dword v129, v21, s[12:15], s47 offen sc1
    s_add_u32 s47, s46, 32768
    buffer_store_dword v130, v21, s[12:15], s47 offen sc1
    s_add_u32 s47, s46, 40960
    buffer_store_dword v131, v21, s[12:15], s47 offen sc1
    s_mul_i32 s48, s11, 128
    s_add_u32 s48, s48, 5760
    s_mov_b64 exec, -1
    s_load_dwordx2 s[46:47], s[0:1], 80
    s_add_u32 s34, s4, 39608320
    s_addc_u32 s35, s5, 0
    v_mov_b32 v248, 0
    v_mov_b32 v249, 0
    s_waitcnt vmcnt(12) lgkmcnt(0)
    s_barrier
    s_cmp_eq_u32 s8, 0
    s_cbranch_scc0 Lp1_1477_a
    global_load_dword v249, v248, s[46:47] sc1
Lp1_1477_a:
    s_mov_b32 s67, 1
    s_movk_i32 s68, 84
    s_mov_b32 s66, 0
    s_cmp_lt_u32 s7, 16
    s_cbranch_scc0 Lus_1489_a
    s_lshr_b32 s64, s7, 3
    s_lshl_b32 s65, s6, 1
    s_add_u32 s64, s64, s65
    s_and_b32 s65, s7, 7
    s_cmp_ge_u32 s7, 8
    s_cbranch_scc0 Lus_1489_z
    s_sub_u32 s68, s7, 8
    s_lshl_b32 s68, s68, 3
    s_add_u32 s68, s68, s6
    s_cmp_lt_u32 s68, 36
    s_cbranch_scc0 Lus_1489_z
    s_mov_b32 s67, 3
    s_cmp_lt_u32 s68, 24
    s_cbranch_scc0 Lus_1489_w
    s_mul_i32 s66, s68, 86
    s_lshr_b32 s66, s66, 8
    s_mul_i32 s69, s66, 6
    s_add_u32 s68, s68, s69
    s_add_u32 s68, s68, 6
    s_mul_i32 s66, s66, 128
    s_add_u32 s66, s66, 8320
    s_branch Lus_1489_z
Lus_1489_w:
    s_add_u32 s68, s68, 48
    s_movk_i32 s66, 3072
    s_branch Lus_1489_z
Lus_1489_a:
    s_cmp_lt_u32 s7, 24
    s_cbranch_scc1 Lus_1489_v
    s_mov_b32 s67, 0
    s_branch Lus_1489_z
Lus_1489_v:
    s_sub_u32 s68, s7, 16
    s_lshl_b32 s68, s68, 3
    s_add_u32 s68, s68, s6
    s_cmp_lt_u32 s68, 16
    s_cbranch_scc0 Lus_1489_b
    s_lshr_b32 s64, s68, 3
    s_lshl_b32 s65, s6, 1
    s_add_u32 s64, s64, s65
    s_mov_b32 s65, 8
    s_branch Lus_1489_z
Lus_1489_b:
    s_mov_b32 s67, 2
    s_sub_u32 s68, s68, 16
    s_mul_i32 s64, s68, 43
    s_lshr_b32 s64, s64, 8
    s_mul_i32 s65, s64, 3
    s_add_u32 s68, s68, s65
    s_mul_i32 s66, s64, 128
    s_add_u32 s66, s66, 2048
Lus_1489_z:
    s_cmp_eq_u32 s67, 2
    s_cbranch_scc1 Lue_1489_r
    s_load_dwordx2 s[24:25], s[0:1], 40
    v_lshrrev_b32 v5, 3, v0
    v_and_b32 v6, 7, v0
    v_bfe_u32 v7, v0, 4, 1
    v_lshlrev_b32 v7, 2, v7
    v_xor_b32 v6, v6, v7
    v_mul_u32_u24 v5, 1152, v5
    v_lshlrev_b32 v6, 4, v6
    v_add_u32 v2, v5, v6
    v_add_u32 v3, 8192, v2
    s_waitcnt lgkmcnt(0)
    s_mov_b32 s16, s24
    s_and_b32 s17, s25, 0xffff
    s_mov_b32 s18, 663552
    s_mov_b32 s19, 0x20000
    s_mul_i32 s28, s8, 18432
    s_lshl_b32 s29, s65, 7
    s_add_u32 s28, s28, s29
    s_mul_i32 s29, s8, 2048
    s_add_u32 m0, s29, 0
    s_add_u32 s31, s28, 0
    buffer_load_dwordx4 v2, s[16:19], s31 offen lds
    buffer_load_dwordx4 v3, s[16:19], s31 offen offset:1024 lds
    s_add_u32 m0, s29, 8192
    s_add_u32 s31, s28, 73728
    buffer_load_dwordx4 v2, s[16:19], s31 offen lds
    buffer_load_dwordx4 v3, s[16:19], s31 offen offset:1024 lds
    s_add_u32 m0, s29, 16384
    s_add_u32 s31, s28, 147456
    buffer_load_dwordx4 v2, s[16:19], s31 offen lds
    buffer_load_dwordx4 v3, s[16:19], s31 offen offset:1024 lds
    s_add_u32 m0, s29, 24576
    s_add_u32 s31, s28, 221184
    buffer_load_dwordx4 v2, s[16:19], s31 offen lds
    buffer_load_dwordx4 v3, s[16:19], s31 offen offset:1024 lds
    s_add_u32 m0, s29, 32768
    s_add_u32 s31, s28, 294912
    buffer_load_dwordx4 v2, s[16:19], s31 offen lds
    buffer_load_dwordx4 v3, s[16:19], s31 offen offset:1024 lds
    s_add_u32 m0, s29, 40960
    s_add_u32 s31, s28, 368640
    buffer_load_dwordx4 v2, s[16:19], s31 offen lds
    buffer_load_dwordx4 v3, s[16:19], s31 offen offset:1024 lds
    s_add_u32 m0, s29, 49152
    s_add_u32 s31, s28, 442368
    buffer_load_dwordx4 v2, s[16:19], s31 offen lds
    buffer_load_dwordx4 v3, s[16:19], s31 offen offset:1024 lds
    s_add_u32 m0, s29, 57344
    s_add_u32 s31, s28, 516096
    buffer_load_dwordx4 v2, s[16:19], s31 offen lds
    buffer_load_dwordx4 v3, s[16:19], s31 offen offset:1024 lds
    s_add_u32 m0, s29, 65536
    s_add_u32 s31, s28, 589824
    buffer_load_dwordx4 v2, s[16:19], s31 offen lds
    buffer_load_dwordx4 v3, s[16:19], s31 offen offset:1024 lds
    s_cmp_eq_u32 s67, 3
    s_cbranch_scc0 Lue_1489_g
    s_mov_b32 s53, s68
    s_load_dwordx2 s[60:61], s[0:1], 48
    s_load_dwordx2 s[62:63], s[0:1], 16
    s_cmp_lt_u32 s53, 72
    s_cselect_b32 s59, 1, 0
    s_movk_i32 s58, 1152
    s_cselect_b32 s58, 9216, s58
    s_sub_u32 s56, s53, 72
    s_mul_i32 s55, s56, 86
    s_lshr_b32 s55, s55, 8
    s_mul_i32 s57, s55, 3
    s_sub_u32 s57, s56, s57
    s_mul_i32 s56, s55, 288
    s_lshl_b32 s54, s57, 7
    s_add_u32 s56, s56, s54
    s_lshl_b32 s54, s53, 7
    s_cmp_lt_u32 s53, 72
    s_cselect_b32 s56, s54, s56
    s_waitcnt lgkmcnt(0)
    s_cmp_lt_u32 s53, 72
    s_cselect_b32 s36, s60, s62
    s_cselect_b32 s37, s61, s63
    s_mov_b32 s38, 663552
    s_cselect_b32 s38, 5308416, s38
    s_cmp_lt_u32 s53, 84
    s_cselect_b32 s38, s38, 0
    s_and_b32 s37, s37, 0xffff
    s_mov_b32 s39, 0x20000
    v_lshrrev_b32 v17, 3, v0
    v_and_b32 v18, 7, v0
    v_bfe_u32 v19, v0, 4, 1
    v_mul_u32_u24 v19, s59, v19
    v_lshlrev_b32 v19, 2, v19
    v_xor_b32 v18, v18, v19
    v_mul_lo_u32 v17, v17, s58
    v_lshlrev_b32 v18, 4, v18
    v_add_u32 v16, v17, v18
    s_mul_i32 s57, s8, 144
    s_mul_i32 s57, s57, s58
    s_mul_i32 s54, s8, 18432
    s_lshl_b32 s58, s58, 3
    s_add_u32 m0, s54, 73728
    s_add_u32 s55, s56, s57
    buffer_load_dwordx4 v16, s[36:39], s55 offen lds
    s_add_u32 m0, s54, 74752
    s_add_u32 s55, s55, s58
    buffer_load_dwordx4 v16, s[36:39], s55 offen lds
    s_add_u32 m0, s54, 75776
    s_add_u32 s55, s55, s58
    buffer_load_dwordx4 v16, s[36:39], s55 offen lds
    s_add_u32 m0, s54, 76800
    s_add_u32 s55, s55, s58
    buffer_load_dwordx4 v16, s[36:39], s55 offen lds
    s_add_u32 m0, s54, 77824
    s_add_u32 s55, s55, s58
    buffer_load_dwordx4 v16, s[36:39], s55 offen lds
    s_add_u32 m0, s54, 78848
    s_add_u32 s55, s55, s58
    buffer_load_dwordx4 v16, s[36:39], s55 offen lds
    s_add_u32 m0, s54, 79872
    s_add_u32 s55, s55, s58
    buffer_load_dwordx4 v16, s[36:39], s55 offen lds
    s_add_u32 m0, s54, 80896
    s_add_u32 s55, s55, s58
    buffer_load_dwordx4 v16, s[36:39], s55 offen lds
    s_add_u32 m0, s54, 81920
    s_add_u32 s55, s55, s58
    buffer_load_dwordx4 v16, s[36:39], s55 offen lds
    s_add_u32 m0, s54, 82944
    s_add_u32 s55, s55, s58
    buffer_load_dwordx4 v16, s[36:39], s55 offen lds
    s_add_u32 m0, s54, 83968
    s_add_u32 s55, s55, s58
    buffer_load_dwordx4 v16, s[36:39], s55 offen lds
    s_add_u32 m0, s54, 84992
    s_add_u32 s55, s55, s58
    buffer_load_dwordx4 v16, s[36:39], s55 offen lds
    s_add_u32 m0, s54, 86016
    s_add_u32 s55, s55, s58
    buffer_load_dwordx4 v16, s[36:39], s55 offen lds
    s_add_u32 m0, s54, 87040
    s_add_u32 s55, s55, s58
    buffer_load_dwordx4 v16, s[36:39], s55 offen lds
    s_add_u32 m0, s54, 88064
    s_add_u32 s55, s55, s58
    buffer_load_dwordx4 v16, s[36:39], s55 offen lds
    s_add_u32 m0, s54, 89088
    s_add_u32 s55, s55, s58
    buffer_load_dwordx4 v16, s[36:39], s55 offen lds
    s_add_u32 m0, s54, 90112
    s_add_u32 s55, s55, s58
    buffer_load_dwordx4 v16, s[36:39], s55 offen lds
    s_add_u32 m0, s54, 91136
    s_add_u32 s55, s55, s58
    buffer_load_dwordx4 v16, s[36:39], s55 offen lds
    s_waitcnt vmcnt(36)
    s_branch Lue_1489_z
Lue_1489_g:
    s_waitcnt vmcnt(18)
    s_branch Lue_1489_z
Lue_1489_r:
    s_mov_b32 s53, s68
    s_load_dwordx2 s[60:61], s[0:1], 48
    s_load_dwordx2 s[62:63], s[0:1], 16
    s_cmp_lt_u32 s53, 72
    s_cselect_b32 s59, 1, 0
    s_movk_i32 s58, 1152
    s_cselect_b32 s58, 9216, s58
    s_sub_u32 s56, s53, 72
    s_mul_i32 s55, s56, 86
    s_lshr_b32 s55, s55, 8
    s_mul_i32 s57, s55, 3
    s_sub_u32 s57, s56, s57
    s_mul_i32 s56, s55, 288
    s_lshl_b32 s54, s57, 7
    s_add_u32 s56, s56, s54
    s_lshl_b32 s54, s53, 7
    s_cmp_lt_u32 s53, 72
    s_cselect_b32 s56, s54, s56
    s_waitcnt lgkmcnt(0)
    s_cmp_lt_u32 s53, 72
    s_cselect_b32 s36, s60, s62
    s_cselect_b32 s37, s61, s63
    s_mov_b32 s38, 663552
    s_cselect_b32 s38, 5308416, s38
    s_cmp_lt_u32 s53, 84
    s_cselect_b32 s38, s38, 0
    s_and_b32 s37, s37, 0xffff
    s_mov_b32 s39, 0x20000
    v_lshrrev_b32 v17, 3, v0
    v_and_b32 v18, 7, v0
    v_bfe_u32 v19, v0, 4, 1
    v_mul_u32_u24 v19, s59, v19
    v_lshlrev_b32 v19, 2, v19
    v_xor_b32 v18, v18, v19
    v_mul_lo_u32 v17, v17, s58
    v_lshlrev_b32 v18, 4, v18
    v_add_u32 v16, v17, v18
    s_mul_i32 s57, s8, 144
    s_mul_i32 s57, s57, s58
    s_mul_i32 s54, s8, 18432
    s_lshl_b32 s58, s58, 3
    s_add_u32 m0, s54, 73728
    s_add_u32 s55, s56, s57
    buffer_load_dwordx4 v16, s[36:39], s55 offen lds
    s_add_u32 m0, s54, 74752
    s_add_u32 s55, s55, s58
    buffer_load_dwordx4 v16, s[36:39], s55 offen lds
    s_add_u32 m0, s54, 75776
    s_add_u32 s55, s55, s58
    buffer_load_dwordx4 v16, s[36:39], s55 offen lds
    s_add_u32 m0, s54, 76800
    s_add_u32 s55, s55, s58
    buffer_load_dwordx4 v16, s[36:39], s55 offen lds
    s_add_u32 m0, s54, 77824
    s_add_u32 s55, s55, s58
    buffer_load_dwordx4 v16, s[36:39], s55 offen lds
    s_add_u32 m0, s54, 78848
    s_add_u32 s55, s55, s58
    buffer_load_dwordx4 v16, s[36:39], s55 offen lds
    s_add_u32 m0, s54, 79872
    s_add_u32 s55, s55, s58
    buffer_load_dwordx4 v16, s[36:39], s55 offen lds
    s_add_u32 m0, s54, 80896
    s_add_u32 s55, s55, s58
    buffer_load_dwordx4 v16, s[36:39], s55 offen lds
    s_add_u32 m0, s54, 81920
    s_add_u32 s55, s55, s58
    buffer_load_dwordx4 v16, s[36:39], s55 offen lds
    s_add_u32 m0, s54, 82944
    s_add_u32 s55, s55, s58
    buffer_load_dwordx4 v16, s[36:39], s55 offen lds
    s_add_u32 m0, s54, 83968
    s_add_u32 s55, s55, s58
    buffer_load_dwordx4 v16, s[36:39], s55 offen lds
    s_add_u32 m0, s54, 84992
    s_add_u32 s55, s55, s58
    buffer_load_dwordx4 v16, s[36:39], s55 offen lds
    s_add_u32 m0, s54, 86016
    s_add_u32 s55, s55, s58
    buffer_load_dwordx4 v16, s[36:39], s55 offen lds
    s_add_u32 m0, s54, 87040
    s_add_u32 s55, s55, s58
    buffer_load_dwordx4 v16, s[36:39], s55 offen lds
    s_add_u32 m0, s54, 88064
    s_add_u32 s55, s55, s58
    buffer_load_dwordx4 v16, s[36:39], s55 offen lds
    s_add_u32 m0, s54, 89088
    s_add_u32 s55, s55, s58
    buffer_load_dwordx4 v16, s[36:39], s55 offen lds
    s_add_u32 m0, s54, 90112
    s_add_u32 s55, s55, s58
    buffer_load_dwordx4 v16, s[36:39], s55 offen lds
    s_add_u32 m0, s54, 91136
    s_add_u32 s55, s55, s58
    buffer_load_dwordx4 v16, s[36:39], s55 offen lds
    s_waitcnt vmcnt(18)
Lue_1489_z:
    s_barrier
    s_cmp_eq_u32 s8, 0
    s_cbranch_scc0 Lp1_1477_z
    s_mov_b32 s50, 0x40000
Lp1_1477_b:
    v_readfirstlane_b32 s52, v249
    s_cmp_lg_u32 s52, 0
    s_cbranch_scc1 Lp1_1477_c
    global_load_dword v249, v248, s[46:47] sc1
    s_waitcnt vmcnt(0)
    s_sub_u32 s50, s50, 1
    s_cmp_lg_u32 s50, 0
    s_cbranch_scc1 Lp1_1477_b
Lp1_1477_c:
    s_mov_b64 exec, 1
    v_mov_b32 v251, 1
    v_mov_b32 v250, s48
    global_atomic_add v250, v251, s[34:35] sc1
    s_mov_b64 exec, -1
Lp1_1477_z:
    s_branch K_pre
L1_v:
    s_mov_b32 s35, 0
    s_mov_b32 s38, 0
    s_add_u32 m0, s35, s31
    s_nop 0
    buffer_load_dwordx4 v2, s[16:19], s29 offen lds
    buffer_load_dwordx4 v3, s[16:19], s29 offen offset:1024 lds
    buffer_load_dwordx4 v4, s[16:19], s29 offen offset:2048 lds
    buffer_load_dwordx4 v5, s[16:19], s29 offen offset:3072 lds
    s_add_u32 s39, s39, 1
    s_cmp_eq_u32 s39, 9
    s_cselect_b32 s39, 0, s39
    s_cselect_b32 s69, 4294966272, s61
    s_add_u32 s29, s29, s69
    s_add_u32 s35, s35, 36864
    s_cmp_eq_u32 s35, 147456
    s_cselect_b32 s35, 0, s35
    s_add_u32 m0, s38, s36
    s_nop 0
    buffer_load_dwordx4 v6, s[20:23], s30 offen lds
    buffer_load_dwordx4 v7, s[20:23], s30 offen offset:1024 lds
    buffer_load_dwordx4 v8, s[20:23], s30 offen offset:2048 lds
    buffer_load_dwordx4 v9, s[20:23], s30 offen offset:3072 lds
    s_add_u32 m0, m0, 4096
    s_nop 0
    buffer_load_dwordx4 v10, s[20:23], s30 offen lds
    s_add_u32 s64, s64, 1
    s_cmp_eq_u32 s64, 9
    s_cselect_b32 s64, 0, s64
    s_cselect_b32 s69, s60, s34
    s_add_u32 s30, s30, s69
    s_add_u32 s38, s38, 36864
    s_cmp_eq_u32 s38, 147456
    s_cselect_b32 s38, 0, s38
    s_add_u32 m0, s35, s31
    s_nop 0
    buffer_load_dwordx4 v2, s[16:19], s29 offen lds
    buffer_load_dwordx4 v3, s[16:19], s29 offen offset:1024 lds
    buffer_load_dwordx4 v4, s[16:19], s29 offen offset:2048 lds
    buffer_load_dwordx4 v5, s[16:19], s29 offen offset:3072 lds
    s_add_u32 s39, s39, 1
    s_cmp_eq_u32 s39, 9
    s_cselect_b32 s39, 0, s39
    s_cselect_b32 s69, 4294966272, s61
    s_add_u32 s29, s29, s69
    s_add_u32 s35, s35, 36864
    s_cmp_eq_u32 s35, 147456
    s_cselect_b32 s35, 0, s35
    s_add_u32 m0, s38, s36
    s_nop 0
    buffer_load_dwordx4 v6, s[20:23], s30 offen lds
    buffer_load_dwordx4 v7, s[20:23], s30 offen offset:1024 lds
    buffer_load_dwordx4 v8, s[20:23], s30 offen offset:2048 lds
    buffer_load_dwordx4 v9, s[20:23], s30 offen offset:3072 lds
    s_add_u32 m0, m0, 4096
    s_nop 0
    buffer_load_dwordx4 v10, s[20:23], s30 offen lds
    s_add_u32 s64, s64, 1
    s_cmp_eq_u32 s64, 9
    s_cselect_b32 s64, 0, s64
    s_cselect_b32 s69, s60, s34
    s_add_u32 s30, s30, s69
    s_add_u32 s38, s38, 36864
    s_cmp_eq_u32 s38, 147456
    s_cselect_b32 s38, 0, s38
    s_add_u32 m0, s35, s31
    s_nop 0
    buffer_load_dwordx4 v2, s[16:19], s29 offen lds
    buffer_load_dwordx4 v3, s[16:19], s29 offen offset:1024 lds
    buffer_load_dwordx4 v4, s[16:19], s29 offen offset:2048 lds
    buffer_load_dwordx4 v5, s[16:19], s29 offen offset:3072 lds
    s_add_u32 s39, s39, 1
    s_cmp_eq_u32 s39, 9
    s_cselect_b32 s39, 0, s39
    s_cselect_b32 s69, 4294966272, s61
    s_add_u32 s29, s29, s69
    s_add_u32 s35, s35, 36864
    s_cmp_eq_u32 s35, 147456
    s_cselect_b32 s35, 0, s35
    v_lshrrev_b32 v21, 5, v0
    v_bfe_u32 v22, v0, 4, 1
    v_bfe_u32 v23, v0, 2, 2
    v_and_b32 v24, 3, v0
    v_and_b32 v25, 1, v0
    v_lshlrev_b32 v25, 1, v25
    v_bfe_u32 v26, v0, 1, 1
    v_or_b32 v25, v25, v26
    v_lshlrev_b32 v26, 3, v21
    v_add_u32 v26, v26, v23
    v_mul_u32_u24 v26, 320, v26
    v_add_u32 v26, 16384, v26
    v_lshlrev_b32 v27, 3, v24
    v_add_u32 v27, v27, v26
    v_mul_u32_u24 v28, 288, v22
    v_add_u32 v15, v27, v28
    v_lshlrev_b32 v28, 5, v22
    v_add_u32 v27, v27, v28
    v_add_u32 v16, 40, v27
    v_add_u32 v17, 112, v27
    v_add_u32 v18, 184, v27
    v_mul_u32_u24 v28, 72, v24
    v_add_u32 v28, v28, v26
    v_add_u32 v19, 32, v28
    v_mov_b32 v112, 0
    v_mov_b32 v113, 0
    v_mov_b32 v114, 0
    v_mov_b32 v115, 0
    s_nop 1
    v_mfma_f32_32x32x16_bf16 v[32:47], v[112:115], v[112:115], 0
    v_mfma_f32_32x32x16_bf16 v[48:63], v[112:115], v[112:115], 0
    v_mfma_f32_32x32x16_bf16 v[64:79], v[112:115], v[112:115], 0
    v_mfma_f32_32x32x16_bf16 v[80:95], v[112:115], v[112:115], 0
    v_mfma_f32_32x32x16_bf16 v[96:111], v[112:115], v[112:115], 0
    s_mov_b32 s32, 0
    s_waitcnt vmcnt(13)
    s_barrier
    ds_read_b128 v[112:115], v11
    ds_read_b64_tr_b16 v[128:129], v15 offset:0
    ds_read_b64_tr_b16 v[130:131], v15 offset:1280
    ds_read_b64_tr_b16 v[132:133], v16 offset:0
    ds_read_b64_tr_b16 v[134:135], v16 offset:1280
    ds_read_b64_tr_b16 v[136:137], v17 offset:0
    ds_read_b64_tr_b16 v[138:139], v17 offset:1280
    ds_read_b64_tr_b16 v[140:141], v18 offset:0
    ds_read_b64_tr_b16 v[142:143], v18 offset:1280
    ds_read_b64_tr_b16 v[144:145], v19 offset:0
    ds_read_b64_tr_b16 v[146:147], v19 offset:1280
    ds_read_b128 v[116:119], v12
    ds_read_b64_tr_b16 v[148:149], v15 offset:5120
    ds_read_b64_tr_b16 v[150:151], v15 offset:6400
    ds_read_b64_tr_b16 v[152:153], v16 offset:5120
    ds_read_b64_tr_b16 v[154:155], v16 offset:6400
    ds_read_b64_tr_b16 v[156:157], v17 offset:5120
    ds_read_b64_tr_b16 v[158:159], v17 offset:6400
    ds_read_b64_tr_b16 v[160:161], v18 offset:5120
    ds_read_b64_tr_b16 v[162:163], v18 offset:6400
    ds_read_b64_tr_b16 v[164:165], v19 offset:5120
    ds_read_b64_tr_b16 v[166:167], v19 offset:6400
.p2align 6
L1_loop_v:
    s_waitcnt lgkmcnt(11)
    v_mfma_f32_32x32x16_bf16 v[32:47], v[112:115], v[128:131], v[32:47]
    ds_read_b128 v[120:123], v13
    ds_read_b64_tr_b16 v[168:169], v15 offset:10240
    ds_read_b64_tr_b16 v[170:171], v15 offset:11520
    s_add_u32 m0, s38, s36
    s_nop 0
    buffer_load_dwordx4 v6, s[20:23], s30 offen lds
    v_mfma_f32_32x32x16_bf16 v[48:63], v[112:115], v[132:135], v[48:63]
    ds_read_b64_tr_b16 v[172:173], v16 offset:10240
    ds_read_b64_tr_b16 v[174:175], v16 offset:11520
    ds_read_b64_tr_b16 v[176:177], v17 offset:10240
    v_mfma_f32_32x32x16_bf16 v[64:79], v[112:115], v[136:139], v[64:79]
    ds_read_b64_tr_b16 v[178:179], v17 offset:11520
    ds_read_b64_tr_b16 v[180:181], v18 offset:10240
    ds_read_b64_tr_b16 v[182:183], v18 offset:11520
    buffer_load_dwordx4 v7, s[20:23], s30 offen offset:1024 lds
    v_mfma_f32_32x32x16_bf16 v[80:95], v[112:115], v[140:143], v[80:95]
    ds_read_b64_tr_b16 v[184:185], v19 offset:10240
    ds_read_b64_tr_b16 v[186:187], v19 offset:11520
    v_mfma_f32_32x32x16_bf16 v[96:111], v[112:115], v[144:147], v[96:111]
    buffer_load_dwordx4 v8, s[20:23], s30 offen offset:2048 lds
    s_waitcnt lgkmcnt(11)
    v_mfma_f32_32x32x16_bf16 v[32:47], v[116:119], v[148:151], v[32:47]
    ds_read_b128 v[124:127], v14
    ds_read_b64_tr_b16 v[188:189], v15 offset:15360
    ds_read_b64_tr_b16 v[190:191], v15 offset:16640
    v_mfma_f32_32x32x16_bf16 v[48:63], v[116:119], v[152:155], v[48:63]
    ds_read_b64_tr_b16 v[192:193], v16 offset:15360
    ds_read_b64_tr_b16 v[194:195], v16 offset:16640
    ds_read_b64_tr_b16 v[196:197], v17 offset:15360
    buffer_load_dwordx4 v9, s[20:23], s30 offen offset:3072 lds
    v_mfma_f32_32x32x16_bf16 v[64:79], v[116:119], v[156:159], v[64:79]
    ds_read_b64_tr_b16 v[198:199], v17 offset:16640
    ds_read_b64_tr_b16 v[200:201], v18 offset:15360
    ds_read_b64_tr_b16 v[202:203], v18 offset:16640
    v_mfma_f32_32x32x16_bf16 v[80:95], v[116:119], v[160:163], v[80:95]
    ds_read_b64_tr_b16 v[204:205], v19 offset:15360
    ds_read_b64_tr_b16 v[206:207], v19 offset:16640
    s_add_u32 m0, m0, 4096
    s_nop 0
    buffer_load_dwordx4 v10, s[20:23], s30 offen lds
    s_add_u32 s64, s64, 1
    s_cmp_eq_u32 s64, 9
    s_cselect_b32 s64, 0, s64
    s_cselect_b32 s69, s60, s34
    s_add_u32 s30, s30, s69
    s_add_u32 s38, s38, 36864
    s_cmp_eq_u32 s38, 147456
    s_cselect_b32 s38, 0, s38
    v_mfma_f32_32x32x16_bf16 v[96:111], v[116:119], v[164:167], v[96:111]
    s_add_u32 s37, s32, 1
    s_and_b32 s33, s37, 3
    s_cmp_eq_u32 s33, 0
    s_cselect_b32 s33, s68, s67
    v_add_u32 v11, s33, v11
    v_add_u32 v12, s33, v12
    v_add_u32 v13, s33, v13
    v_add_u32 v14, s33, v14
    v_add_u32 v15, s33, v15
    v_add_u32 v16, s33, v16
    v_add_u32 v17, s33, v17
    v_add_u32 v18, s33, v18
    v_add_u32 v19, s33, v19
    s_waitcnt lgkmcnt(11)
    v_mfma_f32_32x32x16_bf16 v[32:47], v[120:123], v[168:171], v[32:47]
    s_waitcnt vmcnt(9)
    s_barrier
    s_cmp_lt_u32 s32, 6
    s_cselect_b32 s29, s29, 0x40000000
    s_cselect_b32 s30, s30, 0x40000000
    ds_read_b128 v[112:115], v11
    ds_read_b64_tr_b16 v[128:129], v15 offset:0
    ds_read_b64_tr_b16 v[130:131], v15 offset:1280
    v_mfma_f32_32x32x16_bf16 v[48:63], v[120:123], v[172:175], v[48:63]
    ds_read_b64_tr_b16 v[132:133], v16 offset:0
    ds_read_b64_tr_b16 v[134:135], v16 offset:1280
    ds_read_b64_tr_b16 v[136:137], v17 offset:0
    v_mfma_f32_32x32x16_bf16 v[64:79], v[120:123], v[176:179], v[64:79]
    ds_read_b64_tr_b16 v[138:139], v17 offset:1280
    ds_read_b64_tr_b16 v[140:141], v18 offset:0
    ds_read_b64_tr_b16 v[142:143], v18 offset:1280
    s_add_u32 m0, s35, s31
    s_nop 0
    buffer_load_dwordx4 v2, s[16:19], s29 offen lds
    v_mfma_f32_32x32x16_bf16 v[80:95], v[120:123], v[180:183], v[80:95]
    ds_read_b64_tr_b16 v[144:145], v19 offset:0
    ds_read_b64_tr_b16 v[146:147], v19 offset:1280
    v_mfma_f32_32x32x16_bf16 v[96:111], v[120:123], v[184:187], v[96:111]
    buffer_load_dwordx4 v3, s[16:19], s29 offen offset:1024 lds
    s_waitcnt lgkmcnt(11)
    v_mfma_f32_32x32x16_bf16 v[32:47], v[124:127], v[188:191], v[32:47]
    ds_read_b128 v[116:119], v12
    ds_read_b64_tr_b16 v[148:149], v15 offset:5120
    ds_read_b64_tr_b16 v[150:151], v15 offset:6400
    v_mfma_f32_32x32x16_bf16 v[48:63], v[124:127], v[192:195], v[48:63]
    ds_read_b64_tr_b16 v[152:153], v16 offset:5120
    ds_read_b64_tr_b16 v[154:155], v16 offset:6400
    ds_read_b64_tr_b16 v[156:157], v17 offset:5120
    buffer_load_dwordx4 v4, s[16:19], s29 offen offset:2048 lds
    v_mfma_f32_32x32x16_bf16 v[64:79], v[124:127], v[196:199], v[64:79]
    ds_read_b64_tr_b16 v[158:159], v17 offset:6400
    ds_read_b64_tr_b16 v[160:161], v18 offset:5120
    ds_read_b64_tr_b16 v[162:163], v18 offset:6400
    v_mfma_f32_32x32x16_bf16 v[80:95], v[124:127], v[200:203], v[80:95]
    ds_read_b64_tr_b16 v[164:165], v19 offset:5120
    ds_read_b64_tr_b16 v[166:167], v19 offset:6400
    buffer_load_dwordx4 v5, s[16:19], s29 offen offset:3072 lds
    s_add_u32 s39, s39, 1
    s_cmp_eq_u32 s39, 9
    s_cselect_b32 s39, 0, s39
    s_cselect_b32 s69, 4294966272, s61
    s_add_u32 s29, s29, s69
    s_add_u32 s35, s35, 36864
    s_cmp_eq_u32 s35, 147456
    s_cselect_b32 s35, 0, s35
    v_mfma_f32_32x32x16_bf16 v[96:111], v[124:127], v[204:207], v[96:111]
    s_add_u32 s32, s32, 1
    s_cmp_lt_u32 s32, 9
    s_cbranch_scc1 L1_loop_v
    s_waitcnt lgkmcnt(0)
    s_nop 7
    s_lshl_b32 s44, s9, 2
    s_add_u32 s44, s44, s8
    s_lshl_b32 s45, s11, 3
    s_mul_i32 s46, s45, 77824
    s_mul_i32 s47, s44, 1216
    s_add_u32 s46, s46, s47
    s_add_u32 s46, s46, 4718592
    v_lshrrev_b32 v21, 5, v0
    v_mul_u32_u24 v21, 304, v21
    v_and_b32 v22, 15, v0
    v_lshlrev_b32 v22, 4, v22
    v_add_u32 v22, v22, v21
    v_bfe_u32 v23, v0, 4, 1
    s_mov_b32 s47, 77824
    v_mul_lo_u32 v24, v23, s47
    v_add_u32 v25, v22, v24
    v_mul_u32_u24 v24, 7, v24
    v_add_u32 v26, v22, v24
    s_add_u32 s47, s46, 0
    v_cvt_pk_bf16_f32 v112, v32, v33
    v_cvt_pk_bf16_f32 v113, v34, v35
    v_cvt_pk_bf16_f32 v114, v36, v37
    v_cvt_pk_bf16_f32 v115, v38, v39
    buffer_store_dwordx4 v[112:115], v26, s[12:15], s47 offen offset:0 sc1
    v_cvt_pk_bf16_f32 v116, v40, v41
    v_cvt_pk_bf16_f32 v117, v42, v43
    v_cvt_pk_bf16_f32 v118, v44, v45
    v_cvt_pk_bf16_f32 v119, v46, v47
    buffer_store_dwordx4 v[116:119], v26, s[12:15], s47 offen offset:608 sc1
    s_add_u32 s47, s46, 77824
    v_cvt_pk_bf16_f32 v120, v48, v49
    v_cvt_pk_bf16_f32 v121, v50, v51
    v_cvt_pk_bf16_f32 v122, v52, v53
    v_cvt_pk_bf16_f32 v123, v54, v55
    buffer_store_dwordx4 v[120:123], v25, s[12:15], s47 offen offset:0 sc1
    v_cvt_pk_bf16_f32 v124, v56, v57
    v_cvt_pk_bf16_f32 v125, v58, v59
    v_cvt_pk_bf16_f32 v126, v60, v61
    v_cvt_pk_bf16_f32 v127, v62, v63
    buffer_store_dwordx4 v[124:127], v25, s[12:15], s47 offen offset:608 sc1
    s_add_u32 s47, s46, 233472
    v_cvt_pk_bf16_f32 v112, v64, v65
    v_cvt_pk_bf16_f32 v113, v66, v67
    v_cvt_pk_bf16_f32 v114, v68, v69
    v_cvt_pk_bf16_f32 v115, v70, v71
    buffer_store_dwordx4 v[112:115], v25, s[12:15], s47 offen offset:0 sc1
    v_cvt_pk_bf16_f32 v116, v72, v73
    v_cvt_pk_bf16_f32 v117, v74, v75
    v_cvt_pk_bf16_f32 v118, v76, v77
    v_cvt_pk_bf16_f32 v119, v78, v79
    buffer_store_dwordx4 v[116:119], v25, s[12:15], s47 offen offset:608 sc1
    s_add_u32 s47, s46, 389120
    v_cvt_pk_bf16_f32 v120, v80, v81
    v_cvt_pk_bf16_f32 v121, v82, v83
    v_cvt_pk_bf16_f32 v122, v84, v85
    v_cvt_pk_bf16_f32 v123, v86, v87
    buffer_store_dwordx4 v[120:123], v25, s[12:15], s47 offen offset:0 sc1
    v_cvt_pk_bf16_f32 v124, v88, v89
    v_cvt_pk_bf16_f32 v125, v90, v91
    v_cvt_pk_bf16_f32 v126, v92, v93
    v_cvt_pk_bf16_f32 v127, v94, v95
    buffer_store_dwordx4 v[124:127], v25, s[12:15], s47 offen offset:608 sc1
    v_and_b32 v22, 31, v0
    v_lshrrev_b32 v23, 2, v22
    v_lshlrev_b32 v23, 1, v23
    v_bfe_u32 v24, v22, 1, 1
    v_add_u32 v23, v23, v24
    v_and_b32 v24, 1, v22
    v_add_u32 v24, 16, v24
    v_cmp_lt_u32 vcc, 15, v22
    v_subrev_u32 v25, 16, v22
    v_mov_b32 v27, 18
    v_cndmask_b32 v23, v23, v25, vcc
    v_cndmask_b32 v24, v24, v27, vcc
    s_mov_b32 s47, 77824
    v_mul_lo_u32 v23, v23, s47
    v_lshlrev_b32 v24, 4, v24
    v_add3_u32 v23, v23, v24, v21
    v_mov_b32 v27, 0x3f803f80
    v_cvt_pk_bf16_f32 v128, v96, v97
    v_cndmask_b32 v128, v128, v27, vcc
    v_cvt_pk_bf16_f32 v129, v98, v99
    v_cndmask_b32 v129, v129, v27, vcc
    v_cvt_pk_bf16_f32 v130, v100, v101
    v_cndmask_b32 v130, v130, v27, vcc
    v_cvt_pk_bf16_f32 v131, v102, v103
    v_cndmask_b32 v131, v131, v27, vcc
    v_cvt_pk_bf16_f32 v132, v104, v105
    v_cndmask_b32 v132, v132, v27, vcc
    v_cvt_pk_bf16_f32 v133, v106, v107
    v_cndmask_b32 v133, v133, v27, vcc
    v_cvt_pk_bf16_f32 v134, v108, v109
    v_cndmask_b32 v134, v134, v27, vcc
    v_cvt_pk_bf16_f32 v135, v110, v111
    v_cndmask_b32 v135, v135, v27, vcc
    v_cmp_gt_u32 vcc, 24, v22
    s_nop 1
    s_and_saveexec_b64 s[48:49], vcc
    buffer_store_dwordx4 v[128:131], v23, s[12:15], s46 offen offset:0 sc1
    buffer_store_dwordx4 v[132:135], v23, s[12:15], s46 offen offset:608 sc1
    s_mul_i32 s48, s11, 128
    s_add_u32 s48, s48, 5760
    s_mov_b64 exec, -1
    s_load_dwordx2 s[46:47], s[0:1], 80
    s_add_u32 s34, s4, 39608320
    s_addc_u32 s35, s5, 0
    v_mov_b32 v248, 0
    v_mov_b32 v249, 0
    s_waitcnt vmcnt(10) lgkmcnt(0)
    s_barrier
    s_cmp_eq_u32 s8, 0
    s_cbranch_scc0 Lp1_2188_a
    global_load_dword v249, v248, s[46:47] sc1
Lp1_2188_a:
    s_mov_b32 s67, 1
    s_movk_i32 s68, 84
    s_mov_b32 s66, 0
    s_cmp_lt_u32 s7, 16
    s_cbranch_scc0 Lus_2200_a
    s_lshr_b32 s64, s7, 3
    s_lshl_b32 s65, s6, 1
    s_add_u32 s64, s64, s65
    s_and_b32 s65, s7, 7
    s_cmp_ge_u32 s7, 8
    s_cbranch_scc0 Lus_2200_z
    s_sub_u32 s68, s7, 8
    s_lshl_b32 s68, s68, 3
    s_add_u32 s68, s68, s6
    s_cmp_lt_u32 s68, 36
    s_cbranch_scc0 Lus_2200_z
    s_mov_b32 s67, 3
    s_cmp_lt_u32 s68, 24
    s_cbranch_scc0 Lus_2200_w
    s_mul_i32 s66, s68, 86
    s_lshr_b32 s66, s66, 8
    s_mul_i32 s69, s66, 6
    s_add_u32 s68, s68, s69
    s_add_u32 s68, s68, 6
    s_mul_i32 s66, s66, 128
    s_add_u32 s66, s66, 8320
    s_branch Lus_2200_z
Lus_2200_w:
    s_add_u32 s68, s68, 48
    s_movk_i32 s66, 3072
    s_branch Lus_2200_z
Lus_2200_a:
    s_cmp_lt_u32 s7, 24
    s_cbranch_scc1 Lus_2200_v
    s_mov_b32 s67, 0
    s_branch Lus_2200_z
Lus_2200_v:
    s_sub_u32 s68, s7, 16
    s_lshl_b32 s68, s68, 3
    s_add_u32 s68, s68, s6
    s_cmp_lt_u32 s68, 16
    s_cbranch_scc0 Lus_2200_b
    s_lshr_b32 s64, s68, 3
    s_lshl_b32 s65, s6, 1
    s_add_u32 s64, s64, s65
    s_mov_b32 s65, 8
    s_branch Lus_2200_z
Lus_2200_b:
    s_mov_b32 s67, 2
    s_sub_u32 s68, s68, 16
    s_mul_i32 s64, s68, 43
    s_lshr_b32 s64, s64, 8
    s_mul_i32 s65, s64, 3
    s_add_u32 s68, s68, s65
    s_mul_i32 s66, s64, 128
    s_add_u32 s66, s66, 2048
Lus_2200_z:
    s_cmp_eq_u32 s67, 2
    s_cbranch_scc1 Lue_2200_r
    s_load_dwordx2 s[24:25], s[0:1], 40
    v_lshrrev_b32 v5, 3, v0
    v_and_b32 v6, 7, v0
    v_bfe_u32 v7, v0, 4, 1
    v_lshlrev_b32 v7, 2, v7
    v_xor_b32 v6, v6, v7
    v_mul_u32_u24 v5, 1152, v5
    v_lshlrev_b32 v6, 4, v6
    v_add_u32 v2, v5, v6
    v_add_u32 v3, 8192, v2
    s_waitcnt lgkmcnt(0)
    s_mov_b32 s16, s24
    s_and_b32 s17, s25, 0xffff
    s_mov_b32 s18, 663552
    s_mov_b32 s19, 0x20000
    s_mul_i32 s28, s8, 18432
    s_lshl_b32 s29, s65, 7
    s_add_u32 s28, s28, s29
    s_mul_i32 s29, s8, 2048
    s_add_u32 m0, s29, 0
    s_add_u32 s31, s28, 0
    buffer_load_dwordx4 v2, s[16:19], s31 offen lds
    buffer_load_dwordx4 v3, s[16:19], s31 offen offset:1024 lds
    s_add_u32 m0, s29, 8192
    s_add_u32 s31, s28, 73728
    buffer_load_dwordx4 v2, s[16:19], s31 offen lds
    buffer_load_dwordx4 v3, s[16:19], s31 offen offset:1024 lds
    s_add_u32 m0, s29, 16384
    s_add_u32 s31, s28, 147456
    buffer_load_dwordx4 v2, s[16:19], s31 offen lds
    buffer_load_dwordx4 v3, s[16:19], s31 offen offset:1024 lds
    s_add_u32 m0, s29, 24576
    s_add_u32 s31, s28, 221184
    buffer_load_dwordx4 v2, s[16:19], s31 offen lds
    buffer_load_dwordx4 v3, s[16:19], s31 offen offset:1024 lds
    s_add_u32 m0, s29, 32768
    s_add_u32 s31, s28, 294912
    buffer_load_dwordx4 v2, s[16:19], s31 offen lds
    buffer_load_dwordx4 v3, s[16:19], s31 offen offset:1024 lds
    s_add_u32 m0, s29, 40960
    s_add_u32 s31, s28, 368640
    buffer_load_dwordx4 v2, s[16:19], s31 offen lds
    buffer_load_dwordx4 v3, s[16:19], s31 offen offset:1024 lds
    s_add_u32 m0, s29, 49152
    s_add_u32 s31, s28, 442368
    buffer_load_dwordx4 v2, s[16:19], s31 offen lds
    buffer_load_dwordx4 v3, s[16:19], s31 offen offset:1024 lds
    s_add_u32 m0, s29, 57344
    s_add_u32 s31, s28, 516096
    buffer_load_dwordx4 v2, s[16:19], s31 offen lds
    buffer_load_dwordx4 v3, s[16:19], s31 offen offset:1024 lds
    s_add_u32 m0, s29, 65536
    s_add_u32 s31, s28, 589824
    buffer_load_dwordx4 v2, s[16:19], s31 offen lds
    buffer_load_dwordx4 v3, s[16:19], s31 offen offset:1024 lds
    s_cmp_eq_u32 s67, 3
    s_cbranch_scc0 Lue_2200_g
    s_mov_b32 s53, s68
    s_load_dwordx2 s[60:61], s[0:1], 48
    s_load_dwordx2 s[62:63], s[0:1], 16
    s_cmp_lt_u32 s53, 72
    s_cselect_b32 s59, 1, 0
    s_movk_i32 s58, 1152
    s_cselect_b32 s58, 9216, s58
    s_sub_u32 s56, s53, 72
    s_mul_i32 s55, s56, 86
    s_lshr_b32 s55, s55, 8
    s_mul_i32 s57, s55, 3
    s_sub_u32 s57, s56, s57
    s_mul_i32 s56, s55, 288
    s_lshl_b32 s54, s57, 7
    s_add_u32 s56, s56, s54
    s_lshl_b32 s54, s53, 7
    s_cmp_lt_u32 s53, 72
    s_cselect_b32 s56, s54, s56
    s_waitcnt lgkmcnt(0)
    s_cmp_lt_u32 s53, 72
    s_cselect_b32 s36, s60, s62
    s_cselect_b32 s37, s61, s63
    s_mov_b32 s38, 663552
    s_cselect_b32 s38, 5308416, s38
    s_cmp_lt_u32 s53, 84
    s_cselect_b32 s38, s38, 0
    s_and_b32 s37, s37, 0xffff
    s_mov_b32 s39, 0x20000
    v_lshrrev_b32 v17, 3, v0
    v_and_b32 v18, 7, v0
    v_bfe_u32 v19, v0, 4, 1
    v_mul_u32_u24 v19, s59, v19
    v_lshlrev_b32 v19, 2, v19
    v_xor_b32 v18, v18, v19
    v_mul_lo_u32 v17, v17, s58
    v_lshlrev_b32 v18, 4, v18
    v_add_u32 v16, v17, v18
    s_mul_i32 s57, s8, 144
    s_mul_i32 s57, s57, s58
    s_mul_i32 s54, s8, 18432
    s_lshl_b32 s58, s58, 3
    s_add_u32 m0, s54, 73728
    s_add_u32 s55, s56, s57
    buffer_load_dwordx4 v16, s[36:39], s55 offen lds
    s_add_u32 m0, s54, 74752
    s_add_u32 s55, s55, s58
    buffer_load_dwordx4 v16, s[36:39], s55 offen lds
    s_add_u32 m0, s54, 75776
    s_add_u32 s55, s55, s58
    buffer_load_dwordx4 v16, s[36:39], s55 offen lds
    s_add_u32 m0, s54, 76800
    s_add_u32 s55, s55, s58
    buffer_load_dwordx4 v16, s[36:39], s55 offen lds
    s_add_u32 m0, s54, 77824
    s_add_u32 s55, s55, s58
    buffer_load_dwordx4 v16, s[36:39], s55 offen lds
    s_add_u32 m0, s54, 78848
    s_add_u32 s55, s55, s58
    buffer_load_dwordx4 v16, s[36:39], s55 offen lds
    s_add_u32 m0, s54, 79872
    s_add_u32 s55, s55, s58
    buffer_load_dwordx4 v16, s[36:39], s55 offen lds
    s_add_u32 m0, s54, 80896
    s_add_u32 s55, s55, s58
    buffer_load_dwordx4 v16, s[36:39], s55 offen lds
    s_add_u32 m0, s54, 81920
    s_add_u32 s55, s55, s58
    buffer_load_dwordx4 v16, s[36:39], s55 offen lds
    s_add_u32 m0, s54, 82944
    s_add_u32 s55, s55, s58
    buffer_load_dwordx4 v16, s[36:39], s55 offen lds
    s_add_u32 m0, s54, 83968
    s_add_u32 s55, s55, s58
    buffer_load_dwordx4 v16, s[36:39], s55 offen lds
    s_add_u32 m0, s54, 84992
    s_add_u32 s55, s55, s58
    buffer_load_dwordx4 v16, s[36:39], s55 offen lds
    s_add_u32 m0, s54, 86016
    s_add_u32 s55, s55, s58
    buffer_load_dwordx4 v16, s[36:39], s55 offen lds
    s_add_u32 m0, s54, 87040
    s_add_u32 s55, s55, s58
    buffer_load_dwordx4 v16, s[36:39], s55 offen lds
    s_add_u32 m0, s54, 88064
    s_add_u32 s55, s55, s58
    buffer_load_dwordx4 v16, s[36:39], s55 offen lds
    s_add_u32 m0, s54, 89088
    s_add_u32 s55, s55, s58
    buffer_load_dwordx4 v16, s[36:39], s55 offen lds
    s_add_u32 m0, s54, 90112
    s_add_u32 s55, s55, s58
    buffer_load_dwordx4 v16, s[36:39], s55 offen lds
    s_add_u32 m0, s54, 91136
    s_add_u32 s55, s55, s58
    buffer_load_dwordx4 v16, s[36:39], s55 offen lds
    s_waitcnt vmcnt(36)
    s_branch Lue_2200_z
Lue_2200_g:
    s_waitcnt vmcnt(18)
    s_branch Lue_2200_z
Lue_2200_r:
    s_mov_b32 s53, s68
    s_load_dwordx2 s[60:61], s[0:1], 48
    s_load_dwordx2 s[62:63], s[0:1], 16
    s_cmp_lt_u32 s53, 72
    s_cselect_b32 s59, 1, 0
    s_movk_i32 s58, 1152
    s_cselect_b32 s58, 9216, s58
    s_sub_u32 s56, s53, 72
    s_mul_i32 s55, s56, 86
    s_lshr_b32 s55, s55, 8
    s_mul_i32 s57, s55, 3
    s_sub_u32 s57, s56, s57
    s_mul_i32 s56, s55, 288
    s_lshl_b32 s54, s57, 7
    s_add_u32 s56, s56, s54
    s_lshl_b32 s54, s53, 7
    s_cmp_lt_u32 s53, 72
    s_cselect_b32 s56, s54, s56
    s_waitcnt lgkmcnt(0)
    s_cmp_lt_u32 s53, 72
    s_cselect_b32 s36, s60, s62
    s_cselect_b32 s37, s61, s63
    s_mov_b32 s38, 663552
    s_cselect_b32 s38, 5308416, s38
    s_cmp_lt_u32 s53, 84
    s_cselect_b32 s38, s38, 0
    s_and_b32 s37, s37, 0xffff
    s_mov_b32 s39, 0x20000
    v_lshrrev_b32 v17, 3, v0
    v_and_b32 v18, 7, v0
    v_bfe_u32 v19, v0, 4, 1
    v_mul_u32_u24 v19, s59, v19
    v_lshlrev_b32 v19, 2, v19
    v_xor_b32 v18, v18, v19
    v_mul_lo_u32 v17, v17, s58
    v_lshlrev_b32 v18, 4, v18
    v_add_u32 v16, v17, v18
    s_mul_i32 s57, s8, 144
    s_mul_i32 s57, s57, s58
    s_mul_i32 s54, s8, 18432
    s_lshl_b32 s58, s58, 3
    s_add_u32 m0, s54, 73728
    s_add_u32 s55, s56, s57
    buffer_load_dwordx4 v16, s[36:39], s55 offen lds
    s_add_u32 m0, s54, 74752
    s_add_u32 s55, s55, s58
    buffer_load_dwordx4 v16, s[36:39], s55 offen lds
    s_add_u32 m0, s54, 75776
    s_add_u32 s55, s55, s58
    buffer_load_dwordx4 v16, s[36:39], s55 offen lds
    s_add_u32 m0, s54, 76800
    s_add_u32 s55, s55, s58
    buffer_load_dwordx4 v16, s[36:39], s55 offen lds
    s_add_u32 m0, s54, 77824
    s_add_u32 s55, s55, s58
    buffer_load_dwordx4 v16, s[36:39], s55 offen lds
    s_add_u32 m0, s54, 78848
    s_add_u32 s55, s55, s58
    buffer_load_dwordx4 v16, s[36:39], s55 offen lds
    s_add_u32 m0, s54, 79872
    s_add_u32 s55, s55, s58
    buffer_load_dwordx4 v16, s[36:39], s55 offen lds
    s_add_u32 m0, s54, 80896
    s_add_u32 s55, s55, s58
    buffer_load_dwordx4 v16, s[36:39], s55 offen lds
    s_add_u32 m0, s54, 81920
    s_add_u32 s55, s55, s58
    buffer_load_dwordx4 v16, s[36:39], s55 offen lds
    s_add_u32 m0, s54, 82944
    s_add_u32 s55, s55, s58
    buffer_load_dwordx4 v16, s[36:39], s55 offen lds
    s_add_u32 m0, s54, 83968
    s_add_u32 s55, s55, s58
    buffer_load_dwordx4 v16, s[36:39], s55 offen lds
    s_add_u32 m0, s54, 84992
    s_add_u32 s55, s55, s58
    buffer_load_dwordx4 v16, s[36:39], s55 offen lds
    s_add_u32 m0, s54, 86016
    s_add_u32 s55, s55, s58
    buffer_load_dwordx4 v16, s[36:39], s55 offen lds
    s_add_u32 m0, s54, 87040
    s_add_u32 s55, s55, s58
    buffer_load_dwordx4 v16, s[36:39], s55 offen lds
    s_add_u32 m0, s54, 88064
    s_add_u32 s55, s55, s58
    buffer_load_dwordx4 v16, s[36:39], s55 offen lds
    s_add_u32 m0, s54, 89088
    s_add_u32 s55, s55, s58
    buffer_load_dwordx4 v16, s[36:39], s55 offen lds
    s_add_u32 m0, s54, 90112
    s_add_u32 s55, s55, s58
    buffer_load_dwordx4 v16, s[36:39], s55 offen lds
    s_add_u32 m0, s54, 91136
    s_add_u32 s55, s55, s58
    buffer_load_dwordx4 v16, s[36:39], s55 offen lds
    s_waitcnt vmcnt(18)
Lue_2200_z:
    s_barrier
    s_cmp_eq_u32 s8, 0
    s_cbranch_scc0 Lp1_2188_z
    s_mov_b32 s50, 0x40000
Lp1_2188_b:
    v_readfirstlane_b32 s52, v249
    s_cmp_lg_u32 s52, 0
    s_cbranch_scc1 Lp1_2188_c
    global_load_dword v249, v248, s[46:47] sc1
    s_waitcnt vmcnt(0)
    s_sub_u32 s50, s50, 1
    s_cmp_lg_u32 s50, 0
    s_cbranch_scc1 Lp1_2188_b
Lp1_2188_c:
    s_mov_b64 exec, 1
    v_mov_b32 v251, 1
    v_mov_b32 v250, s48
    global_atomic_add v250, v251, s[34:35] sc1
    s_mov_b64 exec, -1
Lp1_2188_z:
    s_branch K_pre
L1_h:
    s_mov_b32 s35, 0
    s_mov_b32 s38, 0
    s_add_u32 m0, s35, s31
    s_nop 0
    buffer_load_dwordx4 v2, s[16:19], s29 offen lds
    buffer_load_dwordx4 v3, s[16:19], s29 offen offset:1024 lds
    buffer_load_dwordx4 v4, s[16:19], s29 offen offset:2048 lds
    buffer_load_dwordx4 v5, s[16:19], s29 offen offset:3072 lds
    s_add_u32 s39, s39, 1
    s_cmp_eq_u32 s39, 9
    s_cselect_b32 s39, 0, s39
    s_cselect_b32 s69, 4294966272, s61
    s_add_u32 s29, s29, s69
    s_add_u32 s35, s35, 36864
    s_cmp_eq_u32 s35, 147456
    s_cselect_b32 s35, 0, s35
    s_add_u32 m0, s38, s36
    s_nop 0
    buffer_load_dwordx4 v6, s[20:23], s30 offen lds
    buffer_load_dwordx4 v7, s[20:23], s30 offen offset:1024 lds
    buffer_load_dwordx4 v8, s[20:23], s30 offen offset:2048 lds
    buffer_load_dwordx4 v9, s[20:23], s30 offen offset:3072 lds
    s_add_u32 m0, m0, 4096
    s_nop 0
    buffer_load_dwordx4 v10, s[20:23], s30 offen lds
    s_add_u32 s64, s64, 1
    s_cmp_eq_u32 s64, 9
    s_cselect_b32 s64, 0, s64
    s_cselect_b32 s69, s60, s34
    s_add_u32 s30, s30, s69
    s_add_u32 s38, s38, 36864
    s_cmp_eq_u32 s38, 147456
    s_cselect_b32 s38, 0, s38
    s_add_u32 m0, s35, s31
    s_nop 0
    buffer_load_dwordx4 v2, s[16:19], s29 offen lds
    buffer_load_dwordx4 v3, s[16:19], s29 offen offset:1024 lds
    buffer_load_dwordx4 v4, s[16:19], s29 offen offset:2048 lds
    buffer_load_dwordx4 v5, s[16:19], s29 offen offset:3072 lds
    s_add_u32 s39, s39, 1
    s_cmp_eq_u32 s39, 9
    s_cselect_b32 s39, 0, s39
    s_cselect_b32 s69, 4294966272, s61
    s_add_u32 s29, s29, s69
    s_add_u32 s35, s35, 36864
    s_cmp_eq_u32 s35, 147456
    s_cselect_b32 s35, 0, s35
    s_add_u32 m0, s38, s36
    s_nop 0
    buffer_load_dwordx4 v6, s[20:23], s30 offen lds
    buffer_load_dwordx4 v7, s[20:23], s30 offen offset:1024 lds
    buffer_load_dwordx4 v8, s[20:23], s30 offen offset:2048 lds
    buffer_load_dwordx4 v9, s[20:23], s30 offen offset:3072 lds
    s_add_u32 m0, m0, 4096
    s_nop 0
    buffer_load_dwordx4 v10, s[20:23], s30 offen lds
    s_add_u32 s64, s64, 1
    s_cmp_eq_u32 s64, 9
    s_cselect_b32 s64, 0, s64
    s_cselect_b32 s69, s60, s34
    s_add_u32 s30, s30, s69
    s_add_u32 s38, s38, 36864
    s_cmp_eq_u32 s38, 147456
    s_cselect_b32 s38, 0, s38
    s_add_u32 m0, s35, s31
    s_nop 0
    buffer_load_dwordx4 v2, s[16:19], s29 offen lds
    buffer_load_dwordx4 v3, s[16:19], s29 offen offset:1024 lds
    buffer_load_dwordx4 v4, s[16:19], s29 offen offset:2048 lds
    buffer_load_dwordx4 v5, s[16:19], s29 offen offset:3072 lds
    s_add_u32 s39, s39, 1
    s_cmp_eq_u32 s39, 9
    s_cselect_b32 s39, 0, s39
    s_cselect_b32 s69, 4294966272, s61
    s_add_u32 s29, s29, s69
    s_add_u32 s35, s35, 36864
    s_cmp_eq_u32 s35, 147456
    s_cselect_b32 s35, 0, s35
    v_lshrrev_b32 v21, 5, v0
    v_bfe_u32 v22, v0, 4, 1
    v_bfe_u32 v23, v0, 2, 2
    v_and_b32 v24, 3, v0
    v_and_b32 v25, 1, v0
    v_lshlrev_b32 v25, 1, v25
    v_bfe_u32 v26, v0, 1, 1
    v_or_b32 v25, v25, v26
    v_lshlrev_b32 v26, 3, v21
    v_add_u32 v26, v26, v23
    v_mul_u32_u24 v26, 320, v26
    v_add_u32 v26, 16384, v26
    v_lshlrev_b32 v27, 3, v25
    v_add_u32 v27, v27, v26
    v_add_u32 v19, 288, v27
    v_lshlrev_b32 v28, 5, v22
    v_add_u32 v27, v27, v28
    v_add_u32 v15, 0, v27
    v_add_u32 v16, 64, v27
    v_add_u32 v17, 128, v27
    v_add_u32 v18, 192, v27
    s_lshl_b32 s69, s8, 6
    v_add_u32 v21, s69, v15
    v_mov_b32 v112, 0
    v_mov_b32 v113, 0
    v_mov_b32 v114, 0
    v_mov_b32 v115, 0
    v_accvgpr_write_b32 a32, s40
    v_accvgpr_write_b32 a33, s40
    v_accvgpr_write_b32 a34, s40
    v_accvgpr_write_b32 a35, s40
    s_nop 1
    v_mfma_f32_32x32x16_bf16 v[32:47], v[112:115], v[112:115], 0
    v_mfma_f32_32x32x16_bf16 v[48:63], v[112:115], v[112:115], 0
    v_mfma_f32_32x32x16_bf16 v[64:79], v[112:115], v[112:115], 0
    v_mfma_f32_32x32x16_bf16 v[80:95], v[112:115], v[112:115], 0
    v_mfma_f32_32x32x16_bf16 v[96:111], v[112:115], v[112:115], 0
    v_mfma_f32_32x32x16_bf16 v[224:239], v[112:115], v[112:115], 0
    v_mfma_f32_32x32x16_bf16 v[240:255], v[112:115], v[112:115], 0
    v_mfma_f32_32x32x16_bf16 a[0:15], v[112:115], v[112:115], 0
    v_mfma_f32_32x32x16_bf16 a[16:31], v[112:115], v[112:115], 0
    s_mov_b32 s32, 0
    s_waitcnt vmcnt(13)
    s_barrier
    ds_read_b128 v[112:115], v11
    ds_read_b64_tr_b16 v[128:129], v15 offset:0
    ds_read_b64_tr_b16 v[130:131], v15 offset:1280
    ds_read_b64_tr_b16 v[132:133], v16 offset:0
    ds_read_b64_tr_b16 v[134:135], v16 offset:1280
    ds_read_b64_tr_b16 v[136:137], v17 offset:0
    ds_read_b64_tr_b16 v[138:139], v17 offset:1280
    ds_read_b64_tr_b16 v[140:141], v18 offset:0
    ds_read_b64_tr_b16 v[142:143], v18 offset:1280
    ds_read_b64_tr_b16 v[144:145], v19 offset:0
    ds_read_b64_tr_b16 v[146:147], v19 offset:1280
    ds_read_b64_tr_b16 a[36:37], v21 offset:0
    ds_read_b64_tr_b16 a[38:39], v21 offset:1280
    ds_read_b128 v[116:119], v12
    ds_read_b64_tr_b16 v[148:149], v15 offset:5120
    ds_read_b64_tr_b16 v[150:151], v15 offset:6400
    ds_read_b64_tr_b16 v[152:153], v16 offset:5120
    ds_read_b64_tr_b16 v[154:155], v16 offset:6400
    ds_read_b64_tr_b16 v[156:157], v17 offset:5120
    ds_read_b64_tr_b16 v[158:159], v17 offset:6400
    ds_read_b64_tr_b16 v[160:161], v18 offset:5120
    ds_read_b64_tr_b16 v[162:163], v18 offset:6400
    ds_read_b64_tr_b16 v[164:165], v19 offset:5120
    ds_read_b64_tr_b16 v[166:167], v19 offset:6400
    ds_read_b64_tr_b16 a[40:41], v21 offset:5120
    ds_read_b64_tr_b16 a[42:43], v21 offset:6400
.p2align 6
L1_loop_h:
    s_waitcnt lgkmcnt(13)
    v_mfma_f32_32x32x16_bf16 v[32:47], v[128:131], v[112:115], v[32:47]
    ds_read_b128 v[120:123], v13
    ds_read_b64_tr_b16 v[168:169], v15 offset:10240
    s_add_u32 m0, s38, s36
    s_nop 0
    buffer_load_dwordx4 v6, s[20:23], s30 offen lds
    v_mfma_f32_32x32x16_bf16 v[48:63], v[132:135], v[112:115], v[48:63]
    ds_read_b64_tr_b16 v[170:171], v15 offset:11520
    ds_read_b64_tr_b16 v[172:173], v16 offset:10240
    v_mfma_f32_32x32x16_bf16 v[64:79], v[136:139], v[112:115], v[64:79]
    ds_read_b64_tr_b16 v[174:175], v16 offset:11520
    ds_read_b64_tr_b16 v[176:177], v17 offset:10240
    buffer_load_dwordx4 v7, s[20:23], s30 offen offset:1024 lds
    v_mfma_f32_32x32x16_bf16 v[80:95], v[140:143], v[112:115], v[80:95]
    ds_read_b64_tr_b16 v[178:179], v17 offset:11520
    ds_read_b64_tr_b16 v[180:181], v18 offset:10240
    v_mfma_f32_32x32x16_bf16 v[96:111], v[144:147], v[112:115], v[96:111]
    ds_read_b64_tr_b16 v[182:183], v18 offset:11520
    ds_read_b64_tr_b16 v[184:185], v19 offset:10240
    buffer_load_dwordx4 v8, s[20:23], s30 offen offset:2048 lds
    v_mfma_f32_32x32x16_bf16 v[224:239], a[32:35], v[112:115], v[224:239]
    ds_read_b64_tr_b16 v[186:187], v19 offset:11520
    ds_read_b64_tr_b16 a[44:45], v21 offset:10240
    v_mfma_f32_32x32x16_bf16 v[240:255], v[112:115], v[112:115], v[240:255]
    ds_read_b64_tr_b16 a[46:47], v21 offset:11520
    v_mfma_f32_32x32x16_bf16 a[0:15], a[36:39], a[32:35], a[0:15]
    v_mfma_f32_32x32x16_bf16 a[16:31], v[144:147], a[32:35], a[16:31]
    s_waitcnt lgkmcnt(13)
    v_mfma_f32_32x32x16_bf16 v[32:47], v[148:151], v[116:119], v[32:47]
    ds_read_b128 v[124:127], v14
    ds_read_b64_tr_b16 v[188:189], v15 offset:15360
    v_mfma_f32_32x32x16_bf16 v[48:63], v[152:155], v[116:119], v[48:63]
    ds_read_b64_tr_b16 v[190:191], v15 offset:16640
    ds_read_b64_tr_b16 v[192:193], v16 offset:15360
    buffer_load_dwordx4 v9, s[20:23], s30 offen offset:3072 lds
    v_mfma_f32_32x32x16_bf16 v[64:79], v[156:159], v[116:119], v[64:79]
    ds_read_b64_tr_b16 v[194:195], v16 offset:16640
    ds_read_b64_tr_b16 v[196:197], v17 offset:15360
    v_mfma_f32_32x32x16_bf16 v[80:95], v[160:163], v[116:119], v[80:95]
    ds_read_b64_tr_b16 v[198:199], v17 offset:16640
    ds_read_b64_tr_b16 v[200:201], v18 offset:15360
    s_add_u32 m0, m0, 4096
    s_nop 0
    buffer_load_dwordx4 v10, s[20:23], s30 offen lds
    s_add_u32 s64, s64, 1
    s_cmp_eq_u32 s64, 9
    s_cselect_b32 s64, 0, s64
    s_cselect_b32 s69, s60, s34
    s_add_u32 s30, s30, s69
    s_add_u32 s38, s38, 36864
    s_cmp_eq_u32 s38, 147456
    s_cselect_b32 s38, 0, s38
    v_mfma_f32_32x32x16_bf16 v[96:111], v[164:167], v[116:119], v[96:111]
    ds_read_b64_tr_b16 v[202:203], v18 offset:16640
    ds_read_b64_tr_b16 v[204:205], v19 offset:15360
    v_mfma_f32_32x32x16_bf16 v[224:239], a[32:35], v[116:119], v[224:239]
    ds_read_b64_tr_b16 v[206:207], v19 offset:16640
    ds_read_b64_tr_b16 a[48:49], v21 offset:15360
    v_mfma_f32_32x32x16_bf16 v[240:255], v[116:119], v[116:119], v[240:255]
    ds_read_b64_tr_b16 a[50:51], v21 offset:16640
    v_mfma_f32_32x32x16_bf16 a[0:15], a[40:43], a[32:35], a[0:15]
    v_mfma_f32_32x32x16_bf16 a[16:31], v[164:167], a[32:35], a[16:31]
    s_add_u32 s37, s32, 1
    s_and_b32 s33, s37, 3
    s_cmp_eq_u32 s33, 0
    s_cselect_b32 s33, s68, s67
    v_add_u32 v11, s33, v11
    v_add_u32 v12, s33, v12
    v_add_u32 v13, s33, v13
    v_add_u32 v14, s33, v14
    v_add_u32 v15, s33, v15
    v_add_u32 v16, s33, v16
    v_add_u32 v17, s33, v17
    v_add_u32 v18, s33, v18
    v_add_u32 v19, s33, v19
    v_add_u32 v21, s33, v21
    s_waitcnt lgkmcnt(13)
    v_mfma_f32_32x32x16_bf16 v[32:47], v[168:171], v[120:123], v[32:47]
    s_waitcnt vmcnt(9)
    s_barrier
    s_cmp_lt_u32 s32, 6
    s_cselect_b32 s29, s29, 0x40000000
    s_cselect_b32 s30, s30, 0x40000000
    ds_read_b128 v[112:115], v11
    ds_read_b64_tr_b16 v[128:129], v15 offset:0
    v_mfma_f32_32x32x16_bf16 v[48:63], v[172:175], v[120:123], v[48:63]
    ds_read_b64_tr_b16 v[130:131], v15 offset:1280
    ds_read_b64_tr_b16 v[132:133], v16 offset:0
    v_mfma_f32_32x32x16_bf16 v[64:79], v[176:179], v[120:123], v[64:79]
    ds_read_b64_tr_b16 v[134:135], v16 offset:1280
    ds_read_b64_tr_b16 v[136:137], v17 offset:0
    s_add_u32 m0, s35, s31
    s_nop 0
    buffer_load_dwordx4 v2, s[16:19], s29 offen lds
    v_mfma_f32_32x32x16_bf16 v[80:95], v[180:183], v[120:123], v[80:95]
    ds_read_b64_tr_b16 v[138:139], v17 offset:1280
    ds_read_b64_tr_b16 v[140:141], v18 offset:0
    v_mfma_f32_32x32x16_bf16 v[96:111], v[184:187], v[120:123], v[96:111]
    ds_read_b64_tr_b16 v[142:143], v18 offset:1280
    ds_read_b64_tr_b16 v[144:145], v19 offset:0
    buffer_load_dwordx4 v3, s[16:19], s29 offen offset:1024 lds
    v_mfma_f32_32x32x16_bf16 v[224:239], a[32:35], v[120:123], v[224:239]
    ds_read_b64_tr_b16 v[146:147], v19 offset:1280
    ds_read_b64_tr_b16 a[36:37], v21 offset:0
    v_mfma_f32_32x32x16_bf16 v[240:255], v[120:123], v[120:123], v[240:255]
    ds_read_b64_tr_b16 a[38:39], v21 offset:1280
    v_mfma_f32_32x32x16_bf16 a[0:15], a[44:47], a[32:35], a[0:15]
    v_mfma_f32_32x32x16_bf16 a[16:31], v[184:187], a[32:35], a[16:31]
    s_waitcnt lgkmcnt(13)
    v_mfma_f32_32x32x16_bf16 v[32:47], v[188:191], v[124:127], v[32:47]
    ds_read_b128 v[116:119], v12
    ds_read_b64_tr_b16 v[148:149], v15 offset:5120
    v_mfma_f32_32x32x16_bf16 v[48:63], v[192:195], v[124:127], v[48:63]
    ds_read_b64_tr_b16 v[150:151], v15 offset:6400
    ds_read_b64_tr_b16 v[152:153], v16 offset:5120
    buffer_load_dwordx4 v4, s[16:19], s29 offen offset:2048 lds
    v_mfma_f32_32x32x16_bf16 v[64:79], v[196:199], v[124:127], v[64:79]
    ds_read_b64_tr_b16 v[154:155], v16 offset:6400
    ds_read_b64_tr_b16 v[156:157], v17 offset:5120
    v_mfma_f32_32x32x16_bf16 v[80:95], v[200:203], v[124:127], v[80:95]
    ds_read_b64_tr_b16 v[158:159], v17 offset:6400
    ds_read_b64_tr_b16 v[160:161], v18 offset:5120
    buffer_load_dwordx4 v5, s[16:19], s29 offen offset:3072 lds
    s_add_u32 s39, s39, 1
    s_cmp_eq_u32 s39, 9
    s_cselect_b32 s39, 0, s39
    s_cselect_b32 s69, 4294966272, s61
    s_add_u32 s29, s29, s69
    s_add_u32 s35, s35, 36864
    s_cmp_eq_u32 s35, 147456
    s_cselect_b32 s35, 0, s35
    v_mfma_f32_32x32x16_bf16 v[96:111], v[204:207], v[124:127], v[96:111]
    ds_read_b64_tr_b16 v[162:163], v18 offset:6400
    ds_read_b64_tr_b16 v[164:165], v19 offset:5120
    v_mfma_f32_32x32x16_bf16 v[224:239], a[32:35], v[124:127], v[224:239]
    ds_read_b64_tr_b16 v[166:167], v19 offset:6400
    ds_read_b64_tr_b16 a[40:41], v21 offset:5120
    v_mfma_f32_32x32x16_bf16 v[240:255], v[124:127], v[124:127], v[240:255]
    ds_read_b64_tr_b16 a[42:43], v21 offset:6400
    v_mfma_f32_32x32x16_bf16 a[0:15], a[48:51], a[32:35], a[0:15]
    v_mfma_f32_32x32x16_bf16 a[16:31], v[204:207], a[32:35], a[16:31]
    s_add_u32 s32, s32, 1
    s_cmp_lt_u32 s32, 9
    s_cbranch_scc1 L1_loop_h
    s_waitcnt lgkmcnt(0)
    s_nop 7
    v_lshrrev_b32 v21, 5, v0
    v_lshlrev_b32 v21, 4, v21
    v_add_u32 v29, 149504, v21
    s_lshl_b32 s44, s8, 7
    v_add_u32 v28, s44, v29
    s_mov_b32 exec_lo, 1
    s_mov_b32 exec_hi, 1
    ds_write_b128 v28, a[0:3] offset:0
    ds_write_b128 v28, a[4:7] offset:32
    ds_write_b128 v28, a[8:11] offset:64
    ds_write_b128 v28, a[12:15] offset:96
    ds_write_b128 v29, a[16:19] offset:512
    ds_write_b128 v29, a[20:23] offset:544
    s_mov_b64 exec, -1
    v_bfe_u32 v28, v0, 0, 1
    v_cmp_eq_u32 s[44:45], 1, v28
    v_bfe_u32 v28, v0, 1, 1
    v_cmp_eq_u32 s[46:47], 1, v28
    v_bfe_u32 v28, v0, 3, 1
    v_cmp_eq_u32 s[48:49], 1, v28
    v_bfe_u32 v28, v0, 4, 1
    v_cmp_eq_u32 s[52:53], 1, v28
    v_bfe_u32 v28, v0, 2, 1
    v_lshrrev_b32 v27, 5, v0
    v_cmp_eq_u32 vcc, v27, v28
    s_nop 0
    v_cndmask_b32 v240, v240, v241, s[44:45]
    v_cndmask_b32 v241, v242, v243, s[44:45]
    v_cndmask_b32 v242, v244, v245, s[44:45]
    v_cndmask_b32 v243, v246, v247, s[44:45]
    v_cndmask_b32 v244, v248, v249, s[44:45]
    v_cndmask_b32 v245, v250, v251, s[44:45]
    v_cndmask_b32 v246, v252, v253, s[44:45]
    v_cndmask_b32 v247, v254, v255, s[44:45]
    v_cndmask_b32 v240, v240, v241, s[46:47]
    v_cndmask_b32 v241, v242, v243, s[46:47]
    v_cndmask_b32 v242, v244, v245, s[46:47]
    v_cndmask_b32 v243, v246, v247, s[46:47]
    v_cndmask_b32 v240, v240, v241, s[48:49]
    v_cndmask_b32 v241, v242, v243, s[48:49]
    v_cndmask_b32 v240, v240, v241, s[52:53]
    v_cndmask_b32 v23, 0, v240, vcc
    v_mov_b32 v28, v23
    v_mul_f32 v22, 0x3ae38e39, v224
    s_nop 0
    v_permlane32_swap_b32 v28, v23
    v_add_f32 v23, v28, v23
    v_mul_f32 v23, 0x3ae38e39, v23
    v_fma_f32 v23, -v22, v22, v23
    v_max_f32 v23, 0, v23
    v_add_f32 v23, 0x3727c5ac, v23
    v_sqrt_f32 v118, v23
    s_nop 0
    v_rcp_f32 v119, v118
    s_nop 0
    v_mul_f32 v122, 0xc0135761, v119
    v_mul_f32 v120, v119, v119
    v_mul_f32 v120, v120, v119
    v_mul_f32 v120, 0xbdd2d3e8, v120
    v_mov_b32 v121, v120
    v_mov_b32 v123, v122
    v_mov_b32 v126, v118
    v_mov_b32 v127, v118
    v_sub_f32 v124, 0, v22
    v_mov_b32 v125, v124
    s_lshl_b32 s45, s9, 7
    s_lshl_b32 s46, s8, 5
    s_add_u32 s45, s45, s46
    s_lshr_b32 s46, s11, 1
    s_add_u32 s46, s46, 1
    s_sub_u32 s47, 0, s46
    s_bitcmp1_b32 s11, 0
    s_cselect_b32 s46, s47, s46
    s_add_u32 s45, s45, s46
    v_and_b32 v21, 31, v0
    v_add_u32 v21, s45, v21
    v_cmp_gt_u32 vcc, 2048, v21
    v_and_b32 v21, 2047, v21
    v_lshrrev_b32 v30, 5, v21
    s_mov_b32 s47, 36864
    v_mul_lo_u32 v30, v30, s47
    v_and_b32 v21, 31, v21
    v_lshlrev_b32 v21, 4, v21
    v_add_u32 v30, v30, v21
    v_lshrrev_b32 v21, 5, v0
    v_lshlrev_b32 v21, 9, v21
    v_add_u32 v30, v30, v21
    s_mov_b64 s[50:51], vcc
    s_mul_i32 s47, s11, 9216
    s_add_u32 s47, s47, 7208960
    s_waitcnt lgkmcnt(0)
    s_barrier
    ds_read_b128 v[128:131], v29 offset:0
    ds_read_b128 v[132:135], v29 offset:32
    ds_read_b128 v[136:139], v29 offset:64
    ds_read_b128 v[140:143], v29 offset:96
    s_waitcnt lgkmcnt(0)
    v_pk_fma_f32 v[32:33], v[124:125], v[128:129], v[32:33]
    v_pk_fma_f32 v[34:35], v[124:125], v[130:131], v[34:35]
    v_pk_fma_f32 v[36:37], v[124:125], v[132:133], v[36:37]
    v_pk_fma_f32 v[38:39], v[124:125], v[134:135], v[38:39]
    v_pk_mul_f32 v[144:145], v[32:33], v[32:33]
    v_pk_mul_f32 v[146:147], v[34:35], v[34:35]
    v_pk_mul_f32 v[148:149], v[36:37], v[36:37]
    v_pk_mul_f32 v[150:151], v[38:39], v[38:39]
    v_pk_fma_f32 v[144:145], v[144:145], v[120:121], v[122:123]
    v_pk_fma_f32 v[146:147], v[146:147], v[120:121], v[122:123]
    v_pk_fma_f32 v[148:149], v[148:149], v[120:121], v[122:123]
    v_pk_fma_f32 v[150:151], v[150:151], v[120:121], v[122:123]
    v_pk_mul_f32 v[144:145], v[32:33], v[144:145]
    v_pk_mul_f32 v[146:147], v[34:35], v[146:147]
    v_pk_mul_f32 v[148:149], v[36:37], v[148:149]
    v_pk_mul_f32 v[150:151], v[38:39], v[150:151]
    v_exp_f32 v144, v144
    v_exp_f32 v145, v145
    v_exp_f32 v146, v146
    v_exp_f32 v147, v147
    v_exp_f32 v148, v148
    v_exp_f32 v149, v149
    v_exp_f32 v150, v150
    v_exp_f32 v151, v151
    v_pk_fma_f32 v[144:145], v[144:145], v[126:127], v[126:127]
    v_pk_fma_f32 v[146:147], v[146:147], v[126:127], v[126:127]
    v_pk_fma_f32 v[148:149], v[148:149], v[126:127], v[126:127]
    v_pk_fma_f32 v[150:151], v[150:151], v[126:127], v[126:127]
    v_rcp_f32 v144, v144
    v_rcp_f32 v145, v145
    v_rcp_f32 v146, v146
    v_rcp_f32 v147, v147
    v_rcp_f32 v148, v148
    v_rcp_f32 v149, v149
    v_rcp_f32 v150, v150
    v_rcp_f32 v151, v151
    v_pk_mul_f32 v[32:33], v[32:33], v[144:145]
    v_pk_mul_f32 v[34:35], v[34:35], v[146:147]
    v_pk_mul_f32 v[36:37], v[36:37], v[148:149]
    v_pk_mul_f32 v[38:39], v[38:39], v[150:151]
    v_cvt_pk_bf16_f32 v152, v32, v33
    v_cvt_pk_bf16_f32 v153, v34, v35
    v_cvt_pk_bf16_f32 v154, v36, v37
    v_cvt_pk_bf16_f32 v155, v38, v39
    v_cndmask_b32 v152, 0, v152, s[50:51]
    v_cndmask_b32 v153, 0, v153, s[50:51]
    v_cndmask_b32 v154, 0, v154, s[50:51]
    v_cndmask_b32 v155, 0, v155, s[50:51]
    buffer_store_dwordx4 v[152:155], v30, s[12:15], s47 offen offset:0 sc1
    v_pk_fma_f32 v[40:41], v[124:125], v[136:137], v[40:41]
    v_pk_fma_f32 v[42:43], v[124:125], v[138:139], v[42:43]
    v_pk_fma_f32 v[44:45], v[124:125], v[140:141], v[44:45]
    v_pk_fma_f32 v[46:47], v[124:125], v[142:143], v[46:47]
    v_pk_mul_f32 v[144:145], v[40:41], v[40:41]
    v_pk_mul_f32 v[146:147], v[42:43], v[42:43]
    v_pk_mul_f32 v[148:149], v[44:45], v[44:45]
    v_pk_mul_f32 v[150:151], v[46:47], v[46:47]
    v_pk_fma_f32 v[144:145], v[144:145], v[120:121], v[122:123]
    v_pk_fma_f32 v[146:147], v[146:147], v[120:121], v[122:123]
    v_pk_fma_f32 v[148:149], v[148:149], v[120:121], v[122:123]
    v_pk_fma_f32 v[150:151], v[150:151], v[120:121], v[122:123]
    v_pk_mul_f32 v[144:145], v[40:41], v[144:145]
    v_pk_mul_f32 v[146:147], v[42:43], v[146:147]
    v_pk_mul_f32 v[148:149], v[44:45], v[148:149]
    v_pk_mul_f32 v[150:151], v[46:47], v[150:151]
    v_exp_f32 v144, v144
    v_exp_f32 v145, v145
    v_exp_f32 v146, v146
    v_exp_f32 v147, v147
    v_exp_f32 v148, v148
    v_exp_f32 v149, v149
    v_exp_f32 v150, v150
    v_exp_f32 v151, v151
    v_pk_fma_f32 v[144:145], v[144:145], v[126:127], v[126:127]
    v_pk_fma_f32 v[146:147], v[146:147], v[126:127], v[126:127]
    v_pk_fma_f32 v[148:149], v[148:149], v[126:127], v[126:127]
    v_pk_fma_f32 v[150:151], v[150:151], v[126:127], v[126:127]
    v_rcp_f32 v144, v144
    v_rcp_f32 v145, v145
    v_rcp_f32 v146, v146
    v_rcp_f32 v147, v147
    v_rcp_f32 v148, v148
    v_rcp_f32 v149, v149
    v_rcp_f32 v150, v150
    v_rcp_f32 v151, v151
    v_pk_mul_f32 v[40:41], v[40:41], v[144:145]
    v_pk_mul_f32 v[42:43], v[42:43], v[146:147]
    v_pk_mul_f32 v[44:45], v[44:45], v[148:149]
    v_pk_mul_f32 v[46:47], v[46:47], v[150:151]
    v_cvt_pk_bf16_f32 v156, v40, v41
    v_cvt_pk_bf16_f32 v157, v42, v43
    v_cvt_pk_bf16_f32 v158, v44, v45
    v_cvt_pk_bf16_f32 v159, v46, v47
    v_cndmask_b32 v156, 0, v156, s[50:51]
    v_cndmask_b32 v157, 0, v157, s[50:51]
    v_cndmask_b32 v158, 0, v158, s[50:51]
    v_cndmask_b32 v159, 0, v159, s[50:51]
    buffer_store_dwordx4 v[156:159], v30, s[12:15], s47 offen offset:1024 sc1
    ds_read_b128 v[128:131], v29 offset:128
    ds_read_b128 v[132:135], v29 offset:160
    ds_read_b128 v[136:139], v29 offset:192
    ds_read_b128 v[140:143], v29 offset:224
    s_waitcnt lgkmcnt(0)
    v_pk_fma_f32 v[48:49], v[124:125], v[128:129], v[48:49]
    v_pk_fma_f32 v[50:51], v[124:125], v[130:131], v[50:51]
    v_pk_fma_f32 v[52:53], v[124:125], v[132:133], v[52:53]
    v_pk_fma_f32 v[54:55], v[124:125], v[134:135], v[54:55]
    v_pk_mul_f32 v[144:145], v[48:49], v[48:49]
    v_pk_mul_f32 v[146:147], v[50:51], v[50:51]
    v_pk_mul_f32 v[148:149], v[52:53], v[52:53]
    v_pk_mul_f32 v[150:151], v[54:55], v[54:55]
    v_pk_fma_f32 v[144:145], v[144:145], v[120:121], v[122:123]
    v_pk_fma_f32 v[146:147], v[146:147], v[120:121], v[122:123]
    v_pk_fma_f32 v[148:149], v[148:149], v[120:121], v[122:123]
    v_pk_fma_f32 v[150:151], v[150:151], v[120:121], v[122:123]
    v_pk_mul_f32 v[144:145], v[48:49], v[144:145]
    v_pk_mul_f32 v[146:147], v[50:51], v[146:147]
    v_pk_mul_f32 v[148:149], v[52:53], v[148:149]
    v_pk_mul_f32 v[150:151], v[54:55], v[150:151]
    v_exp_f32 v144, v144
    v_exp_f32 v145, v145
    v_exp_f32 v146, v146
    v_exp_f32 v147, v147
    v_exp_f32 v148, v148
    v_exp_f32 v149, v149
    v_exp_f32 v150, v150
    v_exp_f32 v151, v151
    v_pk_fma_f32 v[144:145], v[144:145], v[126:127], v[126:127]
    v_pk_fma_f32 v[146:147], v[146:147], v[126:127], v[126:127]
    v_pk_fma_f32 v[148:149], v[148:149], v[126:127], v[126:127]
    v_pk_fma_f32 v[150:151], v[150:151], v[126:127], v[126:127]
    v_rcp_f32 v144, v144
    v_rcp_f32 v145, v145
    v_rcp_f32 v146, v146
    v_rcp_f32 v147, v147
    v_rcp_f32 v148, v148
    v_rcp_f32 v149, v149
    v_rcp_f32 v150, v150
    v_rcp_f32 v151, v151
    v_pk_mul_f32 v[48:49], v[48:49], v[144:145]
    v_pk_mul_f32 v[50:51], v[50:51], v[146:147]
    v_pk_mul_f32 v[52:53], v[52:53], v[148:149]
    v_pk_mul_f32 v[54:55], v[54:55], v[150:151]
    v_cvt_pk_bf16_f32 v152, v48, v49
    v_cvt_pk_bf16_f32 v153, v50, v51
    v_cvt_pk_bf16_f32 v154, v52, v53
    v_cvt_pk_bf16_f32 v155, v54, v55
    v_cndmask_b32 v152, 0, v152, s[50:51]
    v_cndmask_b32 v153, 0, v153, s[50:51]
    v_cndmask_b32 v154, 0, v154, s[50:51]
    v_cndmask_b32 v155, 0, v155, s[50:51]
    buffer_store_dwordx4 v[152:155], v30, s[12:15], s47 offen offset:2048 sc1
    v_pk_fma_f32 v[56:57], v[124:125], v[136:137], v[56:57]
    v_pk_fma_f32 v[58:59], v[124:125], v[138:139], v[58:59]
    v_pk_fma_f32 v[60:61], v[124:125], v[140:141], v[60:61]
    v_pk_fma_f32 v[62:63], v[124:125], v[142:143], v[62:63]
    v_pk_mul_f32 v[144:145], v[56:57], v[56:57]
    v_pk_mul_f32 v[146:147], v[58:59], v[58:59]
    v_pk_mul_f32 v[148:149], v[60:61], v[60:61]
    v_pk_mul_f32 v[150:151], v[62:63], v[62:63]
    v_pk_fma_f32 v[144:145], v[144:145], v[120:121], v[122:123]
    v_pk_fma_f32 v[146:147], v[146:147], v[120:121], v[122:123]
    v_pk_fma_f32 v[148:149], v[148:149], v[120:121], v[122:123]
    v_pk_fma_f32 v[150:151], v[150:151], v[120:121], v[122:123]
    v_pk_mul_f32 v[144:145], v[56:57], v[144:145]
    v_pk_mul_f32 v[146:147], v[58:59], v[146:147]
    v_pk_mul_f32 v[148:149], v[60:61], v[148:149]
    v_pk_mul_f32 v[150:151], v[62:63], v[150:151]
    v_exp_f32 v144, v144
    v_exp_f32 v145, v145
    v_exp_f32 v146, v146
    v_exp_f32 v147, v147
    v_exp_f32 v148, v148
    v_exp_f32 v149, v149
    v_exp_f32 v150, v150
    v_exp_f32 v151, v151
    v_pk_fma_f32 v[144:145], v[144:145], v[126:127], v[126:127]
    v_pk_fma_f32 v[146:147], v[146:147], v[126:127], v[126:127]
    v_pk_fma_f32 v[148:149], v[148:149], v[126:127], v[126:127]
    v_pk_fma_f32 v[150:151], v[150:151], v[126:127], v[126:127]
    v_rcp_f32 v144, v144
    v_rcp_f32 v145, v145
    v_rcp_f32 v146, v146
    v_rcp_f32 v147, v147
    v_rcp_f32 v148, v148
    v_rcp_f32 v149, v149
    v_rcp_f32 v150, v150
    v_rcp_f32 v151, v151
    v_pk_mul_f32 v[56:57], v[56:57], v[144:145]
    v_pk_mul_f32 v[58:59], v[58:59], v[146:147]
    v_pk_mul_f32 v[60:61], v[60:61], v[148:149]
    v_pk_mul_f32 v[62:63], v[62:63], v[150:151]
    v_cvt_pk_bf16_f32 v156, v56, v57
    v_cvt_pk_bf16_f32 v157, v58, v59
    v_cvt_pk_bf16_f32 v158, v60, v61
    v_cvt_pk_bf16_f32 v159, v62, v63
    v_cndmask_b32 v156, 0, v156, s[50:51]
    v_cndmask_b32 v157, 0, v157, s[50:51]
    v_cndmask_b32 v158, 0, v158, s[50:51]
    v_cndmask_b32 v159, 0, v159, s[50:51]
    buffer_store_dwordx4 v[156:159], v30, s[12:15], s47 offen offset:3072 sc1
    s_add_u32 s47, s47, 4096
    ds_read_b128 v[128:131], v29 offset:256
    ds_read_b128 v[132:135], v29 offset:288
    ds_read_b128 v[136:139], v29 offset:320
    ds_read_b128 v[140:143], v29 offset:352
    s_waitcnt lgkmcnt(0)
    v_pk_fma_f32 v[64:65], v[124:125], v[128:129], v[64:65]
    v_pk_fma_f32 v[66:67], v[124:125], v[130:131], v[66:67]
    v_pk_fma_f32 v[68:69], v[124:125], v[132:133], v[68:69]
    v_pk_fma_f32 v[70:71], v[124:125], v[134:135], v[70:71]
    v_pk_mul_f32 v[144:145], v[64:65], v[64:65]
    v_pk_mul_f32 v[146:147], v[66:67], v[66:67]
    v_pk_mul_f32 v[148:149], v[68:69], v[68:69]
    v_pk_mul_f32 v[150:151], v[70:71], v[70:71]
    v_pk_fma_f32 v[144:145], v[144:145], v[120:121], v[122:123]
    v_pk_fma_f32 v[146:147], v[146:147], v[120:121], v[122:123]
    v_pk_fma_f32 v[148:149], v[148:149], v[120:121], v[122:123]
    v_pk_fma_f32 v[150:151], v[150:151], v[120:121], v[122:123]
    v_pk_mul_f32 v[144:145], v[64:65], v[144:145]
    v_pk_mul_f32 v[146:147], v[66:67], v[146:147]
    v_pk_mul_f32 v[148:149], v[68:69], v[148:149]
    v_pk_mul_f32 v[150:151], v[70:71], v[150:151]
    v_exp_f32 v144, v144
    v_exp_f32 v145, v145
    v_exp_f32 v146, v146
    v_exp_f32 v147, v147
    v_exp_f32 v148, v148
    v_exp_f32 v149, v149
    v_exp_f32 v150, v150
    v_exp_f32 v151, v151
    v_pk_fma_f32 v[144:145], v[144:145], v[126:127], v[126:127]
    v_pk_fma_f32 v[146:147], v[146:147], v[126:127], v[126:127]
    v_pk_fma_f32 v[148:149], v[148:149], v[126:127], v[126:127]
    v_pk_fma_f32 v[150:151], v[150:151], v[126:127], v[126:127]
    v_rcp_f32 v144, v144
    v_rcp_f32 v145, v145
    v_rcp_f32 v146, v146
    v_rcp_f32 v147, v147
    v_rcp_f32 v148, v148
    v_rcp_f32 v149, v149
    v_rcp_f32 v150, v150
    v_rcp_f32 v151, v151
    v_pk_mul_f32 v[64:65], v[64:65], v[144:145]
    v_pk_mul_f32 v[66:67], v[66:67], v[146:147]
    v_pk_mul_f32 v[68:69], v[68:69], v[148:149]
    v_pk_mul_f32 v[70:71], v[70:71], v[150:151]
    v_cvt_pk_bf16_f32 v152, v64, v65
    v_cvt_pk_bf16_f32 v153, v66, v67
    v_cvt_pk_bf16_f32 v154, v68, v69
    v_cvt_pk_bf16_f32 v155, v70, v71
    v_cndmask_b32 v152, 0, v152, s[50:51]
    v_cndmask_b32 v153, 0, v153, s[50:51]
    v_cndmask_b32 v154, 0, v154, s[50:51]
    v_cndmask_b32 v155, 0, v155, s[50:51]
    buffer_store_dwordx4 v[152:155], v30, s[12:15], s47 offen offset:0 sc1
    v_pk_fma_f32 v[72:73], v[124:125], v[136:137], v[72:73]
    v_pk_fma_f32 v[74:75], v[124:125], v[138:139], v[74:75]
    v_pk_fma_f32 v[76:77], v[124:125], v[140:141], v[76:77]
    v_pk_fma_f32 v[78:79], v[124:125], v[142:143], v[78:79]
    v_pk_mul_f32 v[144:145], v[72:73], v[72:73]
    v_pk_mul_f32 v[146:147], v[74:75], v[74:75]
    v_pk_mul_f32 v[148:149], v[76:77], v[76:77]
    v_pk_mul_f32 v[150:151], v[78:79], v[78:79]
    v_pk_fma_f32 v[144:145], v[144:145], v[120:121], v[122:123]
    v_pk_fma_f32 v[146:147], v[146:147], v[120:121], v[122:123]
    v_pk_fma_f32 v[148:149], v[148:149], v[120:121], v[122:123]
    v_pk_fma_f32 v[150:151], v[150:151], v[120:121], v[122:123]
    v_pk_mul_f32 v[144:145], v[72:73], v[144:145]
    v_pk_mul_f32 v[146:147], v[74:75], v[146:147]
    v_pk_mul_f32 v[148:149], v[76:77], v[148:149]
    v_pk_mul_f32 v[150:151], v[78:79], v[150:151]
    v_exp_f32 v144, v144
    v_exp_f32 v145, v145
    v_exp_f32 v146, v146
    v_exp_f32 v147, v147
    v_exp_f32 v148, v148
    v_exp_f32 v149, v149
    v_exp_f32 v150, v150
    v_exp_f32 v151, v151
    v_pk_fma_f32 v[144:145], v[144:145], v[126:127], v[126:127]
    v_pk_fma_f32 v[146:147], v[146:147], v[126:127], v[126:127]
    v_pk_fma_f32 v[148:149], v[148:149], v[126:127], v[126:127]
    v_pk_fma_f32 v[150:151], v[150:151], v[126:127], v[126:127]
    v_rcp_f32 v144, v144
    v_rcp_f32 v145, v145
    v_rcp_f32 v146, v146
    v_rcp_f32 v147, v147
    v_rcp_f32 v148, v148
    v_rcp_f32 v149, v149
    v_rcp_f32 v150, v150
    v_rcp_f32 v151, v151
    v_pk_mul_f32 v[72:73], v[72:73], v[144:145]
    v_pk_mul_f32 v[74:75], v[74:75], v[146:147]
    v_pk_mul_f32 v[76:77], v[76:77], v[148:149]
    v_pk_mul_f32 v[78:79], v[78:79], v[150:151]
    v_cvt_pk_bf16_f32 v156, v72, v73
    v_cvt_pk_bf16_f32 v157, v74, v75
    v_cvt_pk_bf16_f32 v158, v76, v77
    v_cvt_pk_bf16_f32 v159, v78, v79
    v_cndmask_b32 v156, 0, v156, s[50:51]
    v_cndmask_b32 v157, 0, v157, s[50:51]
    v_cndmask_b32 v158, 0, v158, s[50:51]
    v_cndmask_b32 v159, 0, v159, s[50:51]
    buffer_store_dwordx4 v[156:159], v30, s[12:15], s47 offen offset:1024 sc1
    ds_read_b128 v[128:131], v29 offset:384
    ds_read_b128 v[132:135], v29 offset:416
    ds_read_b128 v[136:139], v29 offset:448
    ds_read_b128 v[140:143], v29 offset:480
    s_waitcnt lgkmcnt(0)
    v_pk_fma_f32 v[80:81], v[124:125], v[128:129], v[80:81]
    v_pk_fma_f32 v[82:83], v[124:125], v[130:131], v[82:83]
    v_pk_fma_f32 v[84:85], v[124:125], v[132:133], v[84:85]
    v_pk_fma_f32 v[86:87], v[124:125], v[134:135], v[86:87]
    v_pk_mul_f32 v[144:145], v[80:81], v[80:81]
    v_pk_mul_f32 v[146:147], v[82:83], v[82:83]
    v_pk_mul_f32 v[148:149], v[84:85], v[84:85]
    v_pk_mul_f32 v[150:151], v[86:87], v[86:87]
    v_pk_fma_f32 v[144:145], v[144:145], v[120:121], v[122:123]
    v_pk_fma_f32 v[146:147], v[146:147], v[120:121], v[122:123]
    v_pk_fma_f32 v[148:149], v[148:149], v[120:121], v[122:123]
    v_pk_fma_f32 v[150:151], v[150:151], v[120:121], v[122:123]
    v_pk_mul_f32 v[144:145], v[80:81], v[144:145]
    v_pk_mul_f32 v[146:147], v[82:83], v[146:147]
    v_pk_mul_f32 v[148:149], v[84:85], v[148:149]
    v_pk_mul_f32 v[150:151], v[86:87], v[150:151]
    v_exp_f32 v144, v144
    v_exp_f32 v145, v145
    v_exp_f32 v146, v146
    v_exp_f32 v147, v147
    v_exp_f32 v148, v148
    v_exp_f32 v149, v149
    v_exp_f32 v150, v150
    v_exp_f32 v151, v151
    v_pk_fma_f32 v[144:145], v[144:145], v[126:127], v[126:127]
    v_pk_fma_f32 v[146:147], v[146:147], v[126:127], v[126:127]
    v_pk_fma_f32 v[148:149], v[148:149], v[126:127], v[126:127]
    v_pk_fma_f32 v[150:151], v[150:151], v[126:127], v[126:127]
    v_rcp_f32 v144, v144
    v_rcp_f32 v145, v145
    v_rcp_f32 v146, v146
    v_rcp_f32 v147, v147
    v_rcp_f32 v148, v148
    v_rcp_f32 v149, v149
    v_rcp_f32 v150, v150
    v_rcp_f32 v151, v151
    v_pk_mul_f32 v[80:81], v[80:81], v[144:145]
    v_pk_mul_f32 v[82:83], v[82:83], v[146:147]
    v_pk_mul_f32 v[84:85], v[84:85], v[148:149]
    v_pk_mul_f32 v[86:87], v[86:87], v[150:151]
    v_cvt_pk_bf16_f32 v152, v80, v81
    v_cvt_pk_bf16_f32 v153, v82, v83
    v_cvt_pk_bf16_f32 v154, v84, v85
    v_cvt_pk_bf16_f32 v155, v86, v87
    v_cndmask_b32 v152, 0, v152, s[50:51]
    v_cndmask_b32 v153, 0, v153, s[50:51]
    v_cndmask_b32 v154, 0, v154, s[50:51]
    v_cndmask_b32 v155, 0, v155, s[50:51]
    buffer_store_dwordx4 v[152:155], v30, s[12:15], s47 offen offset:2048 sc1
    v_pk_fma_f32 v[88:89], v[124:125], v[136:137], v[88:89]
    v_pk_fma_f32 v[90:91], v[124:125], v[138:139], v[90:91]
    v_pk_fma_f32 v[92:93], v[124:125], v[140:141], v[92:93]
    v_pk_fma_f32 v[94:95], v[124:125], v[142:143], v[94:95]
    v_pk_mul_f32 v[144:145], v[88:89], v[88:89]
    v_pk_mul_f32 v[146:147], v[90:91], v[90:91]
    v_pk_mul_f32 v[148:149], v[92:93], v[92:93]
    v_pk_mul_f32 v[150:151], v[94:95], v[94:95]
    v_pk_fma_f32 v[144:145], v[144:145], v[120:121], v[122:123]
    v_pk_fma_f32 v[146:147], v[146:147], v[120:121], v[122:123]
    v_pk_fma_f32 v[148:149], v[148:149], v[120:121], v[122:123]
    v_pk_fma_f32 v[150:151], v[150:151], v[120:121], v[122:123]
    v_pk_mul_f32 v[144:145], v[88:89], v[144:145]
    v_pk_mul_f32 v[146:147], v[90:91], v[146:147]
    v_pk_mul_f32 v[148:149], v[92:93], v[148:149]
    v_pk_mul_f32 v[150:151], v[94:95], v[150:151]
    v_exp_f32 v144, v144
    v_exp_f32 v145, v145
    v_exp_f32 v146, v146
    v_exp_f32 v147, v147
    v_exp_f32 v148, v148
    v_exp_f32 v149, v149
    v_exp_f32 v150, v150
    v_exp_f32 v151, v151
    v_pk_fma_f32 v[144:145], v[144:145], v[126:127], v[126:127]
    v_pk_fma_f32 v[146:147], v[146:147], v[126:127], v[126:127]
    v_pk_fma_f32 v[148:149], v[148:149], v[126:127], v[126:127]
    v_pk_fma_f32 v[150:151], v[150:151], v[126:127], v[126:127]
    v_rcp_f32 v144, v144
    v_rcp_f32 v145, v145
    v_rcp_f32 v146, v146
    v_rcp_f32 v147, v147
    v_rcp_f32 v148, v148
    v_rcp_f32 v149, v149
    v_rcp_f32 v150, v150
    v_rcp_f32 v151, v151
    v_pk_mul_f32 v[88:89], v[88:89], v[144:145]
    v_pk_mul_f32 v[90:91], v[90:91], v[146:147]
    v_pk_mul_f32 v[92:93], v[92:93], v[148:149]
    v_pk_mul_f32 v[94:95], v[94:95], v[150:151]
    v_cvt_pk_bf16_f32 v156, v88, v89
    v_cvt_pk_bf16_f32 v157, v90, v91
    v_cvt_pk_bf16_f32 v158, v92, v93
    v_cvt_pk_bf16_f32 v159, v94, v95
    v_cndmask_b32 v156, 0, v156, s[50:51]
    v_cndmask_b32 v157, 0, v157, s[50:51]
    v_cndmask_b32 v158, 0, v158, s[50:51]
    v_cndmask_b32 v159, 0, v159, s[50:51]
    buffer_store_dwordx4 v[156:159], v30, s[12:15], s47 offen offset:3072 sc1
    s_add_u32 s47, s47, 4096
    ds_read_b128 v[128:131], v29 offset:512
    ds_read_b128 v[132:135], v29 offset:544
    s_waitcnt lgkmcnt(0)
    v_pk_fma_f32 v[96:97], v[124:125], v[128:129], v[96:97]
    v_pk_fma_f32 v[98:99], v[124:125], v[130:131], v[98:99]
    v_pk_fma_f32 v[100:101], v[124:125], v[132:133], v[100:101]
    v_pk_fma_f32 v[102:103], v[124:125], v[134:135], v[102:103]
    v_pk_mul_f32 v[144:145], v[96:97], v[96:97]
    v_pk_mul_f32 v[146:147], v[98:99], v[98:99]
    v_pk_mul_f32 v[148:149], v[100:101], v[100:101]
    v_pk_mul_f32 v[150:151], v[102:103], v[102:103]
    v_pk_fma_f32 v[144:145], v[144:145], v[120:121], v[122:123]
    v_pk_fma_f32 v[146:147], v[146:147], v[120:121], v[122:123]
    v_pk_fma_f32 v[148:149], v[148:149], v[120:121], v[122:123]
    v_pk_fma_f32 v[150:151], v[150:151], v[120:121], v[122:123]
    v_pk_mul_f32 v[144:145], v[96:97], v[144:145]
    v_pk_mul_f32 v[146:147], v[98:99], v[146:147]
    v_pk_mul_f32 v[148:149], v[100:101], v[148:149]
    v_pk_mul_f32 v[150:151], v[102:103], v[150:151]
    v_exp_f32 v144, v144
    v_exp_f32 v145, v145
    v_exp_f32 v146, v146
    v_exp_f32 v147, v147
    v_exp_f32 v148, v148
    v_exp_f32 v149, v149
    v_exp_f32 v150, v150
    v_exp_f32 v151, v151
    v_pk_fma_f32 v[144:145], v[144:145], v[126:127], v[126:127]
    v_pk_fma_f32 v[146:147], v[146:147], v[126:127], v[126:127]
    v_pk_fma_f32 v[148:149], v[148:149], v[126:127], v[126:127]
    v_pk_fma_f32 v[150:151], v[150:151], v[126:127], v[126:127]
    v_rcp_f32 v144, v144
    v_rcp_f32 v145, v145
    v_rcp_f32 v146, v146
    v_rcp_f32 v147, v147
    v_rcp_f32 v148, v148
    v_rcp_f32 v149, v149
    v_rcp_f32 v150, v150
    v_rcp_f32 v151, v151
    v_pk_mul_f32 v[96:97], v[96:97], v[144:145]
    v_pk_mul_f32 v[98:99], v[98:99], v[146:147]
    v_pk_mul_f32 v[100:101], v[100:101], v[148:149]
    v_pk_mul_f32 v[102:103], v[102:103], v[150:151]
    v_cvt_pk_bf16_f32 v152, v96, v97
    v_cvt_pk_bf16_f32 v153, v98, v99
    v_cvt_pk_bf16_f32 v154, v100, v101
    v_cvt_pk_bf16_f32 v155, v102, v103
    v_cndmask_b32 v152, 0, v152, s[50:51]
    v_cndmask_b32 v153, 0, v153, s[50:51]
    v_cndmask_b32 v154, 0, v154, s[50:51]
    v_cndmask_b32 v155, 0, v155, s[50:51]
    buffer_store_dwordx4 v[152:155], v30, s[12:15], s47 offen offset:0 sc1
    s_mul_i32 s48, s9, 128
    s_add_u32 s48, s48, 6272
    s_and_b32 s49, s11, 1
    s_lshl_b32 s49, s49, 1
    s_sub_u32 s49, 1, s49
    s_add_u32 s49, s49, s9
    s_and_b32 s49, s49, 15
    s_mul_i32 s49, s49, 128
    s_add_u32 s49, s49, 6272
    s_mov_b64 exec, -1
    s_load_dwordx2 s[46:47], s[0:1], 80
    s_add_u32 s34, s4, 39608320
    s_addc_u32 s35, s5, 0
    v_mov_b32 v248, 0
    v_mov_b32 v249, 0
    s_waitcnt lgkmcnt(0)
    s_cmp_eq_u32 s8, 0
    s_cbranch_scc0 Lp1_3400_a
    global_load_dword v249, v248, s[46:47] sc1
Lp1_3400_a:
    s_waitcnt vmcnt(0)
    s_barrier
    s_cmp_eq_u32 s8, 0
    s_cbranch_scc0 Lp1_3400_z
    s_mov_b32 s50, 0x40000
Lp1_3400_b:
    v_readfirstlane_b32 s52, v249
    s_cmp_lg_u32 s52, 0
    s_cbranch_scc1 Lp1_3400_c
    global_load_dword v249, v248, s[46:47] sc1
    s_waitcnt vmcnt(0)
    s_sub_u32 s50, s50, 1
    s_cmp_lg_u32 s50, 0
    s_cbranch_scc1 Lp1_3400_b
Lp1_3400_c:
    s_mov_b64 exec, 1
    v_mov_b32 v251, 1
    v_mov_b32 v250, s48
    global_atomic_add v250, v251, s[34:35] sc1
    v_mov_b32 v250, s49
    global_atomic_add v250, v251, s[34:35] sc1
    s_mov_b64 exec, -1
Lp1_3400_z:
    s_branch K_pre_h
K_pre:
    s_cmp_eq_u32 s67, 2
    s_cbranch_scc1 K_pre_r
    s_lshl_b32 s9, s64, 2
    s_add_u32 s9, s9, s8
    s_lshl_b32 s33, s65, 1
    s_lshl_b32 s10, s65, 7
    s_lshl_b32 s11, s65, 2
    s_load_dwordx2 s[26:27], s[0:1], 0
    v_lshlrev_b32 v1, 4, v0
    s_waitcnt lgkmcnt(0)
    s_mov_b32 s20, s26
    s_and_b32 s21, s27, 0xffff
    s_mov_b32 s22, 2359296
    s_mov_b32 s23, 0x20000
    v_lshrrev_b32 v5, 5, v0
    v_bfe_u32 v6, v0, 4, 1
    v_bfe_u32 v7, v0, 2, 2
    v_and_b32 v8, 1, v0
    v_lshlrev_b32 v8, 1, v8
    v_bfe_u32 v15, v0, 1, 1
    v_or_b32 v8, v8, v15
    v_lshlrev_b32 v9, 1, v6
    v_lshrrev_b32 v10, 1, v8
    v_add_u32 v9, v9, v10
    v_lshrrev_b32 v10, 1, v7
    v_lshlrev_b32 v10, 2, v10
    v_xor_b32 v9, v9, v10
    v_lshlrev_b32 v9, 4, v9
    v_and_b32 v10, 1, v8
    v_lshlrev_b32 v10, 3, v10
    v_add_u32 v9, v9, v10
    v_lshlrev_b32 v10, 3, v5
    v_add_u32 v10, v10, v7
    v_lshlrev_b32 v10, 7, v10
    v_add_u32 v9, v9, v10
    v_xor_b32 v10, 64, v9
    v_add_u32 v13, 36864, v9
    v_add_u32 v14, 36864, v10
    v_and_b32 v11, 31, v0
    s_movk_i32 s32, 1152
    v_mul_lo_u32 v12, v11, s32
    v_lshlrev_b32 v4, 4, v5
    v_add_u32 v12, v12, v4
    s_mul_i32 s41, s9, 36864
    s_add_u32 s41, s41, s10
    buffer_load_dwordx4 v[112:115], v12, s[20:23], s41 offen offset:0
    buffer_load_dwordx4 v[116:119], v12, s[20:23], s41 offen offset:32
    buffer_load_dwordx4 v[120:123], v12, s[20:23], s41 offen offset:64
    buffer_load_dwordx4 v[124:127], v12, s[20:23], s41 offen offset:96
    s_mul_i32 s48, s64, 128
    s_add_u32 s48, s48, 6272
    s_cmp_eq_u32 s8, 0
    s_cbranch_scc0 Lwait_3487_done
    s_mov_b32 s50, 0x40000
    s_mov_b64 exec, 1
    v_mov_b32 v246, s48
Lwait_3487:
    global_load_dword v250, v246, s[34:35] sc1
    s_waitcnt vmcnt(0)
    s_mov_b32 s51, 1
    v_readfirstlane_b32 s52, v250
    s_cmp_ge_u32 s52, 8
    s_cselect_b32 s51, s51, 0
    s_cmp_eq_u32 s51, 1
    s_cbranch_scc1 Lwait_3487_ok
    s_sub_u32 s50, s50, 1
    s_cmp_lg_u32 s50, 0
    s_cbranch_scc1 Lwait_3487
Lwait_3487_ok:
    s_mov_b64 exec, -1
Lwait_3487_done:
    s_waitcnt vmcnt(0)
    s_barrier
    s_mul_i32 s40, s9, 36864
    s_add_u32 s40, s40, 7208960
    buffer_load_dwordx4 a[0:3], v1, s[12:15], s40 offen offset:0 sc1
    buffer_load_dwordx4 a[4:7], v1, s[12:15], s40 offen offset:1024 sc1
    buffer_load_dwordx4 a[8:11], v1, s[12:15], s40 offen offset:2048 sc1
    buffer_load_dwordx4 a[12:15], v1, s[12:15], s40 offen offset:3072 sc1
    s_add_u32 s40, s40, 4096
    buffer_load_dwordx4 a[16:19], v1, s[12:15], s40 offen offset:0 sc1
    buffer_load_dwordx4 a[20:23], v1, s[12:15], s40 offen offset:1024 sc1
    buffer_load_dwordx4 a[24:27], v1, s[12:15], s40 offen offset:2048 sc1
    buffer_load_dwordx4 a[28:31], v1, s[12:15], s40 offen offset:3072 sc1
    s_add_u32 s40, s40, 4096
    buffer_load_dwordx4 a[32:35], v1, s[12:15], s40 offen offset:0 sc1
    buffer_load_dwordx4 a[36:39], v1, s[12:15], s40 offen offset:1024 sc1
    buffer_load_dwordx4 a[40:43], v1, s[12:15], s40 offen offset:2048 sc1
    buffer_load_dwordx4 a[44:47], v1, s[12:15], s40 offen offset:3072 sc1
    s_add_u32 s40, s40, 4096
    buffer_load_dwordx4 a[48:51], v1, s[12:15], s40 offen offset:0 sc1
    buffer_load_dwordx4 a[52:55], v1, s[12:15], s40 offen offset:1024 sc1
    buffer_load_dwordx4 a[56:59], v1, s[12:15], s40 offen offset:2048 sc1
    buffer_load_dwordx4 a[60:63], v1, s[12:15], s40 offen offset:3072 sc1
    s_add_u32 s40, s40, 4096
    buffer_load_dwordx4 a[64:67], v1, s[12:15], s40 offen offset:0 sc1
    buffer_load_dwordx4 a[68:71], v1, s[12:15], s40 offen offset:1024 sc1
    buffer_load_dwordx4 a[72:75], v1, s[12:15], s40 offen offset:2048 sc1
    buffer_load_dwordx4 a[76:79], v1, s[12:15], s40 offen offset:3072 sc1
    s_add_u32 s40, s40, 4096
    buffer_load_dwordx4 a[80:83], v1, s[12:15], s40 offen offset:0 sc1
    buffer_load_dwordx4 a[84:87], v1, s[12:15], s40 offen offset:1024 sc1
    buffer_load_dwordx4 a[88:91], v1, s[12:15], s40 offen offset:2048 sc1
    buffer_load_dwordx4 a[92:95], v1, s[12:15], s40 offen offset:3072 sc1
    s_add_u32 s40, s40, 4096
    buffer_load_dwordx4 a[96:99], v1, s[12:15], s40 offen offset:0 sc1
    buffer_load_dwordx4 a[100:103], v1, s[12:15], s40 offen offset:1024 sc1
    buffer_load_dwordx4 a[104:107], v1, s[12:15], s40 offen offset:2048 sc1
    buffer_load_dwordx4 a[108:111], v1, s[12:15], s40 offen offset:3072 sc1
    s_add_u32 s40, s40, 4096
    buffer_load_dwordx4 a[112:115], v1, s[12:15], s40 offen offset:0 sc1
    buffer_load_dwordx4 a[116:119], v1, s[12:15], s40 offen offset:1024 sc1
    buffer_load_dwordx4 a[120:123], v1, s[12:15], s40 offen offset:2048 sc1
    buffer_load_dwordx4 a[124:127], v1, s[12:15], s40 offen offset:3072 sc1
    s_add_u32 s40, s40, 4096
    buffer_load_dwordx4 a[128:131], v1, s[12:15], s40 offen offset:0 sc1
    buffer_load_dwordx4 a[132:135], v1, s[12:15], s40 offen offset:1024 sc1
    buffer_load_dwordx4 a[136:139], v1, s[12:15], s40 offen offset:2048 sc1
    buffer_load_dwordx4 a[140:143], v1, s[12:15], s40 offen offset:3072 sc1
    ds_read_b64_tr_b16 v[64:65], v9 offset:0
    ds_read_b64_tr_b16 v[66:67], v9 offset:512
    ds_read_b64_tr_b16 v[68:69], v10 offset:0
    ds_read_b64_tr_b16 v[70:71], v10 offset:512
    ds_read_b64_tr_b16 v[72:73], v9 offset:2048
    ds_read_b64_tr_b16 v[74:75], v9 offset:2560
    ds_read_b64_tr_b16 v[76:77], v10 offset:2048
    ds_read_b64_tr_b16 v[78:79], v10 offset:2560
    ds_read_b64_tr_b16 v[80:81], v9 offset:4096
    ds_read_b64_tr_b16 v[82:83], v9 offset:4608
    ds_read_b64_tr_b16 v[84:85], v10 offset:4096
    ds_read_b64_tr_b16 v[86:87], v10 offset:4608
    s_waitcnt vmcnt(32)
    s_waitcnt lgkmcnt(8)
    v_mfma_f32_32x32x16_bf16 v[16:31], v[64:67], a[0:3], 0
    ds_read_b64_tr_b16 v[88:89], v9 offset:6144
    ds_read_b64_tr_b16 v[90:91], v9 offset:6656
    v_mfma_f32_32x32x16_bf16 v[32:47], v[68:71], a[0:3], 0
    ds_read_b64_tr_b16 v[92:93], v10 offset:6144
    ds_read_b64_tr_b16 v[94:95], v10 offset:6656
    s_waitcnt lgkmcnt(8)
    v_mfma_f32_32x32x16_bf16 v[16:31], v[72:75], a[4:7], v[16:31]
    ds_read_b64_tr_b16 v[64:65], v9 offset:8192
    ds_read_b64_tr_b16 v[66:67], v9 offset:8704
    v_mfma_f32_32x32x16_bf16 v[32:47], v[76:79], a[4:7], v[32:47]
    ds_read_b64_tr_b16 v[68:69], v10 offset:8192
    ds_read_b64_tr_b16 v[70:71], v10 offset:8704
    s_waitcnt lgkmcnt(8)
    v_mfma_f32_32x32x16_bf16 v[16:31], v[80:83], a[8:11], v[16:31]
    ds_read_b64_tr_b16 v[72:73], v9 offset:10240
    ds_read_b64_tr_b16 v[74:75], v9 offset:10752
    v_mfma_f32_32x32x16_bf16 v[32:47], v[84:87], a[8:11], v[32:47]
    ds_read_b64_tr_b16 v[76:77], v10 offset:10240
    ds_read_b64_tr_b16 v[78:79], v10 offset:10752
    s_waitcnt lgkmcnt(8)
    v_mfma_f32_32x32x16_bf16 v[16:31], v[88:91], a[12:15], v[16:31]
    ds_read_b64_tr_b16 v[80:81], v9 offset:12288
    ds_read_b64_tr_b16 v[82:83], v9 offset:12800
    v_mfma_f32_32x32x16_bf16 v[32:47], v[92:95], a[12:15], v[32:47]
    ds_read_b64_tr_b16 v[84:85], v10 offset:12288
    ds_read_b64_tr_b16 v[86:87], v10 offset:12800
    s_waitcnt vmcnt(28)
    s_waitcnt lgkmcnt(8)
    v_mfma_f32_32x32x16_bf16 v[16:31], v[64:67], a[16:19], v[16:31]
    ds_read_b64_tr_b16 v[88:89], v9 offset:14336
    ds_read_b64_tr_b16 v[90:91], v9 offset:14848
    v_mfma_f32_32x32x16_bf16 v[32:47], v[68:71], a[16:19], v[32:47]
    ds_read_b64_tr_b16 v[92:93], v10 offset:14336
    ds_read_b64_tr_b16 v[94:95], v10 offset:14848
    s_waitcnt lgkmcnt(8)
    v_mfma_f32_32x32x16_bf16 v[16:31], v[72:75], a[20:23], v[16:31]
    ds_read_b64_tr_b16 v[64:65], v9 offset:16384
    ds_read_b64_tr_b16 v[66:67], v9 offset:16896
    v_mfma_f32_32x32x16_bf16 v[32:47], v[76:79], a[20:23], v[32:47]
    ds_read_b64_tr_b16 v[68:69], v10 offset:16384
    ds_read_b64_tr_b16 v[70:71], v10 offset:16896
    s_waitcnt lgkmcnt(8)
    v_mfma_f32_32x32x16_bf16 v[16:31], v[80:83], a[24:27], v[16:31]
    ds_read_b64_tr_b16 v[72:73], v9 offset:18432
    ds_read_b64_tr_b16 v[74:75], v9 offset:18944
    v_mfma_f32_32x32x16_bf16 v[32:47], v[84:87], a[24:27], v[32:47]
    ds_read_b64_tr_b16 v[76:77], v10 offset:18432
    ds_read_b64_tr_b16 v[78:79], v10 offset:18944
    s_waitcnt lgkmcnt(8)
    v_mfma_f32_32x32x16_bf16 v[16:31], v[88:91], a[28:31], v[16:31]
    ds_read_b64_tr_b16 v[80:81], v9 offset:20480
    ds_read_b64_tr_b16 v[82:83], v9 offset:20992
    v_mfma_f32_32x32x16_bf16 v[32:47], v[92:95], a[28:31], v[32:47]
    ds_read_b64_tr_b16 v[84:85], v10 offset:20480
    ds_read_b64_tr_b16 v[86:87], v10 offset:20992
    s_waitcnt vmcnt(24)
    s_waitcnt lgkmcnt(8)
    v_mfma_f32_32x32x16_bf16 v[16:31], v[64:67], a[32:35], v[16:31]
    ds_read_b64_tr_b16 v[88:89], v9 offset:22528
    ds_read_b64_tr_b16 v[90:91], v9 offset:23040
    v_mfma_f32_32x32x16_bf16 v[32:47], v[68:71], a[32:35], v[32:47]
    ds_read_b64_tr_b16 v[92:93], v10 offset:22528
    ds_read_b64_tr_b16 v[94:95], v10 offset:23040
    s_waitcnt lgkmcnt(8)
    v_mfma_f32_32x32x16_bf16 v[16:31], v[72:75], a[36:39], v[16:31]
    ds_read_b64_tr_b16 v[64:65], v9 offset:24576
    ds_read_b64_tr_b16 v[66:67], v9 offset:25088
    v_mfma_f32_32x32x16_bf16 v[32:47], v[76:79], a[36:39], v[32:47]
    ds_read_b64_tr_b16 v[68:69], v10 offset:24576
    ds_read_b64_tr_b16 v[70:71], v10 offset:25088
    s_waitcnt lgkmcnt(8)
    v_mfma_f32_32x32x16_bf16 v[16:31], v[80:83], a[40:43], v[16:31]
    ds_read_b64_tr_b16 v[72:73], v9 offset:26624
    ds_read_b64_tr_b16 v[74:75], v9 offset:27136
    v_mfma_f32_32x32x16_bf16 v[32:47], v[84:87], a[40:43], v[32:47]
    ds_read_b64_tr_b16 v[76:77], v10 offset:26624
    ds_read_b64_tr_b16 v[78:79], v10 offset:27136
    s_waitcnt lgkmcnt(8)
    v_mfma_f32_32x32x16_bf16 v[16:31], v[88:91], a[44:47], v[16:31]
    ds_read_b64_tr_b16 v[80:81], v9 offset:28672
    ds_read_b64_tr_b16 v[82:83], v9 offset:29184
    v_mfma_f32_32x32x16_bf16 v[32:47], v[92:95], a[44:47], v[32:47]
    ds_read_b64_tr_b16 v[84:85], v10 offset:28672
    ds_read_b64_tr_b16 v[86:87], v10 offset:29184
    s_waitcnt vmcnt(20)
    s_waitcnt lgkmcnt(8)
    v_mfma_f32_32x32x16_bf16 v[16:31], v[64:67], a[48:51], v[16:31]
    ds_read_b64_tr_b16 v[88:89], v9 offset:30720
    ds_read_b64_tr_b16 v[90:91], v9 offset:31232
    v_mfma_f32_32x32x16_bf16 v[32:47], v[68:71], a[48:51], v[32:47]
    ds_read_b64_tr_b16 v[92:93], v10 offset:30720
    ds_read_b64_tr_b16 v[94:95], v10 offset:31232
    s_waitcnt lgkmcnt(8)
    v_mfma_f32_32x32x16_bf16 v[16:31], v[72:75], a[52:55], v[16:31]
    ds_read_b64_tr_b16 v[64:65], v9 offset:32768
    ds_read_b64_tr_b16 v[66:67], v9 offset:33280
    v_mfma_f32_32x32x16_bf16 v[32:47], v[76:79], a[52:55], v[32:47]
    ds_read_b64_tr_b16 v[68:69], v10 offset:32768
    ds_read_b64_tr_b16 v[70:71], v10 offset:33280
    s_waitcnt lgkmcnt(8)
    v_mfma_f32_32x32x16_bf16 v[16:31], v[80:83], a[56:59], v[16:31]
    ds_read_b64_tr_b16 v[72:73], v9 offset:34816
    ds_read_b64_tr_b16 v[74:75], v9 offset:35328
    v_mfma_f32_32x32x16_bf16 v[32:47], v[84:87], a[56:59], v[32:47]
    ds_read_b64_tr_b16 v[76:77], v10 offset:34816
    ds_read_b64_tr_b16 v[78:79], v10 offset:35328
    s_waitcnt lgkmcnt(8)
    v_mfma_f32_32x32x16_bf16 v[16:31], v[88:91], a[60:63], v[16:31]
    ds_read_b64_tr_b16 v[80:81], v13 offset:0
    ds_read_b64_tr_b16 v[82:83], v13 offset:512
    v_mfma_f32_32x32x16_bf16 v[32:47], v[92:95], a[60:63], v[32:47]
    ds_read_b64_tr_b16 v[84:85], v14 offset:0
    ds_read_b64_tr_b16 v[86:87], v14 offset:512
    s_waitcnt vmcnt(16)
    s_waitcnt lgkmcnt(8)
    v_mfma_f32_32x32x16_bf16 v[16:31], v[64:67], a[64:67], v[16:31]
    ds_read_b64_tr_b16 v[88:89], v13 offset:2048
    ds_read_b64_tr_b16 v[90:91], v13 offset:2560
    v_mfma_f32_32x32x16_bf16 v[32:47], v[68:71], a[64:67], v[32:47]
    ds_read_b64_tr_b16 v[92:93], v14 offset:2048
    ds_read_b64_tr_b16 v[94:95], v14 offset:2560
    s_waitcnt lgkmcnt(8)
    v_mfma_f32_32x32x16_bf16 v[16:31], v[72:75], a[68:71], v[16:31]
    ds_read_b64_tr_b16 v[64:65], v13 offset:4096
    ds_read_b64_tr_b16 v[66:67], v13 offset:4608
    v_mfma_f32_32x32x16_bf16 v[32:47], v[76:79], a[68:71], v[32:47]
    ds_read_b64_tr_b16 v[68:69], v14 offset:4096
    ds_read_b64_tr_b16 v[70:71], v14 offset:4608
    s_waitcnt lgkmcnt(8)
    v_mfma_f32_32x32x16_bf16 v[16:31], v[80:83], a[72:75], v[16:31]
    ds_read_b64_tr_b16 v[72:73], v13 offset:6144
    ds_read_b64_tr_b16 v[74:75], v13 offset:6656
    v_mfma_f32_32x32x16_bf16 v[32:47], v[84:87], a[72:75], v[32:47]
    ds_read_b64_tr_b16 v[76:77], v14 offset:6144
    ds_read_b64_tr_b16 v[78:79], v14 offset:6656
    s_waitcnt lgkmcnt(8)
    v_mfma_f32_32x32x16_bf16 v[16:31], v[88:91], a[76:79], v[16:31]
    ds_read_b64_tr_b16 v[80:81], v13 offset:8192
    ds_read_b64_tr_b16 v[82:83], v13 offset:8704
    v_mfma_f32_32x32x16_bf16 v[32:47], v[92:95], a[76:79], v[32:47]
    ds_read_b64_tr_b16 v[84:85], v14 offset:8192
    ds_read_b64_tr_b16 v[86:87], v14 offset:8704
    s_waitcnt vmcnt(12)
    s_waitcnt lgkmcnt(8)
    v_mfma_f32_32x32x16_bf16 v[16:31], v[64:67], a[80:83], v[16:31]
    ds_read_b64_tr_b16 v[88:89], v13 offset:10240
    ds_read_b64_tr_b16 v[90:91], v13 offset:10752
    v_mfma_f32_32x32x16_bf16 v[32:47], v[68:71], a[80:83], v[32:47]
    ds_read_b64_tr_b16 v[92:93], v14 offset:10240
    ds_read_b64_tr_b16 v[94:95], v14 offset:10752
    s_waitcnt lgkmcnt(8)
    v_mfma_f32_32x32x16_bf16 v[16:31], v[72:75], a[84:87], v[16:31]
    ds_read_b64_tr_b16 v[64:65], v13 offset:12288
    ds_read_b64_tr_b16 v[66:67], v13 offset:12800
    v_mfma_f32_32x32x16_bf16 v[32:47], v[76:79], a[84:87], v[32:47]
    ds_read_b64_tr_b16 v[68:69], v14 offset:12288
    ds_read_b64_tr_b16 v[70:71], v14 offset:12800
    s_waitcnt lgkmcnt(8)
    v_mfma_f32_32x32x16_bf16 v[16:31], v[80:83], a[88:91], v[16:31]
    ds_read_b64_tr_b16 v[72:73], v13 offset:14336
    ds_read_b64_tr_b16 v[74:75], v13 offset:14848
    v_mfma_f32_32x32x16_bf16 v[32:47], v[84:87], a[88:91], v[32:47]
    ds_read_b64_tr_b16 v[76:77], v14 offset:14336
    ds_read_b64_tr_b16 v[78:79], v14 offset:14848
    s_waitcnt lgkmcnt(8)
    v_mfma_f32_32x32x16_bf16 v[16:31], v[88:91], a[92:95], v[16:31]
    ds_read_b64_tr_b16 v[80:81], v13 offset:16384
    ds_read_b64_tr_b16 v[82:83], v13 offset:16896
    v_mfma_f32_32x32x16_bf16 v[32:47], v[92:95], a[92:95], v[32:47]
    ds_read_b64_tr_b16 v[84:85], v14 offset:16384
    ds_read_b64_tr_b16 v[86:87], v14 offset:16896
    s_waitcnt vmcnt(8)
    s_waitcnt lgkmcnt(8)
    v_mfma_f32_32x32x16_bf16 v[16:31], v[64:67], a[96:99], v[16:31]
    ds_read_b64_tr_b16 v[88:89], v13 offset:18432
    ds_read_b64_tr_b16 v[90:91], v13 offset:18944
    v_mfma_f32_32x32x16_bf16 v[32:47], v[68:71], a[96:99], v[32:47]
    ds_read_b64_tr_b16 v[92:93], v14 offset:18432
    ds_read_b64_tr_b16 v[94:95], v14 offset:18944
    s_waitcnt lgkmcnt(8)
    v_mfma_f32_32x32x16_bf16 v[16:31], v[72:75], a[100:103], v[16:31]
    ds_read_b64_tr_b16 v[64:65], v13 offset:20480
    ds_read_b64_tr_b16 v[66:67], v13 offset:20992
    v_mfma_f32_32x32x16_bf16 v[32:47], v[76:79], a[100:103], v[32:47]
    ds_read_b64_tr_b16 v[68:69], v14 offset:20480
    ds_read_b64_tr_b16 v[70:71], v14 offset:20992
    s_waitcnt lgkmcnt(8)
    v_mfma_f32_32x32x16_bf16 v[16:31], v[80:83], a[104:107], v[16:31]
    ds_read_b64_tr_b16 v[72:73], v13 offset:22528
    ds_read_b64_tr_b16 v[74:75], v13 offset:23040
    v_mfma_f32_32x32x16_bf16 v[32:47], v[84:87], a[104:107], v[32:47]
    ds_read_b64_tr_b16 v[76:77], v14 offset:22528
    ds_read_b64_tr_b16 v[78:79], v14 offset:23040
    s_waitcnt lgkmcnt(8)
    v_mfma_f32_32x32x16_bf16 v[16:31], v[88:91], a[108:111], v[16:31]
    ds_read_b64_tr_b16 v[80:81], v13 offset:24576
    ds_read_b64_tr_b16 v[82:83], v13 offset:25088
    v_mfma_f32_32x32x16_bf16 v[32:47], v[92:95], a[108:111], v[32:47]
    ds_read_b64_tr_b16 v[84:85], v14 offset:24576
    ds_read_b64_tr_b16 v[86:87], v14 offset:25088
    s_waitcnt vmcnt(4)
    s_waitcnt lgkmcnt(8)
    v_mfma_f32_32x32x16_bf16 v[16:31], v[64:67], a[112:115], v[16:31]
    ds_read_b64_tr_b16 v[88:89], v13 offset:26624
    ds_read_b64_tr_b16 v[90:91], v13 offset:27136
    v_mfma_f32_32x32x16_bf16 v[32:47], v[68:71], a[112:115], v[32:47]
    ds_read_b64_tr_b16 v[92:93], v14 offset:26624
    ds_read_b64_tr_b16 v[94:95], v14 offset:27136
    s_waitcnt lgkmcnt(8)
    v_mfma_f32_32x32x16_bf16 v[16:31], v[72:75], a[116:119], v[16:31]
    ds_read_b64_tr_b16 v[64:65], v13 offset:28672
    ds_read_b64_tr_b16 v[66:67], v13 offset:29184
    v_mfma_f32_32x32x16_bf16 v[32:47], v[76:79], a[116:119], v[32:47]
    ds_read_b64_tr_b16 v[68:69], v14 offset:28672
    ds_read_b64_tr_b16 v[70:71], v14 offset:29184
    s_waitcnt lgkmcnt(8)
    v_mfma_f32_32x32x16_bf16 v[16:31], v[80:83], a[120:123], v[16:31]
    ds_read_b64_tr_b16 v[72:73], v13 offset:30720
    ds_read_b64_tr_b16 v[74:75], v13 offset:31232
    v_mfma_f32_32x32x16_bf16 v[32:47], v[84:87], a[120:123], v[32:47]
    ds_read_b64_tr_b16 v[76:77], v14 offset:30720
    ds_read_b64_tr_b16 v[78:79], v14 offset:31232
    s_waitcnt lgkmcnt(8)
    v_mfma_f32_32x32x16_bf16 v[16:31], v[88:91], a[124:127], v[16:31]
    ds_read_b64_tr_b16 v[80:81], v13 offset:32768
    ds_read_b64_tr_b16 v[82:83], v13 offset:33280
    v_mfma_f32_32x32x16_bf16 v[32:47], v[92:95], a[124:127], v[32:47]
    ds_read_b64_tr_b16 v[84:85], v14 offset:32768
    ds_read_b64_tr_b16 v[86:87], v14 offset:33280
    s_waitcnt vmcnt(0)
    s_waitcnt lgkmcnt(8)
    v_mfma_f32_32x32x16_bf16 v[16:31], v[64:67], a[128:131], v[16:31]
    ds_read_b64_tr_b16 v[88:89], v13 offset:34816
    ds_read_b64_tr_b16 v[90:91], v13 offset:35328
    v_mfma_f32_32x32x16_bf16 v[32:47], v[68:71], a[128:131], v[32:47]
    ds_read_b64_tr_b16 v[92:93], v14 offset:34816
    ds_read_b64_tr_b16 v[94:95], v14 offset:35328
    s_waitcnt lgkmcnt(8)
    v_mfma_f32_32x32x16_bf16 v[16:31], v[72:75], a[132:135], v[16:31]
    v_mfma_f32_32x32x16_bf16 v[32:47], v[76:79], a[132:135], v[32:47]
    s_waitcnt lgkmcnt(4)
    v_mfma_f32_32x32x16_bf16 v[16:31], v[80:83], a[136:139], v[16:31]
    v_mfma_f32_32x32x16_bf16 v[32:47], v[84:87], a[136:139], v[32:47]
    s_waitcnt lgkmcnt(0)
    v_mfma_f32_32x32x16_bf16 v[16:31], v[88:91], a[140:143], v[16:31]
    v_mfma_f32_32x32x16_bf16 v[32:47], v[92:95], a[140:143], v[32:47]
    s_mov_b32 s42, 0x00003f80
    s_mov_b32 s43, 0x3f800000
    s_mov_b32 s44, 0x3f803f80
    s_mul_i32 s45, s9, 36
    s_add_u32 s45, s45, s11
    s_lshl_b32 s45, s45, 10
    s_add_u32 s45, s45, 9576448
    v_mov_b32 v2, 0
    v_mov_b32 v3, 0
    s_nop 9
    v_dot2c_f32_bf16 v16, s42, v112
    v_dot2c_f32_bf16 v17, s43, v112
    v_dot2c_f32_bf16 v18, s42, v113
    v_dot2c_f32_bf16 v19, s43, v113
    v_dot2c_f32_bf16 v20, s42, v114
    v_dot2c_f32_bf16 v21, s43, v114
    v_dot2c_f32_bf16 v22, s42, v115
    v_dot2c_f32_bf16 v23, s43, v115
    s_nop 2
    v_cvt_pk_bf16_f32 v64, v16, v17
    v_cvt_pk_bf16_f32 v65, v18, v19
    v_cvt_pk_bf16_f32 v66, v20, v21
    v_cvt_pk_bf16_f32 v67, v22, v23
    buffer_store_dwordx4 v[64:67], v1, s[12:15], s45 offen offset:0 sc1
    v_dot2c_f32_bf16 v2, s44, v64
    v_dot2c_f32_bf16 v3, v64, v64
    v_dot2c_f32_bf16 v2, s44, v65
    v_dot2c_f32_bf16 v3, v65, v65
    v_dot2c_f32_bf16 v2, s44, v66
    v_dot2c_f32_bf16 v3, v66, v66
    v_dot2c_f32_bf16 v2, s44, v67
    v_dot2c_f32_bf16 v3, v67, v67
    v_dot2c_f32_bf16 v24, s42, v116
    v_dot2c_f32_bf16 v25, s43, v116
    v_dot2c_f32_bf16 v26, s42, v117
    v_dot2c_f32_bf16 v27, s43, v117
    v_dot2c_f32_bf16 v28, s42, v118
    v_dot2c_f32_bf16 v29, s43, v118
    v_dot2c_f32_bf16 v30, s42, v119
    v_dot2c_f32_bf16 v31, s43, v119
    s_nop 2
    v_cvt_pk_bf16_f32 v68, v24, v25
    v_cvt_pk_bf16_f32 v69, v26, v27
    v_cvt_pk_bf16_f32 v70, v28, v29
    v_cvt_pk_bf16_f32 v71, v30, v31
    buffer_store_dwordx4 v[68:71], v1, s[12:15], s45 offen offset:1024 sc1
    v_dot2c_f32_bf16 v2, s44, v68
    v_dot2c_f32_bf16 v3, v68, v68
    v_dot2c_f32_bf16 v2, s44, v69
    v_dot2c_f32_bf16 v3, v69, v69
    v_dot2c_f32_bf16 v2, s44, v70
    v_dot2c_f32_bf16 v3, v70, v70
    v_dot2c_f32_bf16 v2, s44, v71
    v_dot2c_f32_bf16 v3, v71, v71
    v_dot2c_f32_bf16 v32, s42, v120
    v_dot2c_f32_bf16 v33, s43, v120
    v_dot2c_f32_bf16 v34, s42, v121
    v_dot2c_f32_bf16 v35, s43, v121
    v_dot2c_f32_bf16 v36, s42, v122
    v_dot2c_f32_bf16 v37, s43, v122
    v_dot2c_f32_bf16 v38, s42, v123
    v_dot2c_f32_bf16 v39, s43, v123
    s_nop 2
    v_cvt_pk_bf16_f32 v72, v32, v33
    v_cvt_pk_bf16_f32 v73, v34, v35
    v_cvt_pk_bf16_f32 v74, v36, v37
    v_cvt_pk_bf16_f32 v75, v38, v39
    buffer_store_dwordx4 v[72:75], v1, s[12:15], s45 offen offset:2048 sc1
    v_dot2c_f32_bf16 v2, s44, v72
    v_dot2c_f32_bf16 v3, v72, v72
    v_dot2c_f32_bf16 v2, s44, v73
    v_dot2c_f32_bf16 v3, v73, v73
    v_dot2c_f32_bf16 v2, s44, v74
    v_dot2c_f32_bf16 v3, v74, v74
    v_dot2c_f32_bf16 v2, s44, v75
    v_dot2c_f32_bf16 v3, v75, v75
    v_dot2c_f32_bf16 v40, s42, v124
    v_dot2c_f32_bf16 v41, s43, v124
    v_dot2c_f32_bf16 v42, s42, v125
    v_dot2c_f32_bf16 v43, s43, v125
    v_dot2c_f32_bf16 v44, s42, v126
    v_dot2c_f32_bf16 v45, s43, v126
    v_dot2c_f32_bf16 v46, s42, v127
    v_dot2c_f32_bf16 v47, s43, v127
    s_nop 2
    v_cvt_pk_bf16_f32 v76, v40, v41
    v_cvt_pk_bf16_f32 v77, v42, v43
    v_cvt_pk_bf16_f32 v78, v44, v45
    v_cvt_pk_bf16_f32 v79, v46, v47
    buffer_store_dwordx4 v[76:79], v1, s[12:15], s45 offen offset:3072 sc1
    v_dot2c_f32_bf16 v2, s44, v76
    v_dot2c_f32_bf16 v3, v76, v76
    v_dot2c_f32_bf16 v2, s44, v77
    v_dot2c_f32_bf16 v3, v77, v77
    v_dot2c_f32_bf16 v2, s44, v78
    v_dot2c_f32_bf16 v3, v78, v78
    v_dot2c_f32_bf16 v2, s44, v79
    v_dot2c_f32_bf16 v3, v79, v79
    v_lshlrev_b32 v4, 14, v5
    v_lshlrev_b32 v6, 2, v11
    v_add_u32 v4, v4, v6
    s_lshl_b32 s46, s33, 14
    s_lshl_b32 s47, s9, 7
    s_add_u32 s46, s46, s47
    s_add_u32 s46, s46, 11935744
    s_add_u32 s47, s46, 8192
    buffer_store_dword v2, v4, s[12:15], s46 offen sc1
    buffer_store_dword v3, v4, s[12:15], s47 offen sc1
    s_mul_i32 s48, s64, 128
    s_waitcnt vmcnt(0)
    s_barrier
    s_cmp_eq_u32 s8, 0
    s_cbranch_scc0 Lpub_3927
    s_mov_b64 exec, 1
    v_mov_b32 v250, s48
    v_mov_b32 v251, 1
    global_atomic_add v250, v251, s[34:35] sc1
    s_mov_b64 exec, -1
Lpub_3927:
    s_cmp_eq_u32 s67, 3
    s_cbranch_scc0 K_pre_end
    s_branch K_pre_r2
K_pre_r:
    s_waitcnt vmcnt(0)
    s_barrier
K_pre_r2:
    v_lshlrev_b32 v1, 4, v0
    s_mov_b32 s53, s68
    s_cmp_lt_u32 s53, 72
    s_cbranch_scc1 K_rw3
    s_sub_u32 s46, s53, 72
    s_mul_i32 s40, s46, 86
    s_lshr_b32 s40, s40, 8
    s_mul_i32 s41, s40, 3
    s_sub_u32 s41, s46, s41
    v_lshrrev_b32 v5, 5, v0
    v_bfe_u32 v6, v0, 4, 1
    v_bfe_u32 v7, v0, 2, 2
    v_and_b32 v8, 1, v0
    v_lshlrev_b32 v8, 1, v8
    v_bfe_u32 v15, v0, 1, 1
    v_or_b32 v8, v8, v15
    s_and_b32 s42, s8, 1
    s_lshr_b32 s43, s8, 1
    v_lshlrev_b32 v9, 5, v6
    v_lshlrev_b32 v10, 3, v8
    v_add_u32 v9, v9, v10
    s_lshl_b32 s44, s42, 6
    s_add_u32 s44, s44, 73728
    v_add_u32 v9, s44, v9
    v_lshlrev_b32 v10, 2, v5
    v_add_u32 v10, v10, v7
    v_lshlrev_b32 v10, 7, v10
    v_add_u32 v10, v10, v9
    s_mul_i32 s44, s43, 41472
    v_add_u32 v10, s44, v10
    v_lshrrev_b32 v11, 1, v7
    v_lshlrev_b32 v12, 2, v5
    v_add_u32 v12, v12, v11
    v_mul_u32_u24 v12, 18, v12
    v_xor_b32 v11, 1, v11
    v_lshlrev_b32 v11, 4, v11
    v_add_u32 v12, v12, v11
    v_and_b32 v11, 1, v7
    v_add_u32 v12, v12, v11
    v_lshlrev_b32 v12, 7, v12
    v_add_u32 v12, v12, v9
    ds_read_b64_tr_b16 v[16:17], v10 offset:0
    ds_read_b64_tr_b16 v[18:19], v10 offset:1024
    ds_read_b64_tr_b16 v[20:21], v10 offset:2560
    ds_read_b64_tr_b16 v[22:23], v10 offset:3584
    ds_read_b64_tr_b16 v[24:25], v10 offset:4608
    ds_read_b64_tr_b16 v[26:27], v10 offset:5632
    ds_read_b64_tr_b16 v[28:29], v10 offset:7168
    ds_read_b64_tr_b16 v[30:31], v10 offset:8192
    ds_read_b64_tr_b16 v[32:33], v10 offset:9216
    ds_read_b64_tr_b16 v[34:35], v10 offset:10240
    ds_read_b64_tr_b16 v[36:37], v10 offset:11776
    ds_read_b64_tr_b16 v[38:39], v10 offset:12800
    ds_read_b64_tr_b16 v[40:41], v10 offset:13824
    ds_read_b64_tr_b16 v[42:43], v10 offset:14848
    ds_read_b64_tr_b16 v[44:45], v10 offset:16384
    ds_read_b64_tr_b16 v[46:47], v10 offset:17408
    ds_read_b64_tr_b16 v[48:49], v10 offset:18432
    ds_read_b64_tr_b16 v[50:51], v10 offset:19456
    ds_read_b64_tr_b16 v[52:53], v10 offset:20992
    ds_read_b64_tr_b16 v[54:55], v10 offset:22016
    ds_read_b64_tr_b16 v[56:57], v10 offset:23040
    ds_read_b64_tr_b16 v[58:59], v10 offset:24064
    ds_read_b64_tr_b16 v[60:61], v10 offset:25600
    ds_read_b64_tr_b16 v[62:63], v10 offset:26624
    ds_read_b64_tr_b16 v[64:65], v10 offset:27648
    ds_read_b64_tr_b16 v[66:67], v10 offset:28672
    ds_read_b64_tr_b16 v[68:69], v10 offset:30208
    ds_read_b64_tr_b16 v[70:71], v10 offset:31232
    s_cmp_eq_u32 s43, 0
    s_cbranch_scc0 K2_wo_x
    ds_read_b64_tr_b16 v[72:73], v10 offset:32256
    ds_read_b64_tr_b16 v[74:75], v10 offset:33280
    ds_read_b64_tr_b16 v[76:77], v10 offset:34816
    ds_read_b64_tr_b16 v[78:79], v10 offset:35840
    ds_read_b64_tr_b16 v[80:81], v10 offset:36864
    ds_read_b64_tr_b16 v[82:83], v10 offset:37888
    ds_read_b64_tr_b16 v[84:85], v10 offset:39424
    ds_read_b64_tr_b16 v[86:87], v10 offset:40448
    s_branch K2_wo_y
K2_wo_x:
    ds_read_b64_tr_b16 v[72:73], v12 offset:0
    ds_read_b64_tr_b16 v[74:75], v12 offset:4608
    ds_read_b64_tr_b16 v[76:77], v12 offset:18432
    ds_read_b64_tr_b16 v[78:79], v12 offset:23040
    ds_read_b64_tr_b16 v[80:81], v12 offset:36864
    ds_read_b64_tr_b16 v[82:83], v12 offset:41472
    ds_read_b64_tr_b16 v[84:85], v12 offset:55296
    ds_read_b64_tr_b16 v[86:87], v12 offset:59904
K2_wo_y:
    s_lshl_b32 s44, s41, 1
    s_add_u32 s44, s44, s42
    s_cmp_eq_u32 s44, 5
    s_cbranch_scc1 K_pre_pub
    s_mul_i32 s45, s40, 5
    s_add_u32 s45, s45, s44
    s_mul_i32 s45, s45, 36
    s_mul_i32 s46, s43, 18
    s_add_u32 s45, s45, s46
    s_lshl_b32 s47, s45, 10
    s_add_u32 s47, s47, 17637376
    s_waitcnt lgkmcnt(0)
    buffer_store_dwordx4 v[16:19], v1, s[12:15], s47 offen offset:0 sc1
    buffer_store_dwordx4 v[20:23], v1, s[12:15], s47 offen offset:1024 sc1
    buffer_store_dwordx4 v[24:27], v1, s[12:15], s47 offen offset:2048 sc1
    buffer_store_dwordx4 v[28:31], v1, s[12:15], s47 offen offset:3072 sc1
    s_add_u32 s47, s47, 4096
    buffer_store_dwordx4 v[32:35], v1, s[12:15], s47 offen offset:0 sc1
    buffer_store_dwordx4 v[36:39], v1, s[12:15], s47 offen offset:1024 sc1
    buffer_store_dwordx4 v[40:43], v1, s[12:15], s47 offen offset:2048 sc1
    buffer_store_dwordx4 v[44:47], v1, s[12:15], s47 offen offset:3072 sc1
    s_add_u32 s47, s47, 4096
    buffer_store_dwordx4 v[48:51], v1, s[12:15], s47 offen offset:0 sc1
    buffer_store_dwordx4 v[52:55], v1, s[12:15], s47 offen offset:1024 sc1
    buffer_store_dwordx4 v[56:59], v1, s[12:15], s47 offen offset:2048 sc1
    buffer_store_dwordx4 v[60:63], v1, s[12:15], s47 offen offset:3072 sc1
    s_add_u32 s47, s47, 4096
    buffer_store_dwordx4 v[64:67], v1, s[12:15], s47 offen offset:0 sc1
    buffer_store_dwordx4 v[68:71], v1, s[12:15], s47 offen offset:1024 sc1
    buffer_store_dwordx4 v[72:75], v1, s[12:15], s47 offen offset:2048 sc1
    buffer_store_dwordx4 v[76:79], v1, s[12:15], s47 offen offset:3072 sc1
    s_add_u32 s47, s47, 4096
    buffer_store_dwordx4 v[80:83], v1, s[12:15], s47 offen offset:0 sc1
    buffer_store_dwordx4 v[84:87], v1, s[12:15], s47 offen offset:1024 sc1
    s_branch K_pre_pub
K_rw3:
    v_lshrrev_b32 v5, 5, v0
    v_bfe_u32 v6, v0, 4, 1
    v_bfe_u32 v7, v0, 2, 2
    v_and_b32 v8, 1, v0
    v_lshlrev_b32 v8, 1, v8
    v_bfe_u32 v15, v0, 1, 1
    v_or_b32 v8, v8, v15
    s_and_b32 s40, s8, 1
    s_lshr_b32 s41, s8, 1
    v_lshlrev_b32 v9, 1, v6
    v_lshrrev_b32 v10, 1, v8
    v_add_u32 v9, v9, v10
    s_lshl_b32 s42, s40, 2
    v_add_u32 v9, s42, v9
    v_lshrrev_b32 v10, 1, v7
    v_lshlrev_b32 v10, 2, v10
    v_xor_b32 v9, v9, v10
    v_lshlrev_b32 v9, 4, v9
    v_and_b32 v10, 1, v8
    v_lshlrev_b32 v10, 3, v10
    v_add_u32 v9, v9, v10
    v_lshlrev_b32 v10, 3, v5
    v_add_u32 v10, v10, v7
    v_lshlrev_b32 v10, 7, v10
    v_add_u32 v9, v9, v10
    s_mul_i32 s42, s41, 36864
    s_add_u32 s42, s42, 73728
    v_add_u32 v9, s42, v9
    ds_read_b64_tr_b16 v[16:17], v9 offset:0
    ds_read_b64_tr_b16 v[18:19], v9 offset:512
    ds_read_b64_tr_b16 v[20:21], v9 offset:2048
    ds_read_b64_tr_b16 v[22:23], v9 offset:2560
    ds_read_b64_tr_b16 v[24:25], v9 offset:4096
    ds_read_b64_tr_b16 v[26:27], v9 offset:4608
    ds_read_b64_tr_b16 v[28:29], v9 offset:6144
    ds_read_b64_tr_b16 v[30:31], v9 offset:6656
    ds_read_b64_tr_b16 v[32:33], v9 offset:8192
    ds_read_b64_tr_b16 v[34:35], v9 offset:8704
    ds_read_b64_tr_b16 v[36:37], v9 offset:10240
    ds_read_b64_tr_b16 v[38:39], v9 offset:10752
    ds_read_b64_tr_b16 v[40:41], v9 offset:12288
    ds_read_b64_tr_b16 v[42:43], v9 offset:12800
    ds_read_b64_tr_b16 v[44:45], v9 offset:14336
    ds_read_b64_tr_b16 v[46:47], v9 offset:14848
    ds_read_b64_tr_b16 v[48:49], v9 offset:16384
    ds_read_b64_tr_b16 v[50:51], v9 offset:16896
    ds_read_b64_tr_b16 v[52:53], v9 offset:18432
    ds_read_b64_tr_b16 v[54:55], v9 offset:18944
    ds_read_b64_tr_b16 v[56:57], v9 offset:20480
    ds_read_b64_tr_b16 v[58:59], v9 offset:20992
    ds_read_b64_tr_b16 v[60:61], v9 offset:22528
    ds_read_b64_tr_b16 v[62:63], v9 offset:23040
    ds_read_b64_tr_b16 v[64:65], v9 offset:24576
    ds_read_b64_tr_b16 v[66:67], v9 offset:25088
    ds_read_b64_tr_b16 v[68:69], v9 offset:26624
    ds_read_b64_tr_b16 v[70:71], v9 offset:27136
    ds_read_b64_tr_b16 v[72:73], v9 offset:28672
    ds_read_b64_tr_b16 v[74:75], v9 offset:29184
    ds_read_b64_tr_b16 v[76:77], v9 offset:30720
    ds_read_b64_tr_b16 v[78:79], v9 offset:31232
    ds_read_b64_tr_b16 v[80:81], v9 offset:32768
    ds_read_b64_tr_b16 v[82:83], v9 offset:33280
    ds_read_b64_tr_b16 v[84:85], v9 offset:34816
    ds_read_b64_tr_b16 v[86:87], v9 offset:35328
    v_mov_b32 v104, 0x3f803f80
    v_mov_b32 v105, 0x3f803f80
    v_mov_b32 v106, 0x3f803f80
    v_mov_b32 v107, 0x3f803f80
    s_nop 0
    s_waitcnt lgkmcnt(15)
    v_mfma_f32_32x32x16_bf16 v[112:127], v[104:107], v[16:19], 0
    v_mfma_f32_32x32x16_bf16 v[112:127], v[104:107], v[20:23], v[112:127]
    v_mfma_f32_32x32x16_bf16 v[112:127], v[104:107], v[24:27], v[112:127]
    s_waitcnt lgkmcnt(15)
    v_mfma_f32_32x32x16_bf16 v[112:127], v[104:107], v[28:31], v[112:127]
    v_mfma_f32_32x32x16_bf16 v[112:127], v[104:107], v[32:35], v[112:127]
    v_mfma_f32_32x32x16_bf16 v[112:127], v[104:107], v[36:39], v[112:127]
    s_waitcnt lgkmcnt(15)
    v_mfma_f32_32x32x16_bf16 v[112:127], v[104:107], v[40:43], v[112:127]
    v_mfma_f32_32x32x16_bf16 v[112:127], v[104:107], v[44:47], v[112:127]
    v_mfma_f32_32x32x16_bf16 v[112:127], v[104:107], v[48:51], v[112:127]
    s_waitcnt lgkmcnt(12)
    v_mfma_f32_32x32x16_bf16 v[112:127], v[104:107], v[52:55], v[112:127]
    v_mfma_f32_32x32x16_bf16 v[112:127], v[104:107], v[56:59], v[112:127]
    v_mfma_f32_32x32x16_bf16 v[112:127], v[104:107], v[60:63], v[112:127]
    s_waitcnt lgkmcnt(6)
    v_mfma_f32_32x32x16_bf16 v[112:127], v[104:107], v[64:67], v[112:127]
    v_mfma_f32_32x32x16_bf16 v[112:127], v[104:107], v[68:71], v[112:127]
    v_mfma_f32_32x32x16_bf16 v[112:127], v[104:107], v[72:75], v[112:127]
    s_waitcnt lgkmcnt(0)
    v_mfma_f32_32x32x16_bf16 v[112:127], v[104:107], v[76:79], v[112:127]
    v_mfma_f32_32x32x16_bf16 v[112:127], v[104:107], v[80:83], v[112:127]
    v_mfma_f32_32x32x16_bf16 v[112:127], v[104:107], v[84:87], v[112:127]
    v_lshlrev_b32 v12, 2, v0
    s_lshl_b32 s42, s8, 8
    s_add_u32 s42, s42, 147456
    v_add_u32 v13, s42, v12
    s_nop 8
    v_mov_b32 v10, v112
    ds_write_b32 v13, v10
    s_mov_b32 s44, 0x00003f80
    s_mov_b32 s45, 0x3f800000
    s_xor_b32 s42, s8, 2
    s_lshl_b32 s42, s42, 8
    s_add_u32 s42, s42, 147456
    v_add_u32 v13, s42, v12
    s_waitcnt lgkmcnt(0)
    s_barrier
    ds_read_b32 v11, v13
    s_waitcnt lgkmcnt(0)
    v_add_f32 v10, v10, v11
    v_mul_f32 v10, 0xbae38e39, v10
    s_lshl_b32 s46, s53, 1
    s_add_u32 s46, s46, s40
    s_mul_i32 s47, s46, 36864
    s_add_u32 s47, s47, 12328960
    s_mul_i32 s42, s41, 18432
    s_add_u32 s47, s47, s42
    v_mov_b32 v11, v10
    v_lshlrev_b32 v88, 16, v16
    v_and_b32 v89, 0xffff0000, v16
    v_lshlrev_b32 v90, 16, v17
    v_and_b32 v91, 0xffff0000, v17
    v_lshlrev_b32 v92, 16, v18
    v_and_b32 v93, 0xffff0000, v18
    v_lshlrev_b32 v94, 16, v19
    v_and_b32 v95, 0xffff0000, v19
    v_pk_add_f32 v[88:89], v[88:89], v[10:11]
    v_pk_add_f32 v[90:91], v[90:91], v[10:11]
    v_pk_add_f32 v[92:93], v[92:93], v[10:11]
    v_pk_add_f32 v[94:95], v[94:95], v[10:11]
    v_cvt_pk_bf16_f32 v16, v88, v89
    v_cvt_pk_bf16_f32 v17, v90, v91
    v_cvt_pk_bf16_f32 v18, v92, v93
    v_cvt_pk_bf16_f32 v19, v94, v95
    buffer_store_dwordx4 v[16:19], v1, s[12:15], s47 offen offset:0 sc1
    v_lshlrev_b32 v96, 16, v20
    v_and_b32 v97, 0xffff0000, v20
    v_lshlrev_b32 v98, 16, v21
    v_and_b32 v99, 0xffff0000, v21
    v_lshlrev_b32 v100, 16, v22
    v_and_b32 v101, 0xffff0000, v22
    v_lshlrev_b32 v102, 16, v23
    v_and_b32 v103, 0xffff0000, v23
    v_pk_add_f32 v[96:97], v[96:97], v[10:11]
    v_pk_add_f32 v[98:99], v[98:99], v[10:11]
    v_pk_add_f32 v[100:101], v[100:101], v[10:11]
    v_pk_add_f32 v[102:103], v[102:103], v[10:11]
    v_cvt_pk_bf16_f32 v20, v96, v97
    v_cvt_pk_bf16_f32 v21, v98, v99
    v_cvt_pk_bf16_f32 v22, v100, v101
    v_cvt_pk_bf16_f32 v23, v102, v103
    buffer_store_dwordx4 v[20:23], v1, s[12:15], s47 offen offset:1024 sc1
    v_lshlrev_b32 v88, 16, v24
    v_and_b32 v89, 0xffff0000, v24
    v_lshlrev_b32 v90, 16, v25
    v_and_b32 v91, 0xffff0000, v25
    v_lshlrev_b32 v92, 16, v26
    v_and_b32 v93, 0xffff0000, v26
    v_lshlrev_b32 v94, 16, v27
    v_and_b32 v95, 0xffff0000, v27
    v_pk_add_f32 v[88:89], v[88:89], v[10:11]
    v_pk_add_f32 v[90:91], v[90:91], v[10:11]
    v_pk_add_f32 v[92:93], v[92:93], v[10:11]
    v_pk_add_f32 v[94:95], v[94:95], v[10:11]
    v_cvt_pk_bf16_f32 v24, v88, v89
    v_cvt_pk_bf16_f32 v25, v90, v91
    v_cvt_pk_bf16_f32 v26, v92, v93
    v_cvt_pk_bf16_f32 v27, v94, v95
    buffer_store_dwordx4 v[24:27], v1, s[12:15], s47 offen offset:2048 sc1
    v_lshlrev_b32 v96, 16, v28
    v_and_b32 v97, 0xffff0000, v28
    v_lshlrev_b32 v98, 16, v29
    v_and_b32 v99, 0xffff0000, v29
    v_lshlrev_b32 v100, 16, v30
    v_and_b32 v101, 0xffff0000, v30
    v_lshlrev_b32 v102, 16, v31
    v_and_b32 v103, 0xffff0000, v31
    v_pk_add_f32 v[96:97], v[96:97], v[10:11]
    v_pk_add_f32 v[98:99], v[98:99], v[10:11]
    v_pk_add_f32 v[100:101], v[100:101], v[10:11]
    v_pk_add_f32 v[102:103], v[102:103], v[10:11]
    v_cvt_pk_bf16_f32 v28, v96, v97
    v_cvt_pk_bf16_f32 v29, v98, v99
    v_cvt_pk_bf16_f32 v30, v100, v101
    v_cvt_pk_bf16_f32 v31, v102, v103
    buffer_store_dwordx4 v[28:31], v1, s[12:15], s47 offen offset:3072 sc1
    s_add_u32 s47, s47, 4096
    v_lshlrev_b32 v88, 16, v32
    v_and_b32 v89, 0xffff0000, v32
    v_lshlrev_b32 v90, 16, v33
    v_and_b32 v91, 0xffff0000, v33
    v_lshlrev_b32 v92, 16, v34
    v_and_b32 v93, 0xffff0000, v34
    v_lshlrev_b32 v94, 16, v35
    v_and_b32 v95, 0xffff0000, v35
    v_pk_add_f32 v[88:89], v[88:89], v[10:11]
    v_pk_add_f32 v[90:91], v[90:91], v[10:11]
    v_pk_add_f32 v[92:93], v[92:93], v[10:11]
    v_pk_add_f32 v[94:95], v[94:95], v[10:11]
    v_cvt_pk_bf16_f32 v32, v88, v89
    v_cvt_pk_bf16_f32 v33, v90, v91
    v_cvt_pk_bf16_f32 v34, v92, v93
    v_cvt_pk_bf16_f32 v35, v94, v95
    buffer_store_dwordx4 v[32:35], v1, s[12:15], s47 offen offset:0 sc1
    v_lshlrev_b32 v96, 16, v36
    v_and_b32 v97, 0xffff0000, v36
    v_lshlrev_b32 v98, 16, v37
    v_and_b32 v99, 0xffff0000, v37
    v_lshlrev_b32 v100, 16, v38
    v_and_b32 v101, 0xffff0000, v38
    v_lshlrev_b32 v102, 16, v39
    v_and_b32 v103, 0xffff0000, v39
    v_pk_add_f32 v[96:97], v[96:97], v[10:11]
    v_pk_add_f32 v[98:99], v[98:99], v[10:11]
    v_pk_add_f32 v[100:101], v[100:101], v[10:11]
    v_pk_add_f32 v[102:103], v[102:103], v[10:11]
    v_cvt_pk_bf16_f32 v36, v96, v97
    v_cvt_pk_bf16_f32 v37, v98, v99
    v_cvt_pk_bf16_f32 v38, v100, v101
    v_cvt_pk_bf16_f32 v39, v102, v103
    buffer_store_dwordx4 v[36:39], v1, s[12:15], s47 offen offset:1024 sc1
    v_lshlrev_b32 v88, 16, v40
    v_and_b32 v89, 0xffff0000, v40
    v_lshlrev_b32 v90, 16, v41
    v_and_b32 v91, 0xffff0000, v41
    v_lshlrev_b32 v92, 16, v42
    v_and_b32 v93, 0xffff0000, v42
    v_lshlrev_b32 v94, 16, v43
    v_and_b32 v95, 0xffff0000, v43
    v_pk_add_f32 v[88:89], v[88:89], v[10:11]
    v_pk_add_f32 v[90:91], v[90:91], v[10:11]
    v_pk_add_f32 v[92:93], v[92:93], v[10:11]
    v_pk_add_f32 v[94:95], v[94:95], v[10:11]
    v_cvt_pk_bf16_f32 v40, v88, v89
    v_cvt_pk_bf16_f32 v41, v90, v91
    v_cvt_pk_bf16_f32 v42, v92, v93
    v_cvt_pk_bf16_f32 v43, v94, v95
    buffer_store_dwordx4 v[40:43], v1, s[12:15], s47 offen offset:2048 sc1
    v_lshlrev_b32 v96, 16, v44
    v_and_b32 v97, 0xffff0000, v44
    v_lshlrev_b32 v98, 16, v45
    v_and_b32 v99, 0xffff0000, v45
    v_lshlrev_b32 v100, 16, v46
    v_and_b32 v101, 0xffff0000, v46
    v_lshlrev_b32 v102, 16, v47
    v_and_b32 v103, 0xffff0000, v47
    v_pk_add_f32 v[96:97], v[96:97], v[10:11]
    v_pk_add_f32 v[98:99], v[98:99], v[10:11]
    v_pk_add_f32 v[100:101], v[100:101], v[10:11]
    v_pk_add_f32 v[102:103], v[102:103], v[10:11]
    v_cvt_pk_bf16_f32 v44, v96, v97
    v_cvt_pk_bf16_f32 v45, v98, v99
    v_cvt_pk_bf16_f32 v46, v100, v101
    v_cvt_pk_bf16_f32 v47, v102, v103
    buffer_store_dwordx4 v[44:47], v1, s[12:15], s47 offen offset:3072 sc1
    s_add_u32 s47, s47, 4096
    v_lshlrev_b32 v88, 16, v48
    v_and_b32 v89, 0xffff0000, v48
    v_lshlrev_b32 v90, 16, v49
    v_and_b32 v91, 0xffff0000, v49
    v_lshlrev_b32 v92, 16, v50
    v_and_b32 v93, 0xffff0000, v50
    v_lshlrev_b32 v94, 16, v51
    v_and_b32 v95, 0xffff0000, v51
    v_pk_add_f32 v[88:89], v[88:89], v[10:11]
    v_pk_add_f32 v[90:91], v[90:91], v[10:11]
    v_pk_add_f32 v[92:93], v[92:93], v[10:11]
    v_pk_add_f32 v[94:95], v[94:95], v[10:11]
    v_cvt_pk_bf16_f32 v48, v88, v89
    v_cvt_pk_bf16_f32 v49, v90, v91
    v_cvt_pk_bf16_f32 v50, v92, v93
    v_cvt_pk_bf16_f32 v51, v94, v95
    buffer_store_dwordx4 v[48:51], v1, s[12:15], s47 offen offset:0 sc1
    v_lshlrev_b32 v96, 16, v52
    v_and_b32 v97, 0xffff0000, v52
    v_lshlrev_b32 v98, 16, v53
    v_and_b32 v99, 0xffff0000, v53
    v_lshlrev_b32 v100, 16, v54
    v_and_b32 v101, 0xffff0000, v54
    v_lshlrev_b32 v102, 16, v55
    v_and_b32 v103, 0xffff0000, v55
    v_pk_add_f32 v[96:97], v[96:97], v[10:11]
    v_pk_add_f32 v[98:99], v[98:99], v[10:11]
    v_pk_add_f32 v[100:101], v[100:101], v[10:11]
    v_pk_add_f32 v[102:103], v[102:103], v[10:11]
    v_cvt_pk_bf16_f32 v52, v96, v97
    v_cvt_pk_bf16_f32 v53, v98, v99
    v_cvt_pk_bf16_f32 v54, v100, v101
    v_cvt_pk_bf16_f32 v55, v102, v103
    buffer_store_dwordx4 v[52:55], v1, s[12:15], s47 offen offset:1024 sc1
    v_lshlrev_b32 v88, 16, v56
    v_and_b32 v89, 0xffff0000, v56
    v_lshlrev_b32 v90, 16, v57
    v_and_b32 v91, 0xffff0000, v57
    v_lshlrev_b32 v92, 16, v58
    v_and_b32 v93, 0xffff0000, v58
    v_lshlrev_b32 v94, 16, v59
    v_and_b32 v95, 0xffff0000, v59
    v_pk_add_f32 v[88:89], v[88:89], v[10:11]
    v_pk_add_f32 v[90:91], v[90:91], v[10:11]
    v_pk_add_f32 v[92:93], v[92:93], v[10:11]
    v_pk_add_f32 v[94:95], v[94:95], v[10:11]
    v_cvt_pk_bf16_f32 v56, v88, v89
    v_cvt_pk_bf16_f32 v57, v90, v91
    v_cvt_pk_bf16_f32 v58, v92, v93
    v_cvt_pk_bf16_f32 v59, v94, v95
    buffer_store_dwordx4 v[56:59], v1, s[12:15], s47 offen offset:2048 sc1
    v_lshlrev_b32 v96, 16, v60
    v_and_b32 v97, 0xffff0000, v60
    v_lshlrev_b32 v98, 16, v61
    v_and_b32 v99, 0xffff0000, v61
    v_lshlrev_b32 v100, 16, v62
    v_and_b32 v101, 0xffff0000, v62
    v_lshlrev_b32 v102, 16, v63
    v_and_b32 v103, 0xffff0000, v63
    v_pk_add_f32 v[96:97], v[96:97], v[10:11]
    v_pk_add_f32 v[98:99], v[98:99], v[10:11]
    v_pk_add_f32 v[100:101], v[100:101], v[10:11]
    v_pk_add_f32 v[102:103], v[102:103], v[10:11]
    v_cvt_pk_bf16_f32 v60, v96, v97
    v_cvt_pk_bf16_f32 v61, v98, v99
    v_cvt_pk_bf16_f32 v62, v100, v101
    v_cvt_pk_bf16_f32 v63, v102, v103
    buffer_store_dwordx4 v[60:63], v1, s[12:15], s47 offen offset:3072 sc1
    s_add_u32 s47, s47, 4096
    v_lshlrev_b32 v88, 16, v64
    v_and_b32 v89, 0xffff0000, v64
    v_lshlrev_b32 v90, 16, v65
    v_and_b32 v91, 0xffff0000, v65
    v_lshlrev_b32 v92, 16, v66
    v_and_b32 v93, 0xffff0000, v66
    v_lshlrev_b32 v94, 16, v67
    v_and_b32 v95, 0xffff0000, v67
    v_pk_add_f32 v[88:89], v[88:89], v[10:11]
    v_pk_add_f32 v[90:91], v[90:91], v[10:11]
    v_pk_add_f32 v[92:93], v[92:93], v[10:11]
    v_pk_add_f32 v[94:95], v[94:95], v[10:11]
    v_cvt_pk_bf16_f32 v64, v88, v89
    v_cvt_pk_bf16_f32 v65, v90, v91
    v_cvt_pk_bf16_f32 v66, v92, v93
    v_cvt_pk_bf16_f32 v67, v94, v95
    buffer_store_dwordx4 v[64:67], v1, s[12:15], s47 offen offset:0 sc1
    v_lshlrev_b32 v96, 16, v68
    v_and_b32 v97, 0xffff0000, v68
    v_lshlrev_b32 v98, 16, v69
    v_and_b32 v99, 0xffff0000, v69
    v_lshlrev_b32 v100, 16, v70
    v_and_b32 v101, 0xffff0000, v70
    v_lshlrev_b32 v102, 16, v71
    v_and_b32 v103, 0xffff0000, v71
    v_pk_add_f32 v[96:97], v[96:97], v[10:11]
    v_pk_add_f32 v[98:99], v[98:99], v[10:11]
    v_pk_add_f32 v[100:101], v[100:101], v[10:11]
    v_pk_add_f32 v[102:103], v[102:103], v[10:11]
    v_cvt_pk_bf16_f32 v68, v96, v97
    v_cvt_pk_bf16_f32 v69, v98, v99
    v_cvt_pk_bf16_f32 v70, v100, v101
    v_cvt_pk_bf16_f32 v71, v102, v103
    buffer_store_dwordx4 v[68:71], v1, s[12:15], s47 offen offset:1024 sc1
    v_lshlrev_b32 v88, 16, v72
    v_and_b32 v89, 0xffff0000, v72
    v_lshlrev_b32 v90, 16, v73
    v_and_b32 v91, 0xffff0000, v73
    v_lshlrev_b32 v92, 16, v74
    v_and_b32 v93, 0xffff0000, v74
    v_lshlrev_b32 v94, 16, v75
    v_and_b32 v95, 0xffff0000, v75
    v_pk_add_f32 v[88:89], v[88:89], v[10:11]
    v_pk_add_f32 v[90:91], v[90:91], v[10:11]
    v_pk_add_f32 v[92:93], v[92:93], v[10:11]
    v_pk_add_f32 v[94:95], v[94:95], v[10:11]
    v_cvt_pk_bf16_f32 v72, v88, v89
    v_cvt_pk_bf16_f32 v73, v90, v91
    v_cvt_pk_bf16_f32 v74, v92, v93
    v_cvt_pk_bf16_f32 v75, v94, v95
    buffer_store_dwordx4 v[72:75], v1, s[12:15], s47 offen offset:2048 sc1
    v_lshlrev_b32 v96, 16, v76
    v_and_b32 v97, 0xffff0000, v76
    v_lshlrev_b32 v98, 16, v77
    v_and_b32 v99, 0xffff0000, v77
    v_lshlrev_b32 v100, 16, v78
    v_and_b32 v101, 0xffff0000, v78
    v_lshlrev_b32 v102, 16, v79
    v_and_b32 v103, 0xffff0000, v79
    v_pk_add_f32 v[96:97], v[96:97], v[10:11]
    v_pk_add_f32 v[98:99], v[98:99], v[10:11]
    v_pk_add_f32 v[100:101], v[100:101], v[10:11]
    v_pk_add_f32 v[102:103], v[102:103], v[10:11]
    v_cvt_pk_bf16_f32 v76, v96, v97
    v_cvt_pk_bf16_f32 v77, v98, v99
    v_cvt_pk_bf16_f32 v78, v100, v101
    v_cvt_pk_bf16_f32 v79, v102, v103
    buffer_store_dwordx4 v[76:79], v1, s[12:15], s47 offen offset:3072 sc1
    s_add_u32 s47, s47, 4096
    v_lshlrev_b32 v88, 16, v80
    v_and_b32 v89, 0xffff0000, v80
    v_lshlrev_b32 v90, 16, v81
    v_and_b32 v91, 0xffff0000, v81
    v_lshlrev_b32 v92, 16, v82
    v_and_b32 v93, 0xffff0000, v82
    v_lshlrev_b32 v94, 16, v83
    v_and_b32 v95, 0xffff0000, v83
    v_pk_add_f32 v[88:89], v[88:89], v[10:11]
    v_pk_add_f32 v[90:91], v[90:91], v[10:11]
    v_pk_add_f32 v[92:93], v[92:93], v[10:11]
    v_pk_add_f32 v[94:95], v[94:95], v[10:11]
    v_cvt_pk_bf16_f32 v80, v88, v89
    v_cvt_pk_bf16_f32 v81, v90, v91
    v_cvt_pk_bf16_f32 v82, v92, v93
    v_cvt_pk_bf16_f32 v83, v94, v95
    buffer_store_dwordx4 v[80:83], v1, s[12:15], s47 offen offset:0 sc1
    v_lshlrev_b32 v96, 16, v84
    v_and_b32 v97, 0xffff0000, v84
    v_lshlrev_b32 v98, 16, v85
    v_and_b32 v99, 0xffff0000, v85
    v_lshlrev_b32 v100, 16, v86
    v_and_b32 v101, 0xffff0000, v86
    v_lshlrev_b32 v102, 16, v87
    v_and_b32 v103, 0xffff0000, v87
    v_pk_add_f32 v[96:97], v[96:97], v[10:11]
    v_pk_add_f32 v[98:99], v[98:99], v[10:11]
    v_pk_add_f32 v[100:101], v[100:101], v[10:11]
    v_pk_add_f32 v[102:103], v[102:103], v[10:11]
    v_cvt_pk_bf16_f32 v84, v96, v97
    v_cvt_pk_bf16_f32 v85, v98, v99
    v_cvt_pk_bf16_f32 v86, v100, v101
    v_cvt_pk_bf16_f32 v87, v102, v103
    buffer_store_dwordx4 v[84:87], v1, s[12:15], s47 offen offset:1024 sc1
K_pre_pub:
    s_mov_b32 s48, s66
    s_waitcnt vmcnt(0)
    s_barrier
    s_cmp_eq_u32 s8, 0
    s_cbranch_scc0 Lpub_4501
    s_mov_b64 exec, 1
    v_mov_b32 v250, s48
    v_mov_b32 v251, 1
    global_atomic_add v250, v251, s[34:35] sc1
    s_mov_b64 exec, -1
Lpub_4501:
    s_cmp_ge_u32 s53, 72
    s_cbranch_scc0 K_pre_end
    s_cmp_eq_u32 s8, 0
    s_cbranch_scc0 K_pre_end
    s_mov_b64 exec, 0xff
    v_lshlrev_b32 v250, 7, v0
    v_add_u32 v250, 8320, v250
    v_mov_b32 v251, 1
    global_atomic_add v250, v251, s[34:35] sc1
    s_mov_b64 exec, -1
K_pre_h:
K_pre_end:
    s_cmp_lt_u32 s7, 16
    s_cbranch_scc0 L3_attn
L3_mlp:
    s_and_b32 s9, s6, 3
    s_lshl_b32 s9, s9, 2
    s_and_b32 s10, s7, 3
    s_add_u32 s9, s9, s10
    s_lshr_b32 s10, s6, 2
    s_lshl_b32 s10, s10, 2
    s_lshr_b32 s11, s7, 2
    s_add_u32 s6, s10, s11
    s_mov_b32 s7, s9
    s_mul_i32 s48, s7, 128
    s_mul_i32 s49, s6, 128
    s_add_u32 s49, s49, 2048
    s_cmp_eq_u32 s8, 0
    s_cbranch_scc0 Lwait_4536_done
    s_mov_b32 s50, 0x40000
    s_mov_b64 exec, 1
    v_mov_b32 v246, s48
    v_mov_b32 v247, s49
Lwait_4536:
    global_load_dword v250, v246, s[34:35] sc1
    global_load_dword v251, v247, s[34:35] sc1
    s_waitcnt vmcnt(0)
    s_mov_b32 s51, 1
    v_readfirstlane_b32 s52, v250
    s_cmp_ge_u32 s52, 9
    s_cselect_b32 s51, s51, 0
    v_readfirstlane_b32 s52, v251
    s_cmp_ge_u32 s52, 6
    s_cselect_b32 s51, s51, 0
    s_cmp_eq_u32 s51, 1
    s_cbranch_scc1 Lwait_4536_ok
    s_sub_u32 s50, s50, 1
    s_cmp_lg_u32 s50, 0
    s_cbranch_scc1 Lwait_4536
Lwait_4536_ok:
    s_mov_b64 exec, -1
Lwait_4536_done:
    s_load_dwordx2 s[32:33], s[0:1], 56
    s_lshl_b32 s9, s7, 2
    s_add_u32 s9, s9, s8
    s_mul_i32 s18, s8, 9216
    s_mul_i32 s10, s6, 663552
    s_add_u32 s19, s10, 12328960
    s_add_u32 s20, s19, 4096
    s_add_u32 s21, s19, 8192
    s_mov_b32 s28, s10
    s_add_u32 s29, s10, 4096
    s_add_u32 s31, s10, 8192
    v_lshlrev_b32 v7, 4, v0
    v_add_u32 v2, s18, v7
    v_add_u32 v12, 73728, v7
    v_add_u32 v13, 110592, v7
    v_add_u32 v6, 36864, v7
    v_and_b32 v8, 31, v0
    v_lshlrev_b32 v8, 2, v8
    v_lshrrev_b32 v9, 5, v0
    v_lshlrev_b32 v9, 13, v9
    v_add_u32 v8, v8, v9
    v_lshrrev_b32 v9, 3, v0
    v_xor_b32 v10, 64, v2
    v_cmp_lt_u32 vcc, 5, v9
    s_nop 1
    v_cndmask_b32 v11, v2, v10, vcc
    v_cmp_gt_u32 vcc, 4, v9
    s_nop 1
    v_cndmask_b32 v1, v2, v10, vcc
    v_lshrrev_b32 v16, 5, v0
    v_bfe_u32 v17, v0, 4, 1
    v_bfe_u32 v18, v0, 2, 2
    v_and_b32 v19, 1, v0
    v_bfe_u32 v21, v0, 1, 1
    v_lshlrev_b32 v17, 1, v17
    v_add_u32 v17, v17, v19
    v_lshrrev_b32 v19, 1, v18
    v_lshlrev_b32 v19, 2, v19
    v_xor_b32 v17, v17, v19
    v_lshlrev_b32 v16, 3, v16
    v_add_u32 v16, v16, v18
    v_mul_u32_u24 v16, 1152, v16
    v_lshlrev_b32 v21, 3, v21
    v_add_u32 v16, v16, v21
    v_lshlrev_b32 v17, 4, v17
    v_add_u32 v14, v16, v17
    v_xor_b32 v17, 64, v17
    v_add_u32 v15, v16, v17
    v_cmp_lt_u32 vcc, 1, v9
    s_waitcnt lgkmcnt(0)
    s_nop 0
    v_cndmask_b32 v0, v2, v10, vcc
    s_mov_b32 s24, s32
    s_and_b32 s25, s33, 0xffff
    s_mov_b32 s26, 5308416
    s_mov_b32 s27, 0x20000
    v_mov_b32 v16, 0
    v_mov_b32 v17, 0
    v_mov_b32 v18, 0
    v_mov_b32 v19, 0
    s_nop 1
    v_mfma_f32_32x32x16_bf16 v[80:95], v[16:19], v[16:19], 0
    v_mfma_f32_32x32x16_bf16 v[96:111], v[16:19], v[16:19], 0
    v_mfma_f32_32x32x16_bf16 v[112:127], v[16:19], v[16:19], 0
    v_mfma_f32_32x32x16_bf16 v[128:143], v[16:19], v[16:19], 0
    v_mfma_f32_32x32x16_bf16 v[144:159], v[16:19], v[16:19], 0
    v_mfma_f32_32x32x16_bf16 v[160:175], v[16:19], v[16:19], 0
    v_mfma_f32_32x32x16_bf16 v[176:191], v[16:19], v[16:19], 0
    v_mfma_f32_32x32x16_bf16 v[192:207], v[16:19], v[16:19], 0
    v_mfma_f32_32x32x16_bf16 v[208:223], v[16:19], v[16:19], 0
    v_mfma_f32_32x32x16_bf16 v[224:239], v[16:19], v[16:19], 0
    v_mfma_f32_32x32x16_bf16 v[240:255], v[16:19], v[16:19], 0
    v_mfma_f32_32x32x16_bf16 a[144:159], v[16:19], v[16:19], 0
    v_mfma_f32_32x32x16_bf16 a[160:175], v[16:19], v[16:19], 0
    v_mfma_f32_32x32x16_bf16 a[176:191], v[16:19], v[16:19], 0
    v_mfma_f32_32x32x16_bf16 a[192:207], v[16:19], v[16:19], 0
    v_mfma_f32_32x32x16_bf16 a[208:223], v[16:19], v[16:19], 0
    v_mfma_f32_32x32x16_bf16 a[224:239], v[16:19], v[16:19], 0
    v_mfma_f32_32x32x16_bf16 a[240:255], v[16:19], v[16:19], 0
    s_waitcnt vmcnt(0)
    s_barrier
    s_add_u32 m0, s18, 36864
    s_nop 0
    buffer_load_dwordx4 v2, s[12:15], s19 offen offset:0 sc1 lds
    buffer_load_dwordx4 v2, s[12:15], s19 offen offset:1024 sc1 lds
    buffer_load_dwordx4 v2, s[12:15], s19 offen offset:2048 sc1 lds
    buffer_load_dwordx4 v2, s[12:15], s19 offen offset:3072 sc1 lds
    s_add_u32 m0, s18, 40960
    s_nop 0
    buffer_load_dwordx4 v2, s[12:15], s20 offen offset:0 sc1 lds
    buffer_load_dwordx4 v2, s[12:15], s20 offen offset:1024 sc1 lds
    buffer_load_dwordx4 v2, s[12:15], s20 offen offset:2048 sc1 lds
    buffer_load_dwordx4 v2, s[12:15], s20 offen offset:3072 sc1 lds
    s_add_u32 m0, s18, 45056
    s_nop 0
    buffer_load_dwordx4 v2, s[12:15], s21 offen offset:0 sc1 lds
    s_add_u32 s19, s19, 36864
    s_add_u32 s20, s20, 36864
    s_add_u32 s21, s21, 36864
    s_lshl_b32 s17, s9, 7
    s_add_u32 s17, s17, 11935744
    buffer_load_dword v64, v8, s[12:15], s17 offen sc1
    s_add_u32 s17, s17, 16384
    buffer_load_dword v65, v8, s[12:15], s17 offen sc1
    s_add_u32 s17, s17, 16384
    buffer_load_dword v66, v8, s[12:15], s17 offen sc1
    s_add_u32 s17, s17, 16384
    buffer_load_dword v67, v8, s[12:15], s17 offen sc1
    s_add_u32 s17, s17, 16384
    buffer_load_dword v68, v8, s[12:15], s17 offen sc1
    s_add_u32 s17, s17, 16384
    buffer_load_dword v69, v8, s[12:15], s17 offen sc1
    s_add_u32 s17, s17, 16384
    buffer_load_dword v70, v8, s[12:15], s17 offen sc1
    s_add_u32 s17, s17, 16384
    buffer_load_dword v71, v8, s[12:15], s17 offen sc1
    s_add_u32 s17, s17, 16384
    buffer_load_dword v72, v8, s[12:15], s17 offen sc1
    s_add_u32 s17, s17, 16384
    buffer_load_dword v73, v8, s[12:15], s17 offen sc1
    s_add_u32 s17, s17, 16384
    buffer_load_dword v74, v8, s[12:15], s17 offen sc1
    s_add_u32 s17, s17, 16384
    buffer_load_dword v75, v8, s[12:15], s17 offen sc1
    s_add_u32 s17, s17, 16384
    buffer_load_dword v76, v8, s[12:15], s17 offen sc1
    s_add_u32 s17, s17, 16384
    buffer_load_dword v77, v8, s[12:15], s17 offen sc1
    s_add_u32 s17, s17, 16384
    buffer_load_dword v78, v8, s[12:15], s17 offen sc1
    s_add_u32 s17, s17, 16384
    buffer_load_dword v79, v8, s[12:15], s17 offen sc1
    s_add_u32 s17, s17, 16384
    buffer_load_dword v40, v8, s[12:15], s17 offen sc1
    s_add_u32 s17, s17, 16384
    buffer_load_dword v41, v8, s[12:15], s17 offen sc1
    s_mul_i32 s16, s9, 36864
    s_add_u32 s16, s16, 9576448
    buffer_load_dwordx4 a[0:3], v7, s[12:15], s16 offen offset:0 sc1
    buffer_load_dwordx4 a[4:7], v7, s[12:15], s16 offen offset:1024 sc1
    buffer_load_dwordx4 a[8:11], v7, s[12:15], s16 offen offset:2048 sc1
    buffer_load_dwordx4 a[12:15], v7, s[12:15], s16 offen offset:3072 sc1
    s_add_u32 s16, s16, 4096
    buffer_load_dwordx4 a[16:19], v7, s[12:15], s16 offen offset:0 sc1
    buffer_load_dwordx4 a[20:23], v7, s[12:15], s16 offen offset:1024 sc1
    buffer_load_dwordx4 a[24:27], v7, s[12:15], s16 offen offset:2048 sc1
    buffer_load_dwordx4 a[28:31], v7, s[12:15], s16 offen offset:3072 sc1
    s_add_u32 s16, s16, 4096
    buffer_load_dwordx4 a[32:35], v7, s[12:15], s16 offen offset:0 sc1
    buffer_load_dwordx4 a[36:39], v7, s[12:15], s16 offen offset:1024 sc1
    buffer_load_dwordx4 a[40:43], v7, s[12:15], s16 offen offset:2048 sc1
    buffer_load_dwordx4 a[44:47], v7, s[12:15], s16 offen offset:3072 sc1
    s_add_u32 s16, s16, 4096
    buffer_load_dwordx4 a[48:51], v7, s[12:15], s16 offen offset:0 sc1
    buffer_load_dwordx4 a[52:55], v7, s[12:15], s16 offen offset:1024 sc1
    buffer_load_dwordx4 a[56:59], v7, s[12:15], s16 offen offset:2048 sc1
    buffer_load_dwordx4 a[60:63], v7, s[12:15], s16 offen offset:3072 sc1
    s_add_u32 s16, s16, 4096
    buffer_load_dwordx4 a[64:67], v7, s[12:15], s16 offen offset:0 sc1
    buffer_load_dwordx4 a[68:71], v7, s[12:15], s16 offen offset:1024 sc1
    buffer_load_dwordx4 a[72:75], v7, s[12:15], s16 offen offset:2048 sc1
    buffer_load_dwordx4 a[76:79], v7, s[12:15], s16 offen offset:3072 sc1
    s_add_u32 s16, s16, 4096
    buffer_load_dwordx4 a[80:83], v7, s[12:15], s16 offen offset:0 sc1
    buffer_load_dwordx4 a[84:87], v7, s[12:15], s16 offen offset:1024 sc1
    buffer_load_dwordx4 a[88:91], v7, s[12:15], s16 offen offset:2048 sc1
    buffer_load_dwordx4 a[92:95], v7, s[12:15], s16 offen offset:3072 sc1
    s_add_u32 s16, s16, 4096
    buffer_load_dwordx4 a[96:99], v7, s[12:15], s16 offen offset:0 sc1
    buffer_load_dwordx4 a[100:103], v7, s[12:15], s16 offen offset:1024 sc1
    buffer_load_dwordx4 a[104:107], v7, s[12:15], s16 offen offset:2048 sc1
    buffer_load_dwordx4 a[108:111], v7, s[12:15], s16 offen offset:3072 sc1
    s_add_u32 s16, s16, 4096
    buffer_load_dwordx4 a[112:115], v7, s[12:15], s16 offen offset:0 sc1
    buffer_load_dwordx4 a[116:119], v7, s[12:15], s16 offen offset:1024 sc1
    buffer_load_dwordx4 a[120:123], v7, s[12:15], s16 offen offset:2048 sc1
    buffer_load_dwordx4 a[124:127], v7, s[12:15], s16 offen offset:3072 sc1
    s_add_u32 s16, s16, 4096
    buffer_load_dwordx4 a[128:131], v7, s[12:15], s16 offen offset:0 sc1
    buffer_load_dwordx4 a[132:135], v7, s[12:15], s16 offen offset:1024 sc1
    buffer_load_dwordx4 a[136:139], v7, s[12:15], s16 offen offset:2048 sc1
    buffer_load_dwordx4 a[140:143], v7, s[12:15], s16 offen offset:3072 sc1
    s_add_u32 m0, s18, 110592
    s_nop 0
    buffer_load_dwordx4 v2, s[12:15], s19 offen offset:0 sc1 lds
    buffer_load_dwordx4 v2, s[12:15], s19 offen offset:1024 sc1 lds
    buffer_load_dwordx4 v2, s[12:15], s19 offen offset:2048 sc1 lds
    buffer_load_dwordx4 v2, s[12:15], s19 offen offset:3072 sc1 lds
    s_add_u32 m0, s18, 114688
    s_nop 0
    buffer_load_dwordx4 v2, s[12:15], s20 offen offset:0 sc1 lds
    buffer_load_dwordx4 v2, s[12:15], s20 offen offset:1024 sc1 lds
    buffer_load_dwordx4 v2, s[12:15], s20 offen offset:2048 sc1 lds
    buffer_load_dwordx4 v2, s[12:15], s20 offen offset:3072 sc1 lds
    s_add_u32 m0, s18, 118784
    s_nop 0
    buffer_load_dwordx4 v2, s[12:15], s21 offen offset:0 sc1 lds
    s_add_u32 s19, s19, 36864
    s_add_u32 s20, s20, 36864
    s_add_u32 s21, s21, 36864
    s_waitcnt vmcnt(45)
    s_barrier
    ds_read_b128 v[16:19], v6 offset:0
    ds_read_b128 v[20:23], v6 offset:1024
    ds_read_b128 v[24:27], v6 offset:2048
    ds_read_b128 v[28:31], v6 offset:3072
    ds_read_b128 v[32:35], v6 offset:4096
    ds_read_b128 v[36:39], v6 offset:5120
    s_waitcnt vmcnt(41)
    s_waitcnt lgkmcnt(4)
    v_mfma_f32_32x32x16_bf16 v[48:63], v[16:19], a[0:3], 0
    ds_read_b128 v[16:19], v6 offset:6144
    s_add_u32 m0, s18, 0
    v_add_f32 v64, v64, v65
    v_mfma_f32_32x32x16_bf16 v[48:63], v[20:23], a[4:7], v[48:63]
    ds_read_b128 v[20:23], v6 offset:7168
    buffer_load_dwordx4 v2, s[24:27], s28 offen offset:0 lds
    v_add_f32 v64, v64, v66
    s_waitcnt lgkmcnt(4)
    v_mfma_f32_32x32x16_bf16 v[48:63], v[24:27], a[8:11], v[48:63]
    ds_read_b128 v[24:27], v6 offset:8192
    v_add_f32 v64, v64, v67
    v_add_f32 v64, v64, v68
    v_mfma_f32_32x32x16_bf16 v[48:63], v[28:31], a[12:15], v[48:63]
    ds_read_b128 v[28:31], v6 offset:9216
    s_waitcnt vmcnt(38)
    v_add_f32 v64, v64, v69
    s_waitcnt lgkmcnt(4)
    v_mfma_f32_32x32x16_bf16 v[48:63], v[32:35], a[16:19], v[48:63]
    ds_read_b128 v[32:35], v6 offset:10240
    buffer_load_dwordx4 v2, s[24:27], s28 offen offset:1024 lds
    v_add_f32 v64, v64, v70
    v_mfma_f32_32x32x16_bf16 v[48:63], v[36:39], a[20:23], v[48:63]
    ds_read_b128 v[36:39], v6 offset:11264
    v_add_f32 v64, v64, v71
    v_add_f32 v64, v64, v72
    s_waitcnt lgkmcnt(4)
    v_mfma_f32_32x32x16_bf16 v[48:63], v[16:19], a[24:27], v[48:63]
    ds_read_b128 v[16:19], v6 offset:12288
    v_add_f32 v64, v64, v73
    v_add_f32 v64, v64, v74
    v_mfma_f32_32x32x16_bf16 v[48:63], v[20:23], a[28:31], v[48:63]
    ds_read_b128 v[20:23], v6 offset:13312
    buffer_load_dwordx4 v0, s[24:27], s28 offen offset:2048 lds
    s_waitcnt vmcnt(36)
    s_waitcnt lgkmcnt(4)
    v_mfma_f32_32x32x16_bf16 v[48:63], v[24:27], a[32:35], v[48:63]
    ds_read_b128 v[24:27], v6 offset:14336
    v_add_f32 v64, v64, v75
    v_mfma_f32_32x32x16_bf16 v[48:63], v[28:31], a[36:39], v[48:63]
    ds_read_b128 v[28:31], v6 offset:15360
    v_add_f32 v64, v64, v76
    v_add_f32 v64, v64, v77
    s_waitcnt lgkmcnt(4)
    v_mfma_f32_32x32x16_bf16 v[48:63], v[32:35], a[40:43], v[48:63]
    ds_read_b128 v[32:35], v6 offset:16384
    buffer_load_dwordx4 v10, s[24:27], s28 offen offset:3072 lds
    v_add_f32 v64, v64, v78
    v_mfma_f32_32x32x16_bf16 v[48:63], v[36:39], a[44:47], v[48:63]
    ds_read_b128 v[36:39], v6 offset:17408
    s_waitcnt vmcnt(33)
    v_add_f32 v64, v64, v79
    s_waitcnt lgkmcnt(4)
    v_mfma_f32_32x32x16_bf16 v[48:63], v[16:19], a[48:51], v[48:63]
    ds_read_b128 v[16:19], v6 offset:18432
    s_add_u32 m0, s18, 4096
    v_add_f32 v64, v64, v40
    v_mfma_f32_32x32x16_bf16 v[48:63], v[20:23], a[52:55], v[48:63]
    ds_read_b128 v[20:23], v6 offset:19456
    buffer_load_dwordx4 v1, s[24:27], s29 offen offset:0 lds
    v_add_f32 v64, v64, v41
    s_waitcnt lgkmcnt(4)
    v_mfma_f32_32x32x16_bf16 v[48:63], v[24:27], a[56:59], v[48:63]
    ds_read_b128 v[24:27], v6 offset:20480
    v_mov_b32 v65, v64
    v_mfma_f32_32x32x16_bf16 v[48:63], v[28:31], a[60:63], v[48:63]
    ds_read_b128 v[28:31], v6 offset:21504
    s_waitcnt vmcnt(30)
    s_nop 1
    s_waitcnt lgkmcnt(4)
    v_mfma_f32_32x32x16_bf16 v[48:63], v[32:35], a[64:67], v[48:63]
    ds_read_b128 v[32:35], v6 offset:22528
    buffer_load_dwordx4 v2, s[24:27], s29 offen offset:1024 lds
    v_permlane32_swap_b32 v64, v65
    v_mfma_f32_32x32x16_bf16 v[48:63], v[36:39], a[68:71], v[48:63]
    ds_read_b128 v[36:39], v6 offset:23552
    v_mul_f32 v64, 0x3ae38e39, v64
    v_mul_f32 v65, 0x3ae38e39, v65
    s_waitcnt lgkmcnt(4)
    v_mfma_f32_32x32x16_bf16 v[48:63], v[16:19], a[72:75], v[48:63]
    ds_read_b128 v[16:19], v6 offset:24576
    v_fma_f32 v65, -v64, v64, v65
    v_max_f32 v65, 0, v65
    v_mfma_f32_32x32x16_bf16 v[48:63], v[20:23], a[76:79], v[48:63]
    ds_read_b128 v[20:23], v6 offset:25600
    buffer_load_dwordx4 v11, s[24:27], s29 offen offset:2048 lds
    s_waitcnt vmcnt(28)
    s_waitcnt lgkmcnt(4)
    v_mfma_f32_32x32x16_bf16 v[48:63], v[24:27], a[80:83], v[48:63]
    ds_read_b128 v[24:27], v6 offset:26624
    v_add_f32 v65, 0x3727c5ac, v65
    v_mfma_f32_32x32x16_bf16 v[48:63], v[28:31], a[84:87], v[48:63]
    ds_read_b128 v[28:31], v6 offset:27648
    v_sqrt_f32 v5, v65
    s_nop 0
    s_waitcnt lgkmcnt(4)
    v_mfma_f32_32x32x16_bf16 v[48:63], v[32:35], a[88:91], v[48:63]
    ds_read_b128 v[32:35], v6 offset:28672
    buffer_load_dwordx4 v10, s[24:27], s29 offen offset:3072 lds
    v_mfma_f32_32x32x16_bf16 v[48:63], v[36:39], a[92:95], v[48:63]
    ds_read_b128 v[36:39], v6 offset:29696
    s_waitcnt vmcnt(25)
    v_rcp_f32 v66, v5
    s_waitcnt lgkmcnt(4)
    v_mfma_f32_32x32x16_bf16 v[48:63], v[16:19], a[96:99], v[48:63]
    ds_read_b128 v[16:19], v6 offset:30720
    s_add_u32 m0, s18, 8192
    v_mfma_f32_32x32x16_bf16 v[48:63], v[20:23], a[100:103], v[48:63]
    ds_read_b128 v[20:23], v6 offset:31744
    buffer_load_dwordx4 v10, s[24:27], s31 offen offset:0 lds
    s_nop 0
    s_waitcnt lgkmcnt(4)
    v_mfma_f32_32x32x16_bf16 v[48:63], v[24:27], a[104:107], v[48:63]
    ds_read_b128 v[24:27], v6 offset:32768
    v_mul_f32 v4, 0xc0135761, v66
    v_mul_f32 v67, v66, v66
    v_mfma_f32_32x32x16_bf16 v[48:63], v[28:31], a[108:111], v[48:63]
    ds_read_b128 v[28:31], v6 offset:33792
    s_add_u32 s28, s28, 36864
    s_add_u32 s29, s29, 36864
    s_add_u32 s31, s31, 36864
    s_waitcnt vmcnt(22)
    s_waitcnt lgkmcnt(4)
    v_mfma_f32_32x32x16_bf16 v[48:63], v[32:35], a[112:115], v[48:63]
    ds_read_b128 v[32:35], v6 offset:34816
    v_mfma_f32_32x32x16_bf16 v[48:63], v[36:39], a[116:119], v[48:63]
    ds_read_b128 v[36:39], v6 offset:35840
    v_mul_f32 v67, v67, v66
    v_mul_f32 v3, 0xbdd2d3e8, v67
    s_waitcnt lgkmcnt(4)
    v_mfma_f32_32x32x16_bf16 v[48:63], v[16:19], a[120:123], v[48:63]
    s_waitcnt vmcnt(9)
    s_barrier
    ds_read_b128 v[16:19], v13 offset:0
    v_mfma_f32_32x32x16_bf16 v[48:63], v[20:23], a[124:127], v[48:63]
    ds_read_b128 v[20:23], v13 offset:1024
    s_waitcnt vmcnt(18)
    s_waitcnt lgkmcnt(4)
    v_mfma_f32_32x32x16_bf16 v[48:63], v[24:27], a[128:131], v[48:63]
    ds_read_b128 v[24:27], v13 offset:2048
    v_mfma_f32_32x32x16_bf16 v[48:63], v[28:31], a[132:135], v[48:63]
    ds_read_b128 v[28:31], v13 offset:3072
    s_waitcnt lgkmcnt(4)
    v_mfma_f32_32x32x16_bf16 v[48:63], v[32:35], a[136:139], v[48:63]
    ds_read_b128 v[32:35], v13 offset:4096
    v_mfma_f32_32x32x16_bf16 v[48:63], v[36:39], a[140:143], v[48:63]
    ds_read_b128 v[36:39], v13 offset:5120
    s_waitcnt lgkmcnt(4)
    v_mfma_f32_32x32x16_bf16 v[64:79], v[16:19], a[0:3], 0
    ds_read_b128 v[16:19], v13 offset:6144
    s_add_u32 m0, s18, 73728
    v_mfma_f32_32x32x16_bf16 v[64:79], v[20:23], a[4:7], v[64:79]
    ds_read_b128 v[20:23], v13 offset:7168
    buffer_load_dwordx4 v2, s[12:15], s19 offen offset:0 sc1 lds
    s_waitcnt lgkmcnt(4)
    v_mfma_f32_32x32x16_bf16 v[64:79], v[24:27], a[8:11], v[64:79]
    ds_read_b128 v[24:27], v13 offset:8192
    v_mfma_f32_32x32x16_bf16 v[64:79], v[28:31], a[12:15], v[64:79]
    ds_read_b128 v[28:31], v13 offset:9216
    v_mul_f32 v6, v48, v48
    v_mul_f32 v7, v49, v49
    v_mul_f32 v8, v50, v50
    v_mul_f32 v9, v51, v51
    v_fma_f32 v6, v6, v3, v4
    s_waitcnt lgkmcnt(4)
    v_mfma_f32_32x32x16_bf16 v[64:79], v[32:35], a[16:19], v[64:79]
    ds_read_b128 v[32:35], v13 offset:10240
    buffer_load_dwordx4 v2, s[12:15], s19 offen offset:1024 sc1 lds
    v_fma_f32 v7, v7, v3, v4
    v_fma_f32 v8, v8, v3, v4
    v_fma_f32 v9, v9, v3, v4
    v_mul_f32 v6, v48, v6
    v_mul_f32 v7, v49, v7
    v_mfma_f32_32x32x16_bf16 v[64:79], v[36:39], a[20:23], v[64:79]
    ds_read_b128 v[36:39], v13 offset:11264
    v_mul_f32 v8, v50, v8
    v_mul_f32 v9, v51, v9
    v_exp_f32 v6, v6
    v_exp_f32 v7, v7
    s_waitcnt lgkmcnt(4)
    v_mfma_f32_32x32x16_bf16 v[64:79], v[16:19], a[24:27], v[64:79]
    ds_read_b128 v[16:19], v13 offset:12288
    v_exp_f32 v8, v8
    v_exp_f32 v9, v9
    v_fma_f32 v6, v6, v5, v5
    v_mfma_f32_32x32x16_bf16 v[64:79], v[20:23], a[28:31], v[64:79]
    ds_read_b128 v[20:23], v13 offset:13312
    buffer_load_dwordx4 v2, s[12:15], s19 offen offset:2048 sc1 lds
    v_fma_f32 v7, v7, v5, v5
    v_fma_f32 v8, v8, v5, v5
    v_fma_f32 v9, v9, v5, v5
    s_waitcnt lgkmcnt(4)
    v_mfma_f32_32x32x16_bf16 v[64:79], v[24:27], a[32:35], v[64:79]
    ds_read_b128 v[24:27], v13 offset:14336
    v_rcp_f32 v6, v6
    v_rcp_f32 v7, v7
    v_rcp_f32 v8, v8
    v_mfma_f32_32x32x16_bf16 v[64:79], v[28:31], a[36:39], v[64:79]
    ds_read_b128 v[28:31], v13 offset:15360
    v_rcp_f32 v9, v9
    v_mul_f32 v48, v48, v6
    v_mul_f32 v49, v49, v7
    v_mul_f32 v50, v50, v8
    v_mul_f32 v51, v51, v9
    s_waitcnt lgkmcnt(4)
    v_mfma_f32_32x32x16_bf16 v[64:79], v[32:35], a[40:43], v[64:79]
    ds_read_b128 v[32:35], v13 offset:16384
    buffer_load_dwordx4 v2, s[12:15], s19 offen offset:3072 sc1 lds
    v_mul_f32 v6, v52, v52
    v_mul_f32 v7, v53, v53
    v_mul_f32 v8, v54, v54
    v_mul_f32 v9, v55, v55
    v_mfma_f32_32x32x16_bf16 v[64:79], v[36:39], a[44:47], v[64:79]
    ds_read_b128 v[36:39], v13 offset:17408
    v_fma_f32 v6, v6, v3, v4
    v_fma_f32 v7, v7, v3, v4
    v_fma_f32 v8, v8, v3, v4
    v_fma_f32 v9, v9, v3, v4
    v_mul_f32 v6, v52, v6
    s_waitcnt lgkmcnt(4)
    v_mfma_f32_32x32x16_bf16 v[64:79], v[16:19], a[48:51], v[64:79]
    ds_read_b128 v[16:19], v13 offset:18432
    s_add_u32 m0, s18, 77824
    v_mul_f32 v7, v53, v7
    v_mul_f32 v8, v54, v8
    v_mul_f32 v9, v55, v9
    v_exp_f32 v6, v6
    v_mfma_f32_32x32x16_bf16 v[64:79], v[20:23], a[52:55], v[64:79]
    ds_read_b128 v[20:23], v13 offset:19456
    buffer_load_dwordx4 v2, s[12:15], s20 offen offset:0 sc1 lds
    v_exp_f32 v7, v7
    v_exp_f32 v8, v8
    s_waitcnt lgkmcnt(4)
    v_mfma_f32_32x32x16_bf16 v[64:79], v[24:27], a[56:59], v[64:79]
    ds_read_b128 v[24:27], v13 offset:20480
    v_exp_f32 v9, v9
    v_fma_f32 v6, v6, v5, v5
    v_fma_f32 v7, v7, v5, v5
    v_fma_f32 v8, v8, v5, v5
    v_fma_f32 v9, v9, v5, v5
    v_mfma_f32_32x32x16_bf16 v[64:79], v[28:31], a[60:63], v[64:79]
    ds_read_b128 v[28:31], v13 offset:21504
    v_rcp_f32 v6, v6
    v_rcp_f32 v7, v7
    s_waitcnt lgkmcnt(4)
    v_mfma_f32_32x32x16_bf16 v[64:79], v[32:35], a[64:67], v[64:79]
    ds_read_b128 v[32:35], v13 offset:22528
    buffer_load_dwordx4 v2, s[12:15], s20 offen offset:1024 sc1 lds
    v_rcp_f32 v8, v8
    v_rcp_f32 v9, v9
    v_mul_f32 v52, v52, v6
    v_mfma_f32_32x32x16_bf16 v[64:79], v[36:39], a[68:71], v[64:79]
    ds_read_b128 v[36:39], v13 offset:23552
    v_mul_f32 v53, v53, v7
    v_mul_f32 v54, v54, v8
    v_mul_f32 v55, v55, v9
    v_mul_f32 v6, v56, v56
    v_mul_f32 v7, v57, v57
    v_mul_f32 v8, v58, v58
    s_waitcnt lgkmcnt(4)
    v_mfma_f32_32x32x16_bf16 v[64:79], v[16:19], a[72:75], v[64:79]
    ds_read_b128 v[16:19], v13 offset:24576
    v_mul_f32 v9, v59, v59
    v_fma_f32 v6, v6, v3, v4
    v_fma_f32 v7, v7, v3, v4
    v_fma_f32 v8, v8, v3, v4
    v_fma_f32 v9, v9, v3, v4
    v_mfma_f32_32x32x16_bf16 v[64:79], v[20:23], a[76:79], v[64:79]
    ds_read_b128 v[20:23], v13 offset:25600
    buffer_load_dwordx4 v2, s[12:15], s20 offen offset:2048 sc1 lds
    v_mul_f32 v6, v56, v6
    v_mul_f32 v7, v57, v7
    v_mul_f32 v8, v58, v8
    v_mul_f32 v9, v59, v9
    s_waitcnt lgkmcnt(4)
    v_mfma_f32_32x32x16_bf16 v[64:79], v[24:27], a[80:83], v[64:79]
    ds_read_b128 v[24:27], v13 offset:26624
    v_exp_f32 v6, v6
    v_exp_f32 v7, v7
    v_exp_f32 v8, v8
    v_mfma_f32_32x32x16_bf16 v[64:79], v[28:31], a[84:87], v[64:79]
    ds_read_b128 v[28:31], v13 offset:27648
    v_exp_f32 v9, v9
    v_fma_f32 v6, v6, v5, v5
    v_fma_f32 v7, v7, v5, v5
    v_fma_f32 v8, v8, v5, v5
    s_waitcnt lgkmcnt(4)
    v_mfma_f32_32x32x16_bf16 v[64:79], v[32:35], a[88:91], v[64:79]
    ds_read_b128 v[32:35], v13 offset:28672
    buffer_load_dwordx4 v2, s[12:15], s20 offen offset:3072 sc1 lds
    v_fma_f32 v9, v9, v5, v5
    v_rcp_f32 v6, v6
    v_rcp_f32 v7, v7
    v_mfma_f32_32x32x16_bf16 v[64:79], v[36:39], a[92:95], v[64:79]
    ds_read_b128 v[36:39], v13 offset:29696
    v_rcp_f32 v8, v8
    v_rcp_f32 v9, v9
    v_mul_f32 v56, v56, v6
    s_waitcnt lgkmcnt(4)
    v_mfma_f32_32x32x16_bf16 v[64:79], v[16:19], a[96:99], v[64:79]
    ds_read_b128 v[16:19], v13 offset:30720
    s_add_u32 m0, s18, 81920
    v_mul_f32 v57, v57, v7
    v_mul_f32 v58, v58, v8
    v_mul_f32 v59, v59, v9
    v_mul_f32 v6, v60, v60
    v_mfma_f32_32x32x16_bf16 v[64:79], v[20:23], a[100:103], v[64:79]
    ds_read_b128 v[20:23], v13 offset:31744
    buffer_load_dwordx4 v2, s[12:15], s21 offen offset:0 sc1 lds
    v_mul_f32 v7, v61, v61
    v_mul_f32 v8, v62, v62
    v_mul_f32 v9, v63, v63
    v_fma_f32 v6, v6, v3, v4
    v_fma_f32 v7, v7, v3, v4
    s_waitcnt lgkmcnt(4)
    v_mfma_f32_32x32x16_bf16 v[64:79], v[24:27], a[104:107], v[64:79]
    ds_read_b128 v[24:27], v13 offset:32768
    v_fma_f32 v8, v8, v3, v4
    v_fma_f32 v9, v9, v3, v4
    v_mul_f32 v6, v60, v6
    v_mul_f32 v7, v61, v7
    v_mul_f32 v8, v62, v8
    v_mfma_f32_32x32x16_bf16 v[64:79], v[28:31], a[108:111], v[64:79]
    ds_read_b128 v[28:31], v13 offset:33792
    s_add_u32 s19, s19, 36864
    s_add_u32 s20, s20, 36864
    s_add_u32 s21, s21, 36864
    v_mul_f32 v9, v63, v9
    v_exp_f32 v6, v6
    s_waitcnt lgkmcnt(4)
    v_mfma_f32_32x32x16_bf16 v[64:79], v[32:35], a[112:115], v[64:79]
    ds_read_b128 v[32:35], v13 offset:34816
    v_exp_f32 v7, v7
    v_exp_f32 v8, v8
    v_mfma_f32_32x32x16_bf16 v[64:79], v[36:39], a[116:119], v[64:79]
    ds_read_b128 v[36:39], v13 offset:35840
    v_exp_f32 v9, v9
    v_fma_f32 v6, v6, v5, v5
    v_fma_f32 v7, v7, v5, v5
    v_fma_f32 v8, v8, v5, v5
    v_fma_f32 v9, v9, v5, v5
    s_waitcnt lgkmcnt(4)
    v_mfma_f32_32x32x16_bf16 v[64:79], v[16:19], a[120:123], v[64:79]
    s_waitcnt vmcnt(9)
    s_barrier
    ds_read_b64_tr_b16 v[16:17], v14 offset:0
    ds_read_b64_tr_b16 v[18:19], v14 offset:4608
    v_rcp_f32 v6, v6
    v_mfma_f32_32x32x16_bf16 v[64:79], v[20:23], a[124:127], v[64:79]
    ds_read_b64_tr_b16 v[20:21], v15 offset:0
    ds_read_b64_tr_b16 v[22:23], v15 offset:4608
    v_rcp_f32 v7, v7
    v_rcp_f32 v8, v8
    s_waitcnt lgkmcnt(6)
    v_mfma_f32_32x32x16_bf16 v[64:79], v[24:27], a[128:131], v[64:79]
    ds_read_b64_tr_b16 v[24:25], v14 offset:128
    ds_read_b64_tr_b16 v[26:27], v14 offset:4736
    v_rcp_f32 v9, v9
    v_mul_f32 v60, v60, v6
    v_mul_f32 v61, v61, v7
    v_mul_f32 v62, v62, v8
    v_mfma_f32_32x32x16_bf16 v[64:79], v[28:31], a[132:135], v[64:79]
    ds_read_b64_tr_b16 v[28:29], v15 offset:128
    ds_read_b64_tr_b16 v[30:31], v15 offset:4736
    v_mul_f32 v63, v63, v9
    v_cvt_pk_bf16_f32 v40, v48, v49
    v_cvt_pk_bf16_f32 v41, v50, v51
    v_cvt_pk_bf16_f32 v42, v52, v53
    v_cvt_pk_bf16_f32 v43, v54, v55
    s_waitcnt lgkmcnt(8)
    v_mfma_f32_32x32x16_bf16 v[64:79], v[32:35], a[136:139], v[64:79]
    ds_read_b64_tr_b16 v[32:33], v14 offset:256
    ds_read_b64_tr_b16 v[34:35], v14 offset:4864
    v_cvt_pk_bf16_f32 v44, v56, v57
    v_cvt_pk_bf16_f32 v45, v58, v59
    v_cvt_pk_bf16_f32 v46, v60, v61
    v_cvt_pk_bf16_f32 v47, v62, v63
    v_mfma_f32_32x32x16_bf16 v[64:79], v[36:39], a[140:143], v[64:79]
    ds_read_b64_tr_b16 v[36:37], v15 offset:256
    ds_read_b64_tr_b16 v[38:39], v15 offset:4864
    s_waitcnt lgkmcnt(8)
    s_mov_b32 s22, 8
.p2align 6
L3_mlp_loop:
    s_cmp_eq_u32 s8, 0
    s_cbranch_scc0 L3_mlp_nochk
    s_cmp_eq_u32 s22, 6
    s_cbranch_scc0 L3_mlp_chk
    s_mul_i32 s48, s6, 128
    s_add_u32 s48, s48, 39616640
    s_mov_b32 m0, 147456
    s_nop 0
    buffer_load_dword off, s[12:15], s48 sc1 lds
    s_branch L3_mlp_nochk
L3_mlp_chk:
    s_cmp_eq_u32 s22, 5
    s_cbranch_scc0 L3_mlp_nochk
    v_mov_b32 v6, 147456
    ds_read_b32 v6, v6
    s_waitcnt lgkmcnt(0)
    v_readfirstlane_b32 s52, v6
    s_cmp_ge_u32 s52, 15
    s_cbranch_scc1 L3_mlp_nochk
    s_mul_i32 s48, s6, 128
    s_add_u32 s48, s48, 8320
    s_cmp_eq_u32 s8, 0
    s_cbranch_scc0 Lwaits_5176_done
    s_mov_b32 s50, 0x40000
Lwaits_5176:
    s_mov_b32 s51, 1
    s_add_u32 s46, s34, s48
    s_addc_u32 s47, s35, 0
    v_mov_b32 v6, 0
    global_load_dword v6, v6, s[46:47] sc1
    s_waitcnt vmcnt(0)
    v_readfirstlane_b32 s52, v6
    s_cmp_ge_u32 s52, 15
    s_cselect_b32 s51, s51, 0
    s_cmp_eq_u32 s51, 1
    s_cbranch_scc1 Lwaits_5176_done
    s_sub_u32 s50, s50, 1
    s_cmp_lg_u32 s50, 0
    s_cbranch_scc1 Lwaits_5176
Lwaits_5176_done:
L3_mlp_nochk:
    v_mfma_f32_32x32x16_bf16 v[80:95], v[16:19], v[40:43], v[80:95]
    ds_read_b64_tr_b16 v[16:17], v14 offset:384
    ds_read_b64_tr_b16 v[18:19], v14 offset:4992
    s_add_u32 m0, s18, 36864
    v_mfma_f32_32x32x16_bf16 v[96:111], v[20:23], v[40:43], v[96:111]
    ds_read_b64_tr_b16 v[20:21], v15 offset:384
    ds_read_b64_tr_b16 v[22:23], v15 offset:4992
    buffer_load_dwordx4 v2, s[24:27], s28 offen offset:0 lds
    s_waitcnt lgkmcnt(8)
    v_mfma_f32_32x32x16_bf16 v[112:127], v[24:27], v[40:43], v[112:127]
    ds_read_b64_tr_b16 v[24:25], v14 offset:512
    ds_read_b64_tr_b16 v[26:27], v14 offset:5120
    v_mfma_f32_32x32x16_bf16 v[128:143], v[28:31], v[40:43], v[128:143]
    ds_read_b64_tr_b16 v[28:29], v15 offset:512
    ds_read_b64_tr_b16 v[30:31], v15 offset:5120
    v_mul_f32 v6, v64, v64
    v_mul_f32 v7, v65, v65
    s_waitcnt lgkmcnt(8)
    v_mfma_f32_32x32x16_bf16 v[144:159], v[32:35], v[40:43], v[144:159]
    ds_read_b64_tr_b16 v[32:33], v14 offset:640
    ds_read_b64_tr_b16 v[34:35], v14 offset:5248
    buffer_load_dwordx4 v2, s[24:27], s28 offen offset:1024 lds
    v_mul_f32 v8, v66, v66
    v_mul_f32 v9, v67, v67
    v_mfma_f32_32x32x16_bf16 v[160:175], v[36:39], v[40:43], v[160:175]
    ds_read_b64_tr_b16 v[36:37], v15 offset:640
    ds_read_b64_tr_b16 v[38:39], v15 offset:5248
    v_fma_f32 v6, v6, v3, v4
    v_fma_f32 v7, v7, v3, v4
    s_waitcnt lgkmcnt(8)
    v_mfma_f32_32x32x16_bf16 v[176:191], v[16:19], v[40:43], v[176:191]
    ds_read_b64_tr_b16 v[16:17], v14 offset:768
    ds_read_b64_tr_b16 v[18:19], v14 offset:5376
    v_fma_f32 v8, v8, v3, v4
    v_fma_f32 v9, v9, v3, v4
    v_mul_f32 v6, v64, v6
    v_mfma_f32_32x32x16_bf16 v[192:207], v[20:23], v[40:43], v[192:207]
    ds_read_b64_tr_b16 v[20:21], v15 offset:768
    ds_read_b64_tr_b16 v[22:23], v15 offset:5376
    buffer_load_dwordx4 v0, s[24:27], s28 offen offset:2048 lds
    v_mul_f32 v7, v65, v7
    s_waitcnt lgkmcnt(8)
    v_mfma_f32_32x32x16_bf16 v[208:223], v[24:27], v[40:43], v[208:223]
    ds_read_b64_tr_b16 v[24:25], v14 offset:896
    ds_read_b64_tr_b16 v[26:27], v14 offset:5504
    v_mul_f32 v8, v66, v8
    v_mul_f32 v9, v67, v9
    v_mfma_f32_32x32x16_bf16 v[224:239], v[28:31], v[40:43], v[224:239]
    ds_read_b64_tr_b16 v[28:29], v15 offset:896
    ds_read_b64_tr_b16 v[30:31], v15 offset:5504
    v_exp_f32 v6, v6
    v_exp_f32 v7, v7
    s_waitcnt lgkmcnt(8)
    v_mfma_f32_32x32x16_bf16 v[240:255], v[32:35], v[40:43], v[240:255]
    ds_read_b64_tr_b16 v[32:33], v14 offset:1024
    ds_read_b64_tr_b16 v[34:35], v14 offset:5632
    buffer_load_dwordx4 v10, s[24:27], s28 offen offset:3072 lds
    v_mfma_f32_32x32x16_bf16 a[144:159], v[36:39], v[40:43], a[144:159]
    ds_read_b64_tr_b16 v[36:37], v15 offset:1024
    ds_read_b64_tr_b16 v[38:39], v15 offset:5632
    v_exp_f32 v8, v8
    v_exp_f32 v9, v9
    s_waitcnt lgkmcnt(8)
    v_mfma_f32_32x32x16_bf16 a[160:175], v[16:19], v[40:43], a[160:175]
    ds_read_b64_tr_b16 v[16:17], v14 offset:18432
    ds_read_b64_tr_b16 v[18:19], v14 offset:23040
    s_add_u32 m0, s18, 40960
    v_fma_f32 v6, v6, v5, v5
    v_mfma_f32_32x32x16_bf16 a[176:191], v[20:23], v[40:43], a[176:191]
    ds_read_b64_tr_b16 v[20:21], v15 offset:18432
    ds_read_b64_tr_b16 v[22:23], v15 offset:23040
    buffer_load_dwordx4 v1, s[24:27], s29 offen offset:0 lds
    v_fma_f32 v7, v7, v5, v5
    s_waitcnt lgkmcnt(8)
    v_mfma_f32_32x32x16_bf16 a[192:207], v[24:27], v[40:43], a[192:207]
    ds_read_b64_tr_b16 v[24:25], v14 offset:18560
    ds_read_b64_tr_b16 v[26:27], v14 offset:23168
    v_fma_f32 v8, v8, v5, v5
    v_fma_f32 v9, v9, v5, v5
    v_mfma_f32_32x32x16_bf16 a[208:223], v[28:31], v[40:43], a[208:223]
    ds_read_b64_tr_b16 v[28:29], v15 offset:18560
    ds_read_b64_tr_b16 v[30:31], v15 offset:23168
    v_rcp_f32 v6, v6
    s_waitcnt lgkmcnt(8)
    v_mfma_f32_32x32x16_bf16 a[224:239], v[32:35], v[40:43], a[224:239]
    ds_read_b64_tr_b16 v[32:33], v14 offset:18688
    ds_read_b64_tr_b16 v[34:35], v14 offset:23296
    buffer_load_dwordx4 v2, s[24:27], s29 offen offset:1024 lds
    v_rcp_f32 v7, v7
    v_mfma_f32_32x32x16_bf16 a[240:255], v[36:39], v[40:43], a[240:255]
    ds_read_b64_tr_b16 v[36:37], v15 offset:18688
    ds_read_b64_tr_b16 v[38:39], v15 offset:23296
    v_rcp_f32 v8, v8
    s_waitcnt lgkmcnt(8)
    v_mfma_f32_32x32x16_bf16 v[80:95], v[16:19], v[44:47], v[80:95]
    ds_read_b64_tr_b16 v[16:17], v14 offset:18816
    ds_read_b64_tr_b16 v[18:19], v14 offset:23424
    v_rcp_f32 v9, v9
    v_mul_f32 v64, v64, v6
    v_mfma_f32_32x32x16_bf16 v[96:111], v[20:23], v[44:47], v[96:111]
    ds_read_b64_tr_b16 v[20:21], v15 offset:18816
    ds_read_b64_tr_b16 v[22:23], v15 offset:23424
    buffer_load_dwordx4 v11, s[24:27], s29 offen offset:2048 lds
    v_mul_f32 v65, v65, v7
    v_mul_f32 v66, v66, v8
    s_waitcnt lgkmcnt(8)
    v_mfma_f32_32x32x16_bf16 v[112:127], v[24:27], v[44:47], v[112:127]
    ds_read_b64_tr_b16 v[24:25], v14 offset:18944
    ds_read_b64_tr_b16 v[26:27], v14 offset:23552
    v_mul_f32 v67, v67, v9
    v_mul_f32 v6, v68, v68
    v_mfma_f32_32x32x16_bf16 v[128:143], v[28:31], v[44:47], v[128:143]
    ds_read_b64_tr_b16 v[28:29], v15 offset:18944
    ds_read_b64_tr_b16 v[30:31], v15 offset:23552
    v_mul_f32 v7, v69, v69
    v_mul_f32 v8, v70, v70
    v_mul_f32 v9, v71, v71
    s_waitcnt lgkmcnt(8)
    v_mfma_f32_32x32x16_bf16 v[144:159], v[32:35], v[44:47], v[144:159]
    ds_read_b64_tr_b16 v[32:33], v14 offset:19072
    ds_read_b64_tr_b16 v[34:35], v14 offset:23680
    buffer_load_dwordx4 v10, s[24:27], s29 offen offset:3072 lds
    v_fma_f32 v6, v6, v3, v4
    v_mfma_f32_32x32x16_bf16 v[160:175], v[36:39], v[44:47], v[160:175]
    ds_read_b64_tr_b16 v[36:37], v15 offset:19072
    ds_read_b64_tr_b16 v[38:39], v15 offset:23680
    v_fma_f32 v7, v7, v3, v4
    v_fma_f32 v8, v8, v3, v4
    v_fma_f32 v9, v9, v3, v4
    s_waitcnt lgkmcnt(8)
    v_mfma_f32_32x32x16_bf16 v[176:191], v[16:19], v[44:47], v[176:191]
    ds_read_b64_tr_b16 v[16:17], v14 offset:19200
    ds_read_b64_tr_b16 v[18:19], v14 offset:23808
    s_add_u32 m0, s18, 45056
    v_mul_f32 v6, v68, v6
    v_mfma_f32_32x32x16_bf16 v[192:207], v[20:23], v[44:47], v[192:207]
    ds_read_b64_tr_b16 v[20:21], v15 offset:19200
    ds_read_b64_tr_b16 v[22:23], v15 offset:23808
    buffer_load_dwordx4 v10, s[24:27], s31 offen offset:0 lds
    v_mul_f32 v7, v69, v7
    s_waitcnt lgkmcnt(8)
    v_mfma_f32_32x32x16_bf16 v[208:223], v[24:27], v[44:47], v[208:223]
    ds_read_b64_tr_b16 v[24:25], v14 offset:19328
    ds_read_b64_tr_b16 v[26:27], v14 offset:23936
    v_mul_f32 v8, v70, v8
    v_mul_f32 v9, v71, v9
    v_mfma_f32_32x32x16_bf16 v[224:239], v[28:31], v[44:47], v[224:239]
    ds_read_b64_tr_b16 v[28:29], v15 offset:19328
    ds_read_b64_tr_b16 v[30:31], v15 offset:23936
    s_add_u32 s28, s28, 36864
    s_add_u32 s29, s29, 36864
    s_add_u32 s31, s31, 36864
    s_waitcnt lgkmcnt(8)
    v_mfma_f32_32x32x16_bf16 v[240:255], v[32:35], v[44:47], v[240:255]
    ds_read_b64_tr_b16 v[32:33], v14 offset:19456
    ds_read_b64_tr_b16 v[34:35], v14 offset:24064
    v_exp_f32 v6, v6
    v_mfma_f32_32x32x16_bf16 a[144:159], v[36:39], v[44:47], a[144:159]
    ds_read_b64_tr_b16 v[36:37], v15 offset:19456
    ds_read_b64_tr_b16 v[38:39], v15 offset:24064
    v_exp_f32 v7, v7
    v_exp_f32 v8, v8
    s_waitcnt lgkmcnt(8)
    v_mfma_f32_32x32x16_bf16 a[160:175], v[16:19], v[44:47], a[160:175]
    s_waitcnt vmcnt(9)
    s_barrier
    ds_read_b128 v[16:19], v12 offset:0
    v_mfma_f32_32x32x16_bf16 a[176:191], v[20:23], v[44:47], a[176:191]
    ds_read_b128 v[20:23], v12 offset:1024
    v_exp_f32 v9, v9
    v_fma_f32 v6, v6, v5, v5
    v_fma_f32 v7, v7, v5, v5
    s_waitcnt lgkmcnt(6)
    v_mfma_f32_32x32x16_bf16 a[192:207], v[24:27], v[44:47], a[192:207]
    ds_read_b128 v[24:27], v12 offset:2048
    v_fma_f32 v8, v8, v5, v5
    v_fma_f32 v9, v9, v5, v5
    v_rcp_f32 v6, v6
    v_mfma_f32_32x32x16_bf16 a[208:223], v[28:31], v[44:47], a[208:223]
    ds_read_b128 v[28:31], v12 offset:3072
    v_rcp_f32 v7, v7
    v_rcp_f32 v8, v8
    s_waitcnt lgkmcnt(4)
    v_mfma_f32_32x32x16_bf16 a[224:239], v[32:35], v[44:47], a[224:239]
    ds_read_b128 v[32:35], v12 offset:4096
    v_rcp_f32 v9, v9
    v_mul_f32 v68, v68, v6
    v_mfma_f32_32x32x16_bf16 a[240:255], v[36:39], v[44:47], a[240:255]
    ds_read_b128 v[36:39], v12 offset:5120
    v_mul_f32 v69, v69, v7
    v_mul_f32 v70, v70, v8
    v_mul_f32 v71, v71, v9
    s_waitcnt lgkmcnt(4)
    v_mfma_f32_32x32x16_bf16 v[48:63], v[16:19], a[0:3], 0
    ds_read_b128 v[16:19], v12 offset:6144
    s_add_u32 m0, s18, 110592
    v_cvt_pk_bf16_f32 v40, v64, v65
    v_cvt_pk_bf16_f32 v41, v66, v67
    v_mfma_f32_32x32x16_bf16 v[48:63], v[20:23], a[4:7], v[48:63]
    ds_read_b128 v[20:23], v12 offset:7168
    buffer_load_dwordx4 v2, s[12:15], s19 offen offset:0 sc1 lds
    v_cvt_pk_bf16_f32 v42, v68, v69
    v_cvt_pk_bf16_f32 v43, v70, v71
    s_waitcnt lgkmcnt(4)
    v_mfma_f32_32x32x16_bf16 v[48:63], v[24:27], a[8:11], v[48:63]
    ds_read_b128 v[24:27], v12 offset:8192
    v_mul_f32 v6, v72, v72
    v_mul_f32 v7, v73, v73
    v_mul_f32 v8, v74, v74
    v_mfma_f32_32x32x16_bf16 v[48:63], v[28:31], a[12:15], v[48:63]
    ds_read_b128 v[28:31], v12 offset:9216
    v_mul_f32 v9, v75, v75
    v_fma_f32 v6, v6, v3, v4
    v_fma_f32 v7, v7, v3, v4
    s_waitcnt lgkmcnt(4)
    v_mfma_f32_32x32x16_bf16 v[48:63], v[32:35], a[16:19], v[48:63]
    ds_read_b128 v[32:35], v12 offset:10240
    buffer_load_dwordx4 v2, s[12:15], s19 offen offset:1024 sc1 lds
    v_fma_f32 v8, v8, v3, v4
    v_fma_f32 v9, v9, v3, v4
    v_mfma_f32_32x32x16_bf16 v[48:63], v[36:39], a[20:23], v[48:63]
    ds_read_b128 v[36:39], v12 offset:11264
    v_mul_f32 v6, v72, v6
    v_mul_f32 v7, v73, v7
    s_waitcnt lgkmcnt(4)
    v_mfma_f32_32x32x16_bf16 v[48:63], v[16:19], a[24:27], v[48:63]
    ds_read_b128 v[16:19], v12 offset:12288
    v_mul_f32 v8, v74, v8
    v_mul_f32 v9, v75, v9
    v_exp_f32 v6, v6
    v_mfma_f32_32x32x16_bf16 v[48:63], v[20:23], a[28:31], v[48:63]
    ds_read_b128 v[20:23], v12 offset:13312
    buffer_load_dwordx4 v2, s[12:15], s19 offen offset:2048 sc1 lds
    v_exp_f32 v7, v7
    s_waitcnt lgkmcnt(4)
    v_mfma_f32_32x32x16_bf16 v[48:63], v[24:27], a[32:35], v[48:63]
    ds_read_b128 v[24:27], v12 offset:14336
    v_exp_f32 v8, v8
    v_mfma_f32_32x32x16_bf16 v[48:63], v[28:31], a[36:39], v[48:63]
    ds_read_b128 v[28:31], v12 offset:15360
    v_exp_f32 v9, v9
    v_fma_f32 v6, v6, v5, v5
    s_waitcnt lgkmcnt(4)
    v_mfma_f32_32x32x16_bf16 v[48:63], v[32:35], a[40:43], v[48:63]
    ds_read_b128 v[32:35], v12 offset:16384
    buffer_load_dwordx4 v2, s[12:15], s19 offen offset:3072 sc1 lds
    v_fma_f32 v7, v7, v5, v5
    v_fma_f32 v8, v8, v5, v5
    v_mfma_f32_32x32x16_bf16 v[48:63], v[36:39], a[44:47], v[48:63]
    ds_read_b128 v[36:39], v12 offset:17408
    v_fma_f32 v9, v9, v5, v5
    v_rcp_f32 v6, v6
    s_waitcnt lgkmcnt(4)
    v_mfma_f32_32x32x16_bf16 v[48:63], v[16:19], a[48:51], v[48:63]
    ds_read_b128 v[16:19], v12 offset:18432
    s_add_u32 m0, s18, 114688
    v_rcp_f32 v7, v7
    v_mfma_f32_32x32x16_bf16 v[48:63], v[20:23], a[52:55], v[48:63]
    ds_read_b128 v[20:23], v12 offset:19456
    buffer_load_dwordx4 v2, s[12:15], s20 offen offset:0 sc1 lds
    v_rcp_f32 v8, v8
    s_waitcnt lgkmcnt(4)
    v_mfma_f32_32x32x16_bf16 v[48:63], v[24:27], a[56:59], v[48:63]
    ds_read_b128 v[24:27], v12 offset:20480
    v_rcp_f32 v9, v9
    v_mul_f32 v72, v72, v6
    v_mfma_f32_32x32x16_bf16 v[48:63], v[28:31], a[60:63], v[48:63]
    ds_read_b128 v[28:31], v12 offset:21504
    v_mul_f32 v73, v73, v7
    v_mul_f32 v74, v74, v8
    v_mul_f32 v75, v75, v9
    s_waitcnt lgkmcnt(4)
    v_mfma_f32_32x32x16_bf16 v[48:63], v[32:35], a[64:67], v[48:63]
    ds_read_b128 v[32:35], v12 offset:22528
    buffer_load_dwordx4 v2, s[12:15], s20 offen offset:1024 sc1 lds
    v_cvt_pk_bf16_f32 v44, v72, v73
    v_cvt_pk_bf16_f32 v45, v74, v75
    v_mfma_f32_32x32x16_bf16 v[48:63], v[36:39], a[68:71], v[48:63]
    ds_read_b128 v[36:39], v12 offset:23552
    v_mul_f32 v6, v76, v76
    v_mul_f32 v7, v77, v77
    s_waitcnt lgkmcnt(4)
    v_mfma_f32_32x32x16_bf16 v[48:63], v[16:19], a[72:75], v[48:63]
    ds_read_b128 v[16:19], v12 offset:24576
    v_mul_f32 v8, v78, v78
    v_mul_f32 v9, v79, v79
    v_fma_f32 v6, v6, v3, v4
    v_mfma_f32_32x32x16_bf16 v[48:63], v[20:23], a[76:79], v[48:63]
    ds_read_b128 v[20:23], v12 offset:25600
    buffer_load_dwordx4 v2, s[12:15], s20 offen offset:2048 sc1 lds
    v_fma_f32 v7, v7, v3, v4
    v_fma_f32 v8, v8, v3, v4
    s_waitcnt lgkmcnt(4)
    v_mfma_f32_32x32x16_bf16 v[48:63], v[24:27], a[80:83], v[48:63]
    ds_read_b128 v[24:27], v12 offset:26624
    v_fma_f32 v9, v9, v3, v4
    v_mul_f32 v6, v76, v6
    v_mul_f32 v7, v77, v7
    v_mfma_f32_32x32x16_bf16 v[48:63], v[28:31], a[84:87], v[48:63]
    ds_read_b128 v[28:31], v12 offset:27648
    v_mul_f32 v8, v78, v8
    v_mul_f32 v9, v79, v9
    v_exp_f32 v6, v6
    s_waitcnt lgkmcnt(4)
    v_mfma_f32_32x32x16_bf16 v[48:63], v[32:35], a[88:91], v[48:63]
    ds_read_b128 v[32:35], v12 offset:28672
    buffer_load_dwordx4 v2, s[12:15], s20 offen offset:3072 sc1 lds
    v_exp_f32 v7, v7
    v_mfma_f32_32x32x16_bf16 v[48:63], v[36:39], a[92:95], v[48:63]
    ds_read_b128 v[36:39], v12 offset:29696
    v_exp_f32 v8, v8
    s_waitcnt lgkmcnt(4)
    v_mfma_f32_32x32x16_bf16 v[48:63], v[16:19], a[96:99], v[48:63]
    ds_read_b128 v[16:19], v12 offset:30720
    s_add_u32 m0, s18, 118784
    v_exp_f32 v9, v9
    v_mfma_f32_32x32x16_bf16 v[48:63], v[20:23], a[100:103], v[48:63]
    ds_read_b128 v[20:23], v12 offset:31744
    buffer_load_dwordx4 v2, s[12:15], s21 offen offset:0 sc1 lds
    v_fma_f32 v6, v6, v5, v5
    v_fma_f32 v7, v7, v5, v5
    s_waitcnt lgkmcnt(4)
    v_mfma_f32_32x32x16_bf16 v[48:63], v[24:27], a[104:107], v[48:63]
    ds_read_b128 v[24:27], v12 offset:32768
    v_fma_f32 v8, v8, v5, v5
    v_fma_f32 v9, v9, v5, v5
    v_mfma_f32_32x32x16_bf16 v[48:63], v[28:31], a[108:111], v[48:63]
    ds_read_b128 v[28:31], v12 offset:33792
    s_add_u32 s19, s19, 36864
    s_add_u32 s20, s20, 36864
    s_add_u32 s21, s21, 36864
    s_waitcnt lgkmcnt(4)
    v_mfma_f32_32x32x16_bf16 v[48:63], v[32:35], a[112:115], v[48:63]
    ds_read_b128 v[32:35], v12 offset:34816
    v_rcp_f32 v6, v6
    v_rcp_f32 v7, v7
    v_mfma_f32_32x32x16_bf16 v[48:63], v[36:39], a[116:119], v[48:63]
    ds_read_b128 v[36:39], v12 offset:35840
    v_rcp_f32 v8, v8
    s_waitcnt lgkmcnt(4)
    v_mfma_f32_32x32x16_bf16 v[48:63], v[16:19], a[120:123], v[48:63]
    s_waitcnt vmcnt(9)
    s_barrier
    ds_read_b64_tr_b16 v[16:17], v14 offset:36864
    ds_read_b64_tr_b16 v[18:19], v14 offset:41472
    v_mfma_f32_32x32x16_bf16 v[48:63], v[20:23], a[124:127], v[48:63]
    ds_read_b64_tr_b16 v[20:21], v15 offset:36864
    ds_read_b64_tr_b16 v[22:23], v15 offset:41472
    v_rcp_f32 v9, v9
    s_waitcnt lgkmcnt(6)
    v_mfma_f32_32x32x16_bf16 v[48:63], v[24:27], a[128:131], v[48:63]
    ds_read_b64_tr_b16 v[24:25], v14 offset:36992
    ds_read_b64_tr_b16 v[26:27], v14 offset:41600
    v_mul_f32 v76, v76, v6
    v_mul_f32 v77, v77, v7
    v_mfma_f32_32x32x16_bf16 v[48:63], v[28:31], a[132:135], v[48:63]
    ds_read_b64_tr_b16 v[28:29], v15 offset:36992
    ds_read_b64_tr_b16 v[30:31], v15 offset:41600
    v_mul_f32 v78, v78, v8
    v_mul_f32 v79, v79, v9
    s_waitcnt lgkmcnt(8)
    v_mfma_f32_32x32x16_bf16 v[48:63], v[32:35], a[136:139], v[48:63]
    ds_read_b64_tr_b16 v[32:33], v14 offset:37120
    ds_read_b64_tr_b16 v[34:35], v14 offset:41728
    v_cvt_pk_bf16_f32 v46, v76, v77
    v_cvt_pk_bf16_f32 v47, v78, v79
    v_mfma_f32_32x32x16_bf16 v[48:63], v[36:39], a[140:143], v[48:63]
    ds_read_b64_tr_b16 v[36:37], v15 offset:37120
    ds_read_b64_tr_b16 v[38:39], v15 offset:41728
    s_waitcnt lgkmcnt(8)
    v_mfma_f32_32x32x16_bf16 v[80:95], v[16:19], v[40:43], v[80:95]
    ds_read_b64_tr_b16 v[16:17], v14 offset:37248
    ds_read_b64_tr_b16 v[18:19], v14 offset:41856
    s_add_u32 m0, s18, 0
    v_mfma_f32_32x32x16_bf16 v[96:111], v[20:23], v[40:43], v[96:111]
    ds_read_b64_tr_b16 v[20:21], v15 offset:37248
    ds_read_b64_tr_b16 v[22:23], v15 offset:41856
    buffer_load_dwordx4 v2, s[24:27], s28 offen offset:0 lds
    s_waitcnt lgkmcnt(8)
    v_mfma_f32_32x32x16_bf16 v[112:127], v[24:27], v[40:43], v[112:127]
    ds_read_b64_tr_b16 v[24:25], v14 offset:37376
    ds_read_b64_tr_b16 v[26:27], v14 offset:41984
    v_mfma_f32_32x32x16_bf16 v[128:143], v[28:31], v[40:43], v[128:143]
    ds_read_b64_tr_b16 v[28:29], v15 offset:37376
    ds_read_b64_tr_b16 v[30:31], v15 offset:41984
    v_mul_f32 v6, v48, v48
    v_mul_f32 v7, v49, v49
    s_waitcnt lgkmcnt(8)
    v_mfma_f32_32x32x16_bf16 v[144:159], v[32:35], v[40:43], v[144:159]
    ds_read_b64_tr_b16 v[32:33], v14 offset:37504
    ds_read_b64_tr_b16 v[34:35], v14 offset:42112
    buffer_load_dwordx4 v2, s[24:27], s28 offen offset:1024 lds
    v_mul_f32 v8, v50, v50
    v_mul_f32 v9, v51, v51
    v_mfma_f32_32x32x16_bf16 v[160:175], v[36:39], v[40:43], v[160:175]
    ds_read_b64_tr_b16 v[36:37], v15 offset:37504
    ds_read_b64_tr_b16 v[38:39], v15 offset:42112
    v_fma_f32 v6, v6, v3, v4
    v_fma_f32 v7, v7, v3, v4
    s_waitcnt lgkmcnt(8)
    v_mfma_f32_32x32x16_bf16 v[176:191], v[16:19], v[40:43], v[176:191]
    ds_read_b64_tr_b16 v[16:17], v14 offset:37632
    ds_read_b64_tr_b16 v[18:19], v14 offset:42240
    v_fma_f32 v8, v8, v3, v4
    v_fma_f32 v9, v9, v3, v4
    v_mul_f32 v6, v48, v6
    v_mfma_f32_32x32x16_bf16 v[192:207], v[20:23], v[40:43], v[192:207]
    ds_read_b64_tr_b16 v[20:21], v15 offset:37632
    ds_read_b64_tr_b16 v[22:23], v15 offset:42240
    buffer_load_dwordx4 v0, s[24:27], s28 offen offset:2048 lds
    v_mul_f32 v7, v49, v7
    s_waitcnt lgkmcnt(8)
    v_mfma_f32_32x32x16_bf16 v[208:223], v[24:27], v[40:43], v[208:223]
    ds_read_b64_tr_b16 v[24:25], v14 offset:37760
    ds_read_b64_tr_b16 v[26:27], v14 offset:42368
    v_mul_f32 v8, v50, v8
    v_mul_f32 v9, v51, v9
    v_mfma_f32_32x32x16_bf16 v[224:239], v[28:31], v[40:43], v[224:239]
    ds_read_b64_tr_b16 v[28:29], v15 offset:37760
    ds_read_b64_tr_b16 v[30:31], v15 offset:42368
    v_exp_f32 v6, v6
    v_exp_f32 v7, v7
    s_waitcnt lgkmcnt(8)
    v_mfma_f32_32x32x16_bf16 v[240:255], v[32:35], v[40:43], v[240:255]
    ds_read_b64_tr_b16 v[32:33], v14 offset:37888
    ds_read_b64_tr_b16 v[34:35], v14 offset:42496
    buffer_load_dwordx4 v10, s[24:27], s28 offen offset:3072 lds
    v_mfma_f32_32x32x16_bf16 a[144:159], v[36:39], v[40:43], a[144:159]
    ds_read_b64_tr_b16 v[36:37], v15 offset:37888
    ds_read_b64_tr_b16 v[38:39], v15 offset:42496
    v_exp_f32 v8, v8
    v_exp_f32 v9, v9
    s_waitcnt lgkmcnt(8)
    v_mfma_f32_32x32x16_bf16 a[160:175], v[16:19], v[40:43], a[160:175]
    ds_read_b64_tr_b16 v[16:17], v14 offset:55296
    ds_read_b64_tr_b16 v[18:19], v14 offset:59904
    s_add_u32 m0, s18, 4096
    v_fma_f32 v6, v6, v5, v5
    v_mfma_f32_32x32x16_bf16 a[176:191], v[20:23], v[40:43], a[176:191]
    ds_read_b64_tr_b16 v[20:21], v15 offset:55296
    ds_read_b64_tr_b16 v[22:23], v15 offset:59904
    buffer_load_dwordx4 v1, s[24:27], s29 offen offset:0 lds
    v_fma_f32 v7, v7, v5, v5
    s_waitcnt lgkmcnt(8)
    v_mfma_f32_32x32x16_bf16 a[192:207], v[24:27], v[40:43], a[192:207]
    ds_read_b64_tr_b16 v[24:25], v14 offset:55424
    ds_read_b64_tr_b16 v[26:27], v14 offset:60032
    v_fma_f32 v8, v8, v5, v5
    v_fma_f32 v9, v9, v5, v5
    v_mfma_f32_32x32x16_bf16 a[208:223], v[28:31], v[40:43], a[208:223]
    ds_read_b64_tr_b16 v[28:29], v15 offset:55424
    ds_read_b64_tr_b16 v[30:31], v15 offset:60032
    v_rcp_f32 v6, v6
    s_waitcnt lgkmcnt(8)
    v_mfma_f32_32x32x16_bf16 a[224:239], v[32:35], v[40:43], a[224:239]
    ds_read_b64_tr_b16 v[32:33], v14 offset:55552
    ds_read_b64_tr_b16 v[34:35], v14 offset:60160
    buffer_load_dwordx4 v2, s[24:27], s29 offen offset:1024 lds
    v_rcp_f32 v7, v7
    v_mfma_f32_32x32x16_bf16 a[240:255], v[36:39], v[40:43], a[240:255]
    ds_read_b64_tr_b16 v[36:37], v15 offset:55552
    ds_read_b64_tr_b16 v[38:39], v15 offset:60160
    v_rcp_f32 v8, v8
    s_waitcnt lgkmcnt(8)
    v_mfma_f32_32x32x16_bf16 v[80:95], v[16:19], v[44:47], v[80:95]
    ds_read_b64_tr_b16 v[16:17], v14 offset:55680
    ds_read_b64_tr_b16 v[18:19], v14 offset:60288
    v_rcp_f32 v9, v9
    v_mul_f32 v48, v48, v6
    v_mfma_f32_32x32x16_bf16 v[96:111], v[20:23], v[44:47], v[96:111]
    ds_read_b64_tr_b16 v[20:21], v15 offset:55680
    ds_read_b64_tr_b16 v[22:23], v15 offset:60288
    buffer_load_dwordx4 v11, s[24:27], s29 offen offset:2048 lds
    v_mul_f32 v49, v49, v7
    v_mul_f32 v50, v50, v8
    s_waitcnt lgkmcnt(8)
    v_mfma_f32_32x32x16_bf16 v[112:127], v[24:27], v[44:47], v[112:127]
    ds_read_b64_tr_b16 v[24:25], v14 offset:55808
    ds_read_b64_tr_b16 v[26:27], v14 offset:60416
    v_mul_f32 v51, v51, v9
    v_mul_f32 v6, v52, v52
    v_mfma_f32_32x32x16_bf16 v[128:143], v[28:31], v[44:47], v[128:143]
    ds_read_b64_tr_b16 v[28:29], v15 offset:55808
    ds_read_b64_tr_b16 v[30:31], v15 offset:60416
    v_mul_f32 v7, v53, v53
    v_mul_f32 v8, v54, v54
    v_mul_f32 v9, v55, v55
    s_waitcnt lgkmcnt(8)
    v_mfma_f32_32x32x16_bf16 v[144:159], v[32:35], v[44:47], v[144:159]
    ds_read_b64_tr_b16 v[32:33], v14 offset:55936
    ds_read_b64_tr_b16 v[34:35], v14 offset:60544
    buffer_load_dwordx4 v10, s[24:27], s29 offen offset:3072 lds
    v_fma_f32 v6, v6, v3, v4
    v_mfma_f32_32x32x16_bf16 v[160:175], v[36:39], v[44:47], v[160:175]
    ds_read_b64_tr_b16 v[36:37], v15 offset:55936
    ds_read_b64_tr_b16 v[38:39], v15 offset:60544
    v_fma_f32 v7, v7, v3, v4
    v_fma_f32 v8, v8, v3, v4
    v_fma_f32 v9, v9, v3, v4
    s_waitcnt lgkmcnt(8)
    v_mfma_f32_32x32x16_bf16 v[176:191], v[16:19], v[44:47], v[176:191]
    ds_read_b64_tr_b16 v[16:17], v14 offset:56064
    ds_read_b64_tr_b16 v[18:19], v14 offset:60672
    s_add_u32 m0, s18, 8192
    v_mul_f32 v6, v52, v6
    v_mfma_f32_32x32x16_bf16 v[192:207], v[20:23], v[44:47], v[192:207]
    ds_read_b64_tr_b16 v[20:21], v15 offset:56064
    ds_read_b64_tr_b16 v[22:23], v15 offset:60672
    buffer_load_dwordx4 v10, s[24:27], s31 offen offset:0 lds
    v_mul_f32 v7, v53, v7
    s_waitcnt lgkmcnt(8)
    v_mfma_f32_32x32x16_bf16 v[208:223], v[24:27], v[44:47], v[208:223]
    ds_read_b64_tr_b16 v[24:25], v14 offset:56192
    ds_read_b64_tr_b16 v[26:27], v14 offset:60800
    v_mul_f32 v8, v54, v8
    v_mul_f32 v9, v55, v9
    v_mfma_f32_32x32x16_bf16 v[224:239], v[28:31], v[44:47], v[224:239]
    ds_read_b64_tr_b16 v[28:29], v15 offset:56192
    ds_read_b64_tr_b16 v[30:31], v15 offset:60800
    s_add_u32 s28, s28, 36864
    s_add_u32 s29, s29, 36864
    s_add_u32 s31, s31, 36864
    s_waitcnt lgkmcnt(8)
    v_mfma_f32_32x32x16_bf16 v[240:255], v[32:35], v[44:47], v[240:255]
    ds_read_b64_tr_b16 v[32:33], v14 offset:56320
    ds_read_b64_tr_b16 v[34:35], v14 offset:60928
    v_exp_f32 v6, v6
    v_mfma_f32_32x32x16_bf16 a[144:159], v[36:39], v[44:47], a[144:159]
    ds_read_b64_tr_b16 v[36:37], v15 offset:56320
    ds_read_b64_tr_b16 v[38:39], v15 offset:60928
    v_exp_f32 v7, v7
    v_exp_f32 v8, v8
    s_waitcnt lgkmcnt(8)
    v_mfma_f32_32x32x16_bf16 a[160:175], v[16:19], v[44:47], a[160:175]
    s_waitcnt vmcnt(9)
    s_barrier
    ds_read_b128 v[16:19], v13 offset:0
    v_mfma_f32_32x32x16_bf16 a[176:191], v[20:23], v[44:47], a[176:191]
    ds_read_b128 v[20:23], v13 offset:1024
    v_exp_f32 v9, v9
    v_fma_f32 v6, v6, v5, v5
    v_fma_f32 v7, v7, v5, v5
    s_waitcnt lgkmcnt(6)
    v_mfma_f32_32x32x16_bf16 a[192:207], v[24:27], v[44:47], a[192:207]
    ds_read_b128 v[24:27], v13 offset:2048
    v_fma_f32 v8, v8, v5, v5
    v_fma_f32 v9, v9, v5, v5
    v_rcp_f32 v6, v6
    v_mfma_f32_32x32x16_bf16 a[208:223], v[28:31], v[44:47], a[208:223]
    ds_read_b128 v[28:31], v13 offset:3072
    v_rcp_f32 v7, v7
    v_rcp_f32 v8, v8
    s_waitcnt lgkmcnt(4)
    v_mfma_f32_32x32x16_bf16 a[224:239], v[32:35], v[44:47], a[224:239]
    ds_read_b128 v[32:35], v13 offset:4096
    v_rcp_f32 v9, v9
    v_mul_f32 v52, v52, v6
    v_mfma_f32_32x32x16_bf16 a[240:255], v[36:39], v[44:47], a[240:255]
    ds_read_b128 v[36:39], v13 offset:5120
    v_mul_f32 v53, v53, v7
    v_mul_f32 v54, v54, v8
    v_mul_f32 v55, v55, v9
    s_waitcnt lgkmcnt(4)
    v_mfma_f32_32x32x16_bf16 v[64:79], v[16:19], a[0:3], 0
    ds_read_b128 v[16:19], v13 offset:6144
    s_add_u32 m0, s18, 73728
    v_cvt_pk_bf16_f32 v40, v48, v49
    v_cvt_pk_bf16_f32 v41, v50, v51
    v_mfma_f32_32x32x16_bf16 v[64:79], v[20:23], a[4:7], v[64:79]
    ds_read_b128 v[20:23], v13 offset:7168
    buffer_load_dwordx4 v2, s[12:15], s19 offen offset:0 sc1 lds
    v_cvt_pk_bf16_f32 v42, v52, v53
    v_cvt_pk_bf16_f32 v43, v54, v55
    s_waitcnt lgkmcnt(4)
    v_mfma_f32_32x32x16_bf16 v[64:79], v[24:27], a[8:11], v[64:79]
    ds_read_b128 v[24:27], v13 offset:8192
    v_mul_f32 v6, v56, v56
    v_mul_f32 v7, v57, v57
    v_mul_f32 v8, v58, v58
    v_mfma_f32_32x32x16_bf16 v[64:79], v[28:31], a[12:15], v[64:79]
    ds_read_b128 v[28:31], v13 offset:9216
    v_mul_f32 v9, v59, v59
    v_fma_f32 v6, v6, v3, v4
    v_fma_f32 v7, v7, v3, v4
    s_waitcnt lgkmcnt(4)
    v_mfma_f32_32x32x16_bf16 v[64:79], v[32:35], a[16:19], v[64:79]
    ds_read_b128 v[32:35], v13 offset:10240
    buffer_load_dwordx4 v2, s[12:15], s19 offen offset:1024 sc1 lds
    v_fma_f32 v8, v8, v3, v4
    v_fma_f32 v9, v9, v3, v4
    v_mfma_f32_32x32x16_bf16 v[64:79], v[36:39], a[20:23], v[64:79]
    ds_read_b128 v[36:39], v13 offset:11264
    v_mul_f32 v6, v56, v6
    v_mul_f32 v7, v57, v7
    s_waitcnt lgkmcnt(4)
    v_mfma_f32_32x32x16_bf16 v[64:79], v[16:19], a[24:27], v[64:79]
    ds_read_b128 v[16:19], v13 offset:12288
    v_mul_f32 v8, v58, v8
    v_mul_f32 v9, v59, v9
    v_exp_f32 v6, v6
    v_mfma_f32_32x32x16_bf16 v[64:79], v[20:23], a[28:31], v[64:79]
    ds_read_b128 v[20:23], v13 offset:13312
    buffer_load_dwordx4 v2, s[12:15], s19 offen offset:2048 sc1 lds
    v_exp_f32 v7, v7
    s_waitcnt lgkmcnt(4)
    v_mfma_f32_32x32x16_bf16 v[64:79], v[24:27], a[32:35], v[64:79]
    ds_read_b128 v[24:27], v13 offset:14336
    v_exp_f32 v8, v8
    v_mfma_f32_32x32x16_bf16 v[64:79], v[28:31], a[36:39], v[64:79]
    ds_read_b128 v[28:31], v13 offset:15360
    v_exp_f32 v9, v9
    v_fma_f32 v6, v6, v5, v5
    s_waitcnt lgkmcnt(4)
    v_mfma_f32_32x32x16_bf16 v[64:79], v[32:35], a[40:43], v[64:79]
    ds_read_b128 v[32:35], v13 offset:16384
    buffer_load_dwordx4 v2, s[12:15], s19 offen offset:3072 sc1 lds
    v_fma_f32 v7, v7, v5, v5
    v_fma_f32 v8, v8, v5, v5
    v_mfma_f32_32x32x16_bf16 v[64:79], v[36:39], a[44:47], v[64:79]
    ds_read_b128 v[36:39], v13 offset:17408
    v_fma_f32 v9, v9, v5, v5
    v_rcp_f32 v6, v6
    s_waitcnt lgkmcnt(4)
    v_mfma_f32_32x32x16_bf16 v[64:79], v[16:19], a[48:51], v[64:79]
    ds_read_b128 v[16:19], v13 offset:18432
    s_add_u32 m0, s18, 77824
    v_rcp_f32 v7, v7
    v_mfma_f32_32x32x16_bf16 v[64:79], v[20:23], a[52:55], v[64:79]
    ds_read_b128 v[20:23], v13 offset:19456
    buffer_load_dwordx4 v2, s[12:15], s20 offen offset:0 sc1 lds
    v_rcp_f32 v8, v8
    s_waitcnt lgkmcnt(4)
    v_mfma_f32_32x32x16_bf16 v[64:79], v[24:27], a[56:59], v[64:79]
    ds_read_b128 v[24:27], v13 offset:20480
    v_rcp_f32 v9, v9
    v_mul_f32 v56, v56, v6
    v_mfma_f32_32x32x16_bf16 v[64:79], v[28:31], a[60:63], v[64:79]
    ds_read_b128 v[28:31], v13 offset:21504
    v_mul_f32 v57, v57, v7
    v_mul_f32 v58, v58, v8
    v_mul_f32 v59, v59, v9
    s_waitcnt lgkmcnt(4)
    v_mfma_f32_32x32x16_bf16 v[64:79], v[32:35], a[64:67], v[64:79]
    ds_read_b128 v[32:35], v13 offset:22528
    buffer_load_dwordx4 v2, s[12:15], s20 offen offset:1024 sc1 lds
    v_cvt_pk_bf16_f32 v44, v56, v57
    v_cvt_pk_bf16_f32 v45, v58, v59
    v_mfma_f32_32x32x16_bf16 v[64:79], v[36:39], a[68:71], v[64:79]
    ds_read_b128 v[36:39], v13 offset:23552
    v_mul_f32 v6, v60, v60
    v_mul_f32 v7, v61, v61
    s_waitcnt lgkmcnt(4)
    v_mfma_f32_32x32x16_bf16 v[64:79], v[16:19], a[72:75], v[64:79]
    ds_read_b128 v[16:19], v13 offset:24576
    v_mul_f32 v8, v62, v62
    v_mul_f32 v9, v63, v63
    v_fma_f32 v6, v6, v3, v4
    v_mfma_f32_32x32x16_bf16 v[64:79], v[20:23], a[76:79], v[64:79]
    ds_read_b128 v[20:23], v13 offset:25600
    buffer_load_dwordx4 v2, s[12:15], s20 offen offset:2048 sc1 lds
    v_fma_f32 v7, v7, v3, v4
    v_fma_f32 v8, v8, v3, v4
    s_waitcnt lgkmcnt(4)
    v_mfma_f32_32x32x16_bf16 v[64:79], v[24:27], a[80:83], v[64:79]
    ds_read_b128 v[24:27], v13 offset:26624
    v_fma_f32 v9, v9, v3, v4
    v_mul_f32 v6, v60, v6
    v_mul_f32 v7, v61, v7
    v_mfma_f32_32x32x16_bf16 v[64:79], v[28:31], a[84:87], v[64:79]
    ds_read_b128 v[28:31], v13 offset:27648
    v_mul_f32 v8, v62, v8
    v_mul_f32 v9, v63, v9
    v_exp_f32 v6, v6
    s_waitcnt lgkmcnt(4)
    v_mfma_f32_32x32x16_bf16 v[64:79], v[32:35], a[88:91], v[64:79]
    ds_read_b128 v[32:35], v13 offset:28672
    buffer_load_dwordx4 v2, s[12:15], s20 offen offset:3072 sc1 lds
    v_exp_f32 v7, v7
    v_mfma_f32_32x32x16_bf16 v[64:79], v[36:39], a[92:95], v[64:79]
    ds_read_b128 v[36:39], v13 offset:29696
    v_exp_f32 v8, v8
    s_waitcnt lgkmcnt(4)
    v_mfma_f32_32x32x16_bf16 v[64:79], v[16:19], a[96:99], v[64:79]
    ds_read_b128 v[16:19], v13 offset:30720
    s_add_u32 m0, s18, 81920
    v_exp_f32 v9, v9
    v_mfma_f32_32x32x16_bf16 v[64:79], v[20:23], a[100:103], v[64:79]
    ds_read_b128 v[20:23], v13 offset:31744
    buffer_load_dwordx4 v2, s[12:15], s21 offen offset:0 sc1 lds
    v_fma_f32 v6, v6, v5, v5
    v_fma_f32 v7, v7, v5, v5
    s_waitcnt lgkmcnt(4)
    v_mfma_f32_32x32x16_bf16 v[64:79], v[24:27], a[104:107], v[64:79]
    ds_read_b128 v[24:27], v13 offset:32768
    v_fma_f32 v8, v8, v5, v5
    v_fma_f32 v9, v9, v5, v5
    v_mfma_f32_32x32x16_bf16 v[64:79], v[28:31], a[108:111], v[64:79]
    ds_read_b128 v[28:31], v13 offset:33792
    s_add_u32 s19, s19, 36864
    s_add_u32 s20, s20, 36864
    s_add_u32 s21, s21, 36864
    s_waitcnt lgkmcnt(4)
    v_mfma_f32_32x32x16_bf16 v[64:79], v[32:35], a[112:115], v[64:79]
    ds_read_b128 v[32:35], v13 offset:34816
    v_rcp_f32 v6, v6
    v_rcp_f32 v7, v7
    v_mfma_f32_32x32x16_bf16 v[64:79], v[36:39], a[116:119], v[64:79]
    ds_read_b128 v[36:39], v13 offset:35840
    v_rcp_f32 v8, v8
    s_waitcnt lgkmcnt(4)
    v_mfma_f32_32x32x16_bf16 v[64:79], v[16:19], a[120:123], v[64:79]
    s_waitcnt vmcnt(9)
    s_barrier
    ds_read_b64_tr_b16 v[16:17], v14 offset:0
    ds_read_b64_tr_b16 v[18:19], v14 offset:4608
    v_mfma_f32_32x32x16_bf16 v[64:79], v[20:23], a[124:127], v[64:79]
    ds_read_b64_tr_b16 v[20:21], v15 offset:0
    ds_read_b64_tr_b16 v[22:23], v15 offset:4608
    v_rcp_f32 v9, v9
    s_waitcnt lgkmcnt(6)
    v_mfma_f32_32x32x16_bf16 v[64:79], v[24:27], a[128:131], v[64:79]
    ds_read_b64_tr_b16 v[24:25], v14 offset:128
    ds_read_b64_tr_b16 v[26:27], v14 offset:4736
    v_mul_f32 v60, v60, v6
    v_mul_f32 v61, v61, v7
    v_mfma_f32_32x32x16_bf16 v[64:79], v[28:31], a[132:135], v[64:79]
    ds_read_b64_tr_b16 v[28:29], v15 offset:128
    ds_read_b64_tr_b16 v[30:31], v15 offset:4736
    v_mul_f32 v62, v62, v8
    v_mul_f32 v63, v63, v9
    s_waitcnt lgkmcnt(8)
    v_mfma_f32_32x32x16_bf16 v[64:79], v[32:35], a[136:139], v[64:79]
    ds_read_b64_tr_b16 v[32:33], v14 offset:256
    ds_read_b64_tr_b16 v[34:35], v14 offset:4864
    v_cvt_pk_bf16_f32 v46, v60, v61
    v_cvt_pk_bf16_f32 v47, v62, v63
    v_mfma_f32_32x32x16_bf16 v[64:79], v[36:39], a[140:143], v[64:79]
    ds_read_b64_tr_b16 v[36:37], v15 offset:256
    ds_read_b64_tr_b16 v[38:39], v15 offset:4864
    s_waitcnt lgkmcnt(8)
    s_sub_u32 s22, s22, 1
    s_cmp_lg_u32 s22, 0
    s_cbranch_scc1 L3_mlp_loop
    s_lshr_b32 s61, s2, 3
    s_and_b32 s61, s61, 3
    s_mul_i32 s61, s61, 180
    s_mul_i32 s62, s8, 9
    s_add_u32 s61, s61, s62
    s_lshl_b32 s61, s61, 10
    s_add_u32 s61, s61, 17637376
    s_add_u32 s36, s61, 0
    s_add_u32 s37, s61, 4096
    s_add_u32 s38, s61, 8192
    s_add_u32 s39, s61, 36864
    s_add_u32 s40, s61, 40960
    s_add_u32 s41, s61, 45056
    s_add_u32 s42, s61, 73728
    s_add_u32 s43, s61, 77824
    s_add_u32 s44, s61, 81920
    s_add_u32 s45, s61, 110592
    s_add_u32 s46, s61, 114688
    s_add_u32 s47, s61, 118784
    s_add_u32 s48, s61, 147456
    s_add_u32 s49, s61, 151552
    s_add_u32 s50, s61, 155648
    s_lshl_b32 s10, s6, 6
    s_add_u32 s10, s10, s9
    s_mul_i32 s10, s10, 36864
    s_add_u32 s10, s10, 20733952
    s_add_u32 s51, s10, 0
    s_add_u32 s52, s10, 4096
    s_add_u32 s53, s10, 8192
    s_add_u32 s54, s10, 12288
    s_add_u32 s55, s10, 16384
    s_add_u32 s56, s10, 20480
    s_add_u32 s57, s10, 24576
    s_add_u32 s58, s10, 28672
    s_add_u32 s59, s10, 32768
    v_mfma_f32_32x32x16_bf16 v[80:95], v[16:19], v[40:43], v[80:95]
    ds_read_b64_tr_b16 v[16:17], v14 offset:384
    ds_read_b64_tr_b16 v[18:19], v14 offset:4992
    s_add_u32 m0, s18, 36864
    s_nop 0
    buffer_load_dwordx4 v2, s[24:27], s28 offen offset:0 lds
    v_mfma_f32_32x32x16_bf16 v[96:111], v[20:23], v[40:43], v[96:111]
    ds_read_b64_tr_b16 v[20:21], v15 offset:384
    ds_read_b64_tr_b16 v[22:23], v15 offset:4992
    buffer_load_dwordx4 v2, s[24:27], s28 offen offset:1024 lds
    s_waitcnt lgkmcnt(8)
    v_mfma_f32_32x32x16_bf16 v[112:127], v[24:27], v[40:43], v[112:127]
    ds_read_b64_tr_b16 v[24:25], v14 offset:512
    ds_read_b64_tr_b16 v[26:27], v14 offset:5120
    buffer_load_dwordx4 v0, s[24:27], s28 offen offset:2048 lds
    v_mfma_f32_32x32x16_bf16 v[128:143], v[28:31], v[40:43], v[128:143]
    ds_read_b64_tr_b16 v[28:29], v15 offset:512
    ds_read_b64_tr_b16 v[30:31], v15 offset:5120
    buffer_load_dwordx4 v10, s[24:27], s28 offen offset:3072 lds
    s_waitcnt lgkmcnt(8)
    v_mfma_f32_32x32x16_bf16 v[144:159], v[32:35], v[40:43], v[144:159]
    ds_read_b64_tr_b16 v[32:33], v14 offset:640
    ds_read_b64_tr_b16 v[34:35], v14 offset:5248
    s_add_u32 m0, s18, 40960
    s_nop 0
    buffer_load_dwordx4 v1, s[24:27], s29 offen offset:0 lds
    v_mfma_f32_32x32x16_bf16 v[160:175], v[36:39], v[40:43], v[160:175]
    ds_read_b64_tr_b16 v[36:37], v15 offset:640
    ds_read_b64_tr_b16 v[38:39], v15 offset:5248
    buffer_load_dwordx4 v2, s[24:27], s29 offen offset:1024 lds
    s_waitcnt lgkmcnt(8)
    v_mfma_f32_32x32x16_bf16 v[176:191], v[16:19], v[40:43], v[176:191]
    ds_read_b64_tr_b16 v[16:17], v14 offset:768
    ds_read_b64_tr_b16 v[18:19], v14 offset:5376
    buffer_load_dwordx4 v11, s[24:27], s29 offen offset:2048 lds
    v_mfma_f32_32x32x16_bf16 v[192:207], v[20:23], v[40:43], v[192:207]
    ds_read_b64_tr_b16 v[20:21], v15 offset:768
    ds_read_b64_tr_b16 v[22:23], v15 offset:5376
    buffer_load_dwordx4 v10, s[24:27], s29 offen offset:3072 lds
    s_waitcnt lgkmcnt(8)
    v_mfma_f32_32x32x16_bf16 v[208:223], v[24:27], v[40:43], v[208:223]
    ds_read_b64_tr_b16 v[24:25], v14 offset:896
    ds_read_b64_tr_b16 v[26:27], v14 offset:5504
    s_add_u32 m0, s18, 45056
    s_nop 0
    buffer_load_dwordx4 v10, s[24:27], s31 offen offset:0 lds
    v_mfma_f32_32x32x16_bf16 v[224:239], v[28:31], v[40:43], v[224:239]
    ds_read_b64_tr_b16 v[28:29], v15 offset:896
    ds_read_b64_tr_b16 v[30:31], v15 offset:5504
    v_mul_f32 v6, v64, v64
    v_mul_f32 v7, v65, v65
    v_mul_f32 v8, v66, v66
    v_mul_f32 v9, v67, v67
    v_fma_f32 v6, v6, v3, v4
    v_fma_f32 v7, v7, v3, v4
    s_waitcnt lgkmcnt(8)
    v_mfma_f32_32x32x16_bf16 v[240:255], v[32:35], v[40:43], v[240:255]
    ds_read_b64_tr_b16 v[32:33], v14 offset:1024
    ds_read_b64_tr_b16 v[34:35], v14 offset:5632
    v_fma_f32 v8, v8, v3, v4
    v_fma_f32 v9, v9, v3, v4
    v_mul_f32 v6, v64, v6
    v_mul_f32 v7, v65, v7
    v_mul_f32 v8, v66, v8
    v_mfma_f32_32x32x16_bf16 a[144:159], v[36:39], v[40:43], a[144:159]
    ds_read_b64_tr_b16 v[36:37], v15 offset:1024
    ds_read_b64_tr_b16 v[38:39], v15 offset:5632
    v_mul_f32 v9, v67, v9
    v_exp_f32 v6, v6
    v_exp_f32 v7, v7
    s_waitcnt lgkmcnt(8)
    v_mfma_f32_32x32x16_bf16 a[160:175], v[16:19], v[40:43], a[160:175]
    ds_read_b64_tr_b16 v[16:17], v14 offset:18432
    ds_read_b64_tr_b16 v[18:19], v14 offset:23040
    v_exp_f32 v8, v8
    v_exp_f32 v9, v9
    v_fma_f32 v6, v6, v5, v5
    v_fma_f32 v7, v7, v5, v5
    v_mfma_f32_32x32x16_bf16 a[176:191], v[20:23], v[40:43], a[176:191]
    ds_read_b64_tr_b16 v[20:21], v15 offset:18432
    ds_read_b64_tr_b16 v[22:23], v15 offset:23040
    v_fma_f32 v8, v8, v5, v5
    v_fma_f32 v9, v9, v5, v5
    v_rcp_f32 v6, v6
    v_rcp_f32 v7, v7
    s_waitcnt lgkmcnt(8)
    v_mfma_f32_32x32x16_bf16 a[192:207], v[24:27], v[40:43], a[192:207]
    ds_read_b64_tr_b16 v[24:25], v14 offset:18560
    ds_read_b64_tr_b16 v[26:27], v14 offset:23168
    v_rcp_f32 v8, v8
    v_rcp_f32 v9, v9
    v_mul_f32 v64, v64, v6
    v_mfma_f32_32x32x16_bf16 a[208:223], v[28:31], v[40:43], a[208:223]
    ds_read_b64_tr_b16 v[28:29], v15 offset:18560
    ds_read_b64_tr_b16 v[30:31], v15 offset:23168
    v_mul_f32 v65, v65, v7
    v_mul_f32 v66, v66, v8
    v_mul_f32 v67, v67, v9
    v_mul_f32 v6, v68, v68
    v_mul_f32 v7, v69, v69
    v_mul_f32 v8, v70, v70
    s_waitcnt lgkmcnt(8)
    v_mfma_f32_32x32x16_bf16 a[224:239], v[32:35], v[40:43], a[224:239]
    ds_read_b64_tr_b16 v[32:33], v14 offset:18688
    ds_read_b64_tr_b16 v[34:35], v14 offset:23296
    v_mul_f32 v9, v71, v71
    v_fma_f32 v6, v6, v3, v4
    v_fma_f32 v7, v7, v3, v4
    v_fma_f32 v8, v8, v3, v4
    v_fma_f32 v9, v9, v3, v4
    v_mfma_f32_32x32x16_bf16 a[240:255], v[36:39], v[40:43], a[240:255]
    ds_read_b64_tr_b16 v[36:37], v15 offset:18688
    ds_read_b64_tr_b16 v[38:39], v15 offset:23296
    v_mul_f32 v6, v68, v6
    v_mul_f32 v7, v69, v7
    v_mul_f32 v8, v70, v8
    v_mul_f32 v9, v71, v9
    v_exp_f32 v6, v6
    s_waitcnt lgkmcnt(8)
    v_mfma_f32_32x32x16_bf16 v[80:95], v[16:19], v[44:47], v[80:95]
    ds_read_b64_tr_b16 v[16:17], v14 offset:18816
    ds_read_b64_tr_b16 v[18:19], v14 offset:23424
    v_exp_f32 v7, v7
    v_exp_f32 v8, v8
    v_exp_f32 v9, v9
    v_mfma_f32_32x32x16_bf16 v[96:111], v[20:23], v[44:47], v[96:111]
    ds_read_b64_tr_b16 v[20:21], v15 offset:18816
    ds_read_b64_tr_b16 v[22:23], v15 offset:23424
    v_fma_f32 v6, v6, v5, v5
    v_fma_f32 v7, v7, v5, v5
    v_fma_f32 v8, v8, v5, v5
    v_fma_f32 v9, v9, v5, v5
    s_waitcnt lgkmcnt(8)
    v_mfma_f32_32x32x16_bf16 v[112:127], v[24:27], v[44:47], v[112:127]
    ds_read_b64_tr_b16 v[24:25], v14 offset:18944
    ds_read_b64_tr_b16 v[26:27], v14 offset:23552
    v_rcp_f32 v6, v6
    v_rcp_f32 v7, v7
    v_rcp_f32 v8, v8
    v_mfma_f32_32x32x16_bf16 v[128:143], v[28:31], v[44:47], v[128:143]
    ds_read_b64_tr_b16 v[28:29], v15 offset:18944
    ds_read_b64_tr_b16 v[30:31], v15 offset:23552
    v_rcp_f32 v9, v9
    v_mul_f32 v68, v68, v6
    v_mul_f32 v69, v69, v7
    v_mul_f32 v70, v70, v8
    v_mul_f32 v71, v71, v9
    s_waitcnt lgkmcnt(8)
    v_mfma_f32_32x32x16_bf16 v[144:159], v[32:35], v[44:47], v[144:159]
    ds_read_b64_tr_b16 v[32:33], v14 offset:19072
    ds_read_b64_tr_b16 v[34:35], v14 offset:23680
    v_mul_f32 v6, v72, v72
    v_mul_f32 v7, v73, v73
    v_mul_f32 v8, v74, v74
    v_mul_f32 v9, v75, v75
    v_fma_f32 v6, v6, v3, v4
    v_mfma_f32_32x32x16_bf16 v[160:175], v[36:39], v[44:47], v[160:175]
    ds_read_b64_tr_b16 v[36:37], v15 offset:19072
    ds_read_b64_tr_b16 v[38:39], v15 offset:23680
    v_fma_f32 v7, v7, v3, v4
    v_fma_f32 v8, v8, v3, v4
    v_fma_f32 v9, v9, v3, v4
    v_mul_f32 v6, v72, v6
    v_mul_f32 v7, v73, v7
    v_mul_f32 v8, v74, v8
    s_waitcnt lgkmcnt(8)
    v_mfma_f32_32x32x16_bf16 v[176:191], v[16:19], v[44:47], v[176:191]
    ds_read_b64_tr_b16 v[16:17], v14 offset:19200
    ds_read_b64_tr_b16 v[18:19], v14 offset:23808
    v_mul_f32 v9, v75, v9
    v_exp_f32 v6, v6
    v_exp_f32 v7, v7
    v_mfma_f32_32x32x16_bf16 v[192:207], v[20:23], v[44:47], v[192:207]
    ds_read_b64_tr_b16 v[20:21], v15 offset:19200
    ds_read_b64_tr_b16 v[22:23], v15 offset:23808
    v_exp_f32 v8, v8
    v_exp_f32 v9, v9
    v_fma_f32 v6, v6, v5, v5
    v_fma_f32 v7, v7, v5, v5
    s_waitcnt lgkmcnt(8)
    v_mfma_f32_32x32x16_bf16 v[208:223], v[24:27], v[44:47], v[208:223]
    ds_read_b64_tr_b16 v[24:25], v14 offset:19328
    ds_read_b64_tr_b16 v[26:27], v14 offset:23936
    v_fma_f32 v8, v8, v5, v5
    v_fma_f32 v9, v9, v5, v5
    v_rcp_f32 v6, v6
    v_rcp_f32 v7, v7
    v_mfma_f32_32x32x16_bf16 v[224:239], v[28:31], v[44:47], v[224:239]
    ds_read_b64_tr_b16 v[28:29], v15 offset:19328
    ds_read_b64_tr_b16 v[30:31], v15 offset:23936
    s_add_u32 s28, s28, 36864
    s_add_u32 s29, s29, 36864
    s_add_u32 s31, s31, 36864
    v_rcp_f32 v8, v8
    s_waitcnt lgkmcnt(8)
    v_mfma_f32_32x32x16_bf16 v[240:255], v[32:35], v[44:47], v[240:255]
    ds_read_b64_tr_b16 v[32:33], v14 offset:19456
    ds_read_b64_tr_b16 v[34:35], v14 offset:24064
    v_rcp_f32 v9, v9
    v_mul_f32 v72, v72, v6
    v_mul_f32 v73, v73, v7
    v_mul_f32 v74, v74, v8
    v_mfma_f32_32x32x16_bf16 a[144:159], v[36:39], v[44:47], a[144:159]
    ds_read_b64_tr_b16 v[36:37], v15 offset:19456
    ds_read_b64_tr_b16 v[38:39], v15 offset:24064
    v_mul_f32 v75, v75, v9
    v_mul_f32 v6, v76, v76
    v_mul_f32 v7, v77, v77
    v_mul_f32 v8, v78, v78
    v_mul_f32 v9, v79, v79
    v_fma_f32 v6, v6, v3, v4
    s_waitcnt lgkmcnt(8)
    v_mfma_f32_32x32x16_bf16 a[160:175], v[16:19], v[44:47], a[160:175]
    s_waitcnt vmcnt(0)
    s_barrier
    ds_read_b64_tr_b16 v[16:17], v14 offset:36864
    ds_read_b64_tr_b16 v[18:19], v14 offset:41472
    v_fma_f32 v7, v7, v3, v4
    v_fma_f32 v8, v8, v3, v4
    v_fma_f32 v9, v9, v3, v4
    v_mfma_f32_32x32x16_bf16 a[176:191], v[20:23], v[44:47], a[176:191]
    ds_read_b64_tr_b16 v[20:21], v15 offset:36864
    ds_read_b64_tr_b16 v[22:23], v15 offset:41472
    v_mul_f32 v6, v76, v6
    v_mul_f32 v7, v77, v7
    v_mul_f32 v8, v78, v8
    v_mul_f32 v9, v79, v9
    v_exp_f32 v6, v6
    s_waitcnt lgkmcnt(8)
    v_mfma_f32_32x32x16_bf16 a[192:207], v[24:27], v[44:47], a[192:207]
    ds_read_b64_tr_b16 v[24:25], v14 offset:36992
    ds_read_b64_tr_b16 v[26:27], v14 offset:41600
    v_exp_f32 v7, v7
    v_exp_f32 v8, v8
    v_exp_f32 v9, v9
    v_mfma_f32_32x32x16_bf16 a[208:223], v[28:31], v[44:47], a[208:223]
    ds_read_b64_tr_b16 v[28:29], v15 offset:36992
    ds_read_b64_tr_b16 v[30:31], v15 offset:41600
    v_fma_f32 v6, v6, v5, v5
    v_fma_f32 v7, v7, v5, v5
    v_fma_f32 v8, v8, v5, v5
    v_fma_f32 v9, v9, v5, v5
    s_waitcnt lgkmcnt(8)
    v_mfma_f32_32x32x16_bf16 a[224:239], v[32:35], v[44:47], a[224:239]
    ds_read_b64_tr_b16 v[32:33], v14 offset:37120
    ds_read_b64_tr_b16 v[34:35], v14 offset:41728
    v_rcp_f32 v6, v6
    v_rcp_f32 v7, v7
    v_rcp_f32 v8, v8
    v_mfma_f32_32x32x16_bf16 a[240:255], v[36:39], v[44:47], a[240:255]
    ds_read_b64_tr_b16 v[36:37], v15 offset:37120
    ds_read_b64_tr_b16 v[38:39], v15 offset:41728
    v_rcp_f32 v9, v9
    v_mul_f32 v76, v76, v6
    v_mul_f32 v77, v77, v7
    v_mul_f32 v78, v78, v8
    v_mul_f32 v79, v79, v9
    s_waitcnt lgkmcnt(8)
    v_cvt_pk_bf16_f32 v40, v64, v65
    v_cvt_pk_bf16_f32 v41, v66, v67
    v_cvt_pk_bf16_f32 v42, v68, v69
    v_cvt_pk_bf16_f32 v43, v70, v71
    v_cvt_pk_bf16_f32 v44, v72, v73
    v_cvt_pk_bf16_f32 v45, v74, v75
    v_cvt_pk_bf16_f32 v46, v76, v77
    v_cvt_pk_bf16_f32 v47, v78, v79
    v_subrev_u32 v6, s18, v2
    s_nop 0
    v_mfma_f32_32x32x16_bf16 v[80:95], v[16:19], v[40:43], v[80:95]
    ds_read_b64_tr_b16 v[16:17], v14 offset:37248
    ds_read_b64_tr_b16 v[18:19], v14 offset:41856
    buffer_load_dwordx4 a[0:3], v6, s[12:15], s36 offen offset:0 sc1
    v_mfma_f32_32x32x16_bf16 v[96:111], v[20:23], v[40:43], v[96:111]
    ds_read_b64_tr_b16 v[20:21], v15 offset:37248
    ds_read_b64_tr_b16 v[22:23], v15 offset:41856
    s_waitcnt lgkmcnt(8)
    v_mfma_f32_32x32x16_bf16 v[112:127], v[24:27], v[40:43], v[112:127]
    ds_read_b64_tr_b16 v[24:25], v14 offset:37376
    ds_read_b64_tr_b16 v[26:27], v14 offset:41984
    buffer_load_dwordx4 a[36:39], v6, s[12:15], s39 offen offset:0 sc1
    v_mfma_f32_32x32x16_bf16 v[128:143], v[28:31], v[40:43], v[128:143]
    ds_read_b64_tr_b16 v[28:29], v15 offset:37376
    ds_read_b64_tr_b16 v[30:31], v15 offset:41984
    buffer_load_dwordx4 a[72:75], v6, s[12:15], s42 offen offset:0 sc1
    s_waitcnt lgkmcnt(8)
    v_mfma_f32_32x32x16_bf16 v[144:159], v[32:35], v[40:43], v[144:159]
    ds_read_b64_tr_b16 v[32:33], v14 offset:37504
    ds_read_b64_tr_b16 v[34:35], v14 offset:42112
    v_mfma_f32_32x32x16_bf16 v[160:175], v[36:39], v[40:43], v[160:175]
    ds_read_b64_tr_b16 v[36:37], v15 offset:37504
    ds_read_b64_tr_b16 v[38:39], v15 offset:42112
    buffer_load_dwordx4 a[108:111], v6, s[12:15], s45 offen offset:0 sc1
    s_waitcnt lgkmcnt(8)
    v_mfma_f32_32x32x16_bf16 v[176:191], v[16:19], v[40:43], v[176:191]
    ds_read_b64_tr_b16 v[16:17], v14 offset:37632
    ds_read_b64_tr_b16 v[18:19], v14 offset:42240
    buffer_load_dwordx4 a[4:7], v6, s[12:15], s36 offen offset:1024 sc1
    v_mfma_f32_32x32x16_bf16 v[192:207], v[20:23], v[40:43], v[192:207]
    ds_read_b64_tr_b16 v[20:21], v15 offset:37632
    ds_read_b64_tr_b16 v[22:23], v15 offset:42240
    s_waitcnt lgkmcnt(8)
    v_mfma_f32_32x32x16_bf16 v[208:223], v[24:27], v[40:43], v[208:223]
    ds_read_b64_tr_b16 v[24:25], v14 offset:37760
    ds_read_b64_tr_b16 v[26:27], v14 offset:42368
    buffer_load_dwordx4 a[40:43], v6, s[12:15], s39 offen offset:1024 sc1
    v_mfma_f32_32x32x16_bf16 v[224:239], v[28:31], v[40:43], v[224:239]
    ds_read_b64_tr_b16 v[28:29], v15 offset:37760
    ds_read_b64_tr_b16 v[30:31], v15 offset:42368
    buffer_load_dwordx4 a[76:79], v6, s[12:15], s42 offen offset:1024 sc1
    s_waitcnt lgkmcnt(8)
    v_mfma_f32_32x32x16_bf16 v[240:255], v[32:35], v[40:43], v[240:255]
    ds_read_b64_tr_b16 v[32:33], v14 offset:37888
    ds_read_b64_tr_b16 v[34:35], v14 offset:42496
    v_mfma_f32_32x32x16_bf16 a[144:159], v[36:39], v[40:43], a[144:159]
    ds_read_b64_tr_b16 v[36:37], v15 offset:37888
    ds_read_b64_tr_b16 v[38:39], v15 offset:42496
    buffer_load_dwordx4 a[112:115], v6, s[12:15], s45 offen offset:1024 sc1
    s_waitcnt lgkmcnt(8)
    v_mfma_f32_32x32x16_bf16 a[160:175], v[16:19], v[40:43], a[160:175]
    ds_read_b64_tr_b16 v[16:17], v14 offset:55296
    ds_read_b64_tr_b16 v[18:19], v14 offset:59904
    buffer_load_dwordx4 a[8:11], v6, s[12:15], s36 offen offset:2048 sc1
    v_mfma_f32_32x32x16_bf16 a[176:191], v[20:23], v[40:43], a[176:191]
    ds_read_b64_tr_b16 v[20:21], v15 offset:55296
    ds_read_b64_tr_b16 v[22:23], v15 offset:59904
    s_waitcnt lgkmcnt(8)
    v_mfma_f32_32x32x16_bf16 a[192:207], v[24:27], v[40:43], a[192:207]
    ds_read_b64_tr_b16 v[24:25], v14 offset:55424
    ds_read_b64_tr_b16 v[26:27], v14 offset:60032
    buffer_load_dwordx4 a[44:47], v6, s[12:15], s39 offen offset:2048 sc1
    v_mfma_f32_32x32x16_bf16 a[208:223], v[28:31], v[40:43], a[208:223]
    ds_read_b64_tr_b16 v[28:29], v15 offset:55424
    ds_read_b64_tr_b16 v[30:31], v15 offset:60032
    buffer_load_dwordx4 a[80:83], v6, s[12:15], s42 offen offset:2048 sc1
    s_waitcnt lgkmcnt(8)
    v_mfma_f32_32x32x16_bf16 a[224:239], v[32:35], v[40:43], a[224:239]
    ds_read_b64_tr_b16 v[32:33], v14 offset:55552
    ds_read_b64_tr_b16 v[34:35], v14 offset:60160
    v_mfma_f32_32x32x16_bf16 a[240:255], v[36:39], v[40:43], a[240:255]
    ds_read_b64_tr_b16 v[36:37], v15 offset:55552
    ds_read_b64_tr_b16 v[38:39], v15 offset:60160
    buffer_load_dwordx4 a[116:119], v6, s[12:15], s45 offen offset:2048 sc1
    s_waitcnt lgkmcnt(8)
    v_mfma_f32_32x32x16_bf16 v[80:95], v[16:19], v[44:47], v[80:95]
    ds_read_b64_tr_b16 v[16:17], v14 offset:55680
    ds_read_b64_tr_b16 v[18:19], v14 offset:60288
    buffer_load_dwordx4 a[12:15], v6, s[12:15], s36 offen offset:3072 sc1
    v_mfma_f32_32x32x16_bf16 v[96:111], v[20:23], v[44:47], v[96:111]
    ds_read_b64_tr_b16 v[20:21], v15 offset:55680
    ds_read_b64_tr_b16 v[22:23], v15 offset:60288
    s_waitcnt lgkmcnt(8)
    v_mfma_f32_32x32x16_bf16 v[112:127], v[24:27], v[44:47], v[112:127]
    ds_read_b64_tr_b16 v[24:25], v14 offset:55808
    ds_read_b64_tr_b16 v[26:27], v14 offset:60416
    buffer_load_dwordx4 a[48:51], v6, s[12:15], s39 offen offset:3072 sc1
    v_mfma_f32_32x32x16_bf16 v[128:143], v[28:31], v[44:47], v[128:143]
    ds_read_b64_tr_b16 v[28:29], v15 offset:55808
    ds_read_b64_tr_b16 v[30:31], v15 offset:60416
    buffer_load_dwordx4 a[84:87], v6, s[12:15], s42 offen offset:3072 sc1
    s_waitcnt lgkmcnt(8)
    v_mfma_f32_32x32x16_bf16 v[144:159], v[32:35], v[44:47], v[144:159]
    ds_read_b64_tr_b16 v[32:33], v14 offset:55936
    ds_read_b64_tr_b16 v[34:35], v14 offset:60544
    v_mfma_f32_32x32x16_bf16 v[160:175], v[36:39], v[44:47], v[160:175]
    ds_read_b64_tr_b16 v[36:37], v15 offset:55936
    ds_read_b64_tr_b16 v[38:39], v15 offset:60544
    buffer_load_dwordx4 a[120:123], v6, s[12:15], s45 offen offset:3072 sc1
    s_waitcnt lgkmcnt(8)
    v_mfma_f32_32x32x16_bf16 v[176:191], v[16:19], v[44:47], v[176:191]
    ds_read_b64_tr_b16 v[16:17], v14 offset:56064
    ds_read_b64_tr_b16 v[18:19], v14 offset:60672
    buffer_load_dwordx4 a[16:19], v6, s[12:15], s37 offen offset:0 sc1
    v_mfma_f32_32x32x16_bf16 v[192:207], v[20:23], v[44:47], v[192:207]
    ds_read_b64_tr_b16 v[20:21], v15 offset:56064
    ds_read_b64_tr_b16 v[22:23], v15 offset:60672
    s_waitcnt lgkmcnt(8)
    v_mfma_f32_32x32x16_bf16 v[208:223], v[24:27], v[44:47], v[208:223]
    ds_read_b64_tr_b16 v[24:25], v14 offset:56192
    ds_read_b64_tr_b16 v[26:27], v14 offset:60800
    buffer_load_dwordx4 a[52:55], v6, s[12:15], s40 offen offset:0 sc1
    v_mfma_f32_32x32x16_bf16 v[224:239], v[28:31], v[44:47], v[224:239]
    ds_read_b64_tr_b16 v[28:29], v15 offset:56192
    ds_read_b64_tr_b16 v[30:31], v15 offset:60800
    buffer_load_dwordx4 a[88:91], v6, s[12:15], s43 offen offset:0 sc1
    s_waitcnt lgkmcnt(8)
    v_mfma_f32_32x32x16_bf16 v[240:255], v[32:35], v[44:47], v[240:255]
    ds_read_b64_tr_b16 v[32:33], v14 offset:56320
    ds_read_b64_tr_b16 v[34:35], v14 offset:60928
    v_mfma_f32_32x32x16_bf16 a[144:159], v[36:39], v[44:47], a[144:159]
    ds_read_b64_tr_b16 v[36:37], v15 offset:56320
    ds_read_b64_tr_b16 v[38:39], v15 offset:60928
    buffer_load_dwordx4 a[124:127], v6, s[12:15], s46 offen offset:0 sc1
    s_waitcnt lgkmcnt(8)
    v_mfma_f32_32x32x16_bf16 a[160:175], v[16:19], v[44:47], a[160:175]
    buffer_load_dwordx4 a[20:23], v6, s[12:15], s37 offen offset:1024 sc1
    buffer_load_dwordx4 a[56:59], v6, s[12:15], s40 offen offset:1024 sc1
    buffer_load_dwordx4 a[92:95], v6, s[12:15], s43 offen offset:1024 sc1
    v_mfma_f32_32x32x16_bf16 a[176:191], v[20:23], v[44:47], a[176:191]
    buffer_load_dwordx4 a[128:131], v6, s[12:15], s46 offen offset:1024 sc1
    buffer_load_dwordx4 a[24:27], v6, s[12:15], s37 offen offset:2048 sc1
    s_waitcnt lgkmcnt(4)
    v_mfma_f32_32x32x16_bf16 a[192:207], v[24:27], v[44:47], a[192:207]
    buffer_load_dwordx4 a[60:63], v6, s[12:15], s40 offen offset:2048 sc1
    buffer_load_dwordx4 a[96:99], v6, s[12:15], s43 offen offset:2048 sc1
    buffer_load_dwordx4 a[132:135], v6, s[12:15], s46 offen offset:2048 sc1
    v_mfma_f32_32x32x16_bf16 a[208:223], v[28:31], v[44:47], a[208:223]
    buffer_load_dwordx4 a[28:31], v6, s[12:15], s37 offen offset:3072 sc1
    buffer_load_dwordx4 a[64:67], v6, s[12:15], s40 offen offset:3072 sc1
    buffer_load_dwordx4 a[100:103], v6, s[12:15], s43 offen offset:3072 sc1
    s_waitcnt lgkmcnt(0)
    v_mfma_f32_32x32x16_bf16 a[224:239], v[32:35], v[44:47], a[224:239]
    buffer_load_dwordx4 a[136:139], v6, s[12:15], s46 offen offset:3072 sc1
    buffer_load_dwordx4 a[32:35], v6, s[12:15], s38 offen offset:0 sc1
    v_mfma_f32_32x32x16_bf16 a[240:255], v[36:39], v[44:47], a[240:255]
    buffer_load_dwordx4 a[68:71], v6, s[12:15], s41 offen offset:0 sc1
    buffer_load_dwordx4 a[104:107], v6, s[12:15], s44 offen offset:0 sc1
    buffer_load_dwordx4 a[140:143], v6, s[12:15], s47 offen offset:0 sc1
    s_nop 9
    v_accvgpr_read_b32 v0, a144
    v_accvgpr_read_b32 v1, a145
    v_accvgpr_read_b32 v3, a146
    v_accvgpr_read_b32 v4, a147
    v_accvgpr_read_b32 v5, a148
    v_accvgpr_read_b32 v10, a149
    v_accvgpr_read_b32 v11, a150
    v_accvgpr_read_b32 v9, a151
    v_cvt_pk_bf16_f32 v48, v0, v1
    v_cvt_pk_bf16_f32 v49, v3, v4
    v_cvt_pk_bf16_f32 v50, v5, v10
    v_cvt_pk_bf16_f32 v51, v11, v9
    v_accvgpr_read_b32 v0, a152
    v_accvgpr_read_b32 v1, a153
    v_accvgpr_read_b32 v3, a154
    v_accvgpr_read_b32 v4, a155
    v_accvgpr_read_b32 v5, a156
    v_accvgpr_read_b32 v10, a157
    v_accvgpr_read_b32 v11, a158
    v_accvgpr_read_b32 v9, a159
    v_cvt_pk_bf16_f32 v52, v0, v1
    v_cvt_pk_bf16_f32 v53, v3, v4
    v_cvt_pk_bf16_f32 v54, v5, v10
    v_cvt_pk_bf16_f32 v55, v11, v9
    buffer_store_dwordx4 v[48:51], v6, s[12:15], s56 offen offset:2048 sc1
    buffer_store_dwordx4 v[52:55], v6, s[12:15], s56 offen offset:3072 sc1
    v_accvgpr_read_b32 v0, a160
    v_accvgpr_read_b32 v1, a161
    v_accvgpr_read_b32 v3, a162
    v_accvgpr_read_b32 v4, a163
    v_accvgpr_read_b32 v5, a164
    v_accvgpr_read_b32 v10, a165
    v_accvgpr_read_b32 v11, a166
    v_accvgpr_read_b32 v9, a167
    v_cvt_pk_bf16_f32 v56, v0, v1
    v_cvt_pk_bf16_f32 v57, v3, v4
    v_cvt_pk_bf16_f32 v58, v5, v10
    v_cvt_pk_bf16_f32 v59, v11, v9
    v_accvgpr_read_b32 v0, a168
    v_accvgpr_read_b32 v1, a169
    v_accvgpr_read_b32 v3, a170
    v_accvgpr_read_b32 v4, a171
    v_accvgpr_read_b32 v5, a172
    v_accvgpr_read_b32 v10, a173
    v_accvgpr_read_b32 v11, a174
    v_accvgpr_read_b32 v9, a175
    v_cvt_pk_bf16_f32 v60, v0, v1
    v_cvt_pk_bf16_f32 v61, v3, v4
    v_cvt_pk_bf16_f32 v62, v5, v10
    v_cvt_pk_bf16_f32 v63, v11, v9
    buffer_store_dwordx4 v[56:59], v6, s[12:15], s57 offen offset:0 sc1
    buffer_store_dwordx4 v[60:63], v6, s[12:15], s57 offen offset:1024 sc1
    v_accvgpr_read_b32 v0, a176
    v_accvgpr_read_b32 v1, a177
    v_accvgpr_read_b32 v3, a178
    v_accvgpr_read_b32 v4, a179
    v_accvgpr_read_b32 v5, a180
    v_accvgpr_read_b32 v10, a181
    v_accvgpr_read_b32 v11, a182
    v_accvgpr_read_b32 v9, a183
    v_cvt_pk_bf16_f32 v64, v0, v1
    v_cvt_pk_bf16_f32 v65, v3, v4
    v_cvt_pk_bf16_f32 v66, v5, v10
    v_cvt_pk_bf16_f32 v67, v11, v9
    v_accvgpr_read_b32 v0, a184
    v_accvgpr_read_b32 v1, a185
    v_accvgpr_read_b32 v3, a186
    v_accvgpr_read_b32 v4, a187
    v_accvgpr_read_b32 v5, a188
    v_accvgpr_read_b32 v10, a189
    v_accvgpr_read_b32 v11, a190
    v_accvgpr_read_b32 v9, a191
    v_cvt_pk_bf16_f32 v68, v0, v1
    v_cvt_pk_bf16_f32 v69, v3, v4
    v_cvt_pk_bf16_f32 v70, v5, v10
    v_cvt_pk_bf16_f32 v71, v11, v9
    buffer_store_dwordx4 v[64:67], v6, s[12:15], s57 offen offset:2048 sc1
    buffer_store_dwordx4 v[68:71], v6, s[12:15], s57 offen offset:3072 sc1
    buffer_load_dwordx4 a[144:147], v6, s[12:15], s48 offen offset:0 sc1
    buffer_load_dwordx4 a[148:151], v6, s[12:15], s48 offen offset:1024 sc1
    buffer_load_dwordx4 a[152:155], v6, s[12:15], s48 offen offset:2048 sc1
    buffer_load_dwordx4 a[156:159], v6, s[12:15], s48 offen offset:3072 sc1
    buffer_load_dwordx4 a[160:163], v6, s[12:15], s49 offen offset:0 sc1
    buffer_load_dwordx4 a[164:167], v6, s[12:15], s49 offen offset:1024 sc1
    buffer_load_dwordx4 a[168:171], v6, s[12:15], s49 offen offset:2048 sc1
    buffer_load_dwordx4 a[172:175], v6, s[12:15], s49 offen offset:3072 sc1
    buffer_load_dwordx4 a[176:179], v6, s[12:15], s50 offen offset:0 sc1
    v_accvgpr_read_b32 v0, a192
    v_accvgpr_read_b32 v1, a193
    v_accvgpr_read_b32 v3, a194
    v_accvgpr_read_b32 v4, a195
    v_accvgpr_read_b32 v5, a196
    v_accvgpr_read_b32 v10, a197
    v_accvgpr_read_b32 v11, a198
    v_accvgpr_read_b32 v9, a199
    v_cvt_pk_bf16_f32 v72, v0, v1
    v_cvt_pk_bf16_f32 v73, v3, v4
    v_cvt_pk_bf16_f32 v74, v5, v10
    v_cvt_pk_bf16_f32 v75, v11, v9
    v_accvgpr_read_b32 v0, a200
    v_accvgpr_read_b32 v1, a201
    v_accvgpr_read_b32 v3, a202
    v_accvgpr_read_b32 v4, a203
    v_accvgpr_read_b32 v5, a204
    v_accvgpr_read_b32 v10, a205
    v_accvgpr_read_b32 v11, a206
    v_accvgpr_read_b32 v9, a207
    v_cvt_pk_bf16_f32 v76, v0, v1
    v_cvt_pk_bf16_f32 v77, v3, v4
    v_cvt_pk_bf16_f32 v78, v5, v10
    v_cvt_pk_bf16_f32 v79, v11, v9
    buffer_store_dwordx4 v[72:75], v6, s[12:15], s58 offen offset:0 sc1
    buffer_store_dwordx4 v[76:79], v6, s[12:15], s58 offen offset:1024 sc1
    v_accvgpr_read_b32 v0, a208
    v_accvgpr_read_b32 v1, a209
    v_accvgpr_read_b32 v3, a210
    v_accvgpr_read_b32 v4, a211
    v_accvgpr_read_b32 v5, a212
    v_accvgpr_read_b32 v10, a213
    v_accvgpr_read_b32 v11, a214
    v_accvgpr_read_b32 v9, a215
    v_cvt_pk_bf16_f32 v48, v0, v1
    v_cvt_pk_bf16_f32 v49, v3, v4
    v_cvt_pk_bf16_f32 v50, v5, v10
    v_cvt_pk_bf16_f32 v51, v11, v9
    v_accvgpr_read_b32 v0, a216
    v_accvgpr_read_b32 v1, a217
    v_accvgpr_read_b32 v3, a218
    v_accvgpr_read_b32 v4, a219
    v_accvgpr_read_b32 v5, a220
    v_accvgpr_read_b32 v10, a221
    v_accvgpr_read_b32 v11, a222
    v_accvgpr_read_b32 v9, a223
    v_cvt_pk_bf16_f32 v52, v0, v1
    v_cvt_pk_bf16_f32 v53, v3, v4
    v_cvt_pk_bf16_f32 v54, v5, v10
    v_cvt_pk_bf16_f32 v55, v11, v9
    buffer_store_dwordx4 v[48:51], v6, s[12:15], s58 offen offset:2048 sc1
    buffer_store_dwordx4 v[52:55], v6, s[12:15], s58 offen offset:3072 sc1
    v_accvgpr_read_b32 v0, a224
    v_accvgpr_read_b32 v1, a225
    v_accvgpr_read_b32 v3, a226
    v_accvgpr_read_b32 v4, a227
    v_accvgpr_read_b32 v5, a228
    v_accvgpr_read_b32 v10, a229
    v_accvgpr_read_b32 v11, a230
    v_accvgpr_read_b32 v9, a231
    v_cvt_pk_bf16_f32 v56, v0, v1
    v_cvt_pk_bf16_f32 v57, v3, v4
    v_cvt_pk_bf16_f32 v58, v5, v10
    v_cvt_pk_bf16_f32 v59, v11, v9
    v_accvgpr_read_b32 v0, a232
    v_accvgpr_read_b32 v1, a233
    v_accvgpr_read_b32 v3, a234
    v_accvgpr_read_b32 v4, a235
    v_accvgpr_read_b32 v5, a236
    v_accvgpr_read_b32 v10, a237
    v_accvgpr_read_b32 v11, a238
    v_accvgpr_read_b32 v9, a239
    v_cvt_pk_bf16_f32 v60, v0, v1
    v_cvt_pk_bf16_f32 v61, v3, v4
    v_cvt_pk_bf16_f32 v62, v5, v10
    v_cvt_pk_bf16_f32 v63, v11, v9
    buffer_store_dwordx4 v[56:59], v6, s[12:15], s59 offen offset:0 sc1
    buffer_store_dwordx4 v[60:63], v6, s[12:15], s59 offen offset:1024 sc1
    v_accvgpr_read_b32 v0, a240
    v_accvgpr_read_b32 v1, a241
    v_accvgpr_read_b32 v3, a242
    v_accvgpr_read_b32 v4, a243
    v_accvgpr_read_b32 v5, a244
    v_accvgpr_read_b32 v10, a245
    v_accvgpr_read_b32 v11, a246
    v_accvgpr_read_b32 v9, a247
    v_cvt_pk_bf16_f32 v64, v0, v1
    v_cvt_pk_bf16_f32 v65, v3, v4
    v_cvt_pk_bf16_f32 v66, v5, v10
    v_cvt_pk_bf16_f32 v67, v11, v9
    v_accvgpr_read_b32 v0, a248
    v_accvgpr_read_b32 v1, a249
    v_accvgpr_read_b32 v3, a250
    v_accvgpr_read_b32 v4, a251
    v_accvgpr_read_b32 v5, a252
    v_accvgpr_read_b32 v10, a253
    v_accvgpr_read_b32 v11, a254
    v_accvgpr_read_b32 v9, a255
    v_cvt_pk_bf16_f32 v68, v0, v1
    v_cvt_pk_bf16_f32 v69, v3, v4
    v_cvt_pk_bf16_f32 v70, v5, v10
    v_cvt_pk_bf16_f32 v71, v11, v9
    buffer_store_dwordx4 v[64:67], v6, s[12:15], s59 offen offset:2048 sc1
    buffer_store_dwordx4 v[68:71], v6, s[12:15], s59 offen offset:3072 sc1
    v_cvt_pk_bf16_f32 v72, v80, v81
    v_cvt_pk_bf16_f32 v73, v82, v83
    v_cvt_pk_bf16_f32 v74, v84, v85
    v_cvt_pk_bf16_f32 v75, v86, v87
    v_cvt_pk_bf16_f32 v76, v88, v89
    v_cvt_pk_bf16_f32 v77, v90, v91
    v_cvt_pk_bf16_f32 v78, v92, v93
    v_cvt_pk_bf16_f32 v79, v94, v95
    buffer_store_dwordx4 v[72:75], v6, s[12:15], s51 offen offset:0 sc1
    buffer_store_dwordx4 v[76:79], v6, s[12:15], s51 offen offset:1024 sc1
    v_cvt_pk_bf16_f32 v48, v96, v97
    v_cvt_pk_bf16_f32 v49, v98, v99
    v_cvt_pk_bf16_f32 v50, v100, v101
    v_cvt_pk_bf16_f32 v51, v102, v103
    v_cvt_pk_bf16_f32 v52, v104, v105
    v_cvt_pk_bf16_f32 v53, v106, v107
    v_cvt_pk_bf16_f32 v54, v108, v109
    v_cvt_pk_bf16_f32 v55, v110, v111
    buffer_store_dwordx4 v[48:51], v6, s[12:15], s51 offen offset:2048 sc1
    buffer_store_dwordx4 v[52:55], v6, s[12:15], s51 offen offset:3072 sc1
    v_cvt_pk_bf16_f32 v56, v112, v113
    v_cvt_pk_bf16_f32 v57, v114, v115
    v_cvt_pk_bf16_f32 v58, v116, v117
    v_cvt_pk_bf16_f32 v59, v118, v119
    v_cvt_pk_bf16_f32 v60, v120, v121
    v_cvt_pk_bf16_f32 v61, v122, v123
    v_cvt_pk_bf16_f32 v62, v124, v125
    v_cvt_pk_bf16_f32 v63, v126, v127
    buffer_store_dwordx4 v[56:59], v6, s[12:15], s52 offen offset:0 sc1
    buffer_store_dwordx4 v[60:63], v6, s[12:15], s52 offen offset:1024 sc1
    v_cvt_pk_bf16_f32 v64, v128, v129
    v_cvt_pk_bf16_f32 v65, v130, v131
    v_cvt_pk_bf16_f32 v66, v132, v133
    v_cvt_pk_bf16_f32 v67, v134, v135
    v_cvt_pk_bf16_f32 v68, v136, v137
    v_cvt_pk_bf16_f32 v69, v138, v139
    v_cvt_pk_bf16_f32 v70, v140, v141
    v_cvt_pk_bf16_f32 v71, v142, v143
    buffer_store_dwordx4 v[64:67], v6, s[12:15], s52 offen offset:2048 sc1
    buffer_store_dwordx4 v[68:71], v6, s[12:15], s52 offen offset:3072 sc1
    v_cvt_pk_bf16_f32 v72, v144, v145
    v_cvt_pk_bf16_f32 v73, v146, v147
    v_cvt_pk_bf16_f32 v74, v148, v149
    v_cvt_pk_bf16_f32 v75, v150, v151
    v_cvt_pk_bf16_f32 v76, v152, v153
    v_cvt_pk_bf16_f32 v77, v154, v155
    v_cvt_pk_bf16_f32 v78, v156, v157
    v_cvt_pk_bf16_f32 v79, v158, v159
    buffer_store_dwordx4 v[72:75], v6, s[12:15], s53 offen offset:0 sc1
    buffer_store_dwordx4 v[76:79], v6, s[12:15], s53 offen offset:1024 sc1
    v_cvt_pk_bf16_f32 v48, v160, v161
    v_cvt_pk_bf16_f32 v49, v162, v163
    v_cvt_pk_bf16_f32 v50, v164, v165
    v_cvt_pk_bf16_f32 v51, v166, v167
    v_cvt_pk_bf16_f32 v52, v168, v169
    v_cvt_pk_bf16_f32 v53, v170, v171
    v_cvt_pk_bf16_f32 v54, v172, v173
    v_cvt_pk_bf16_f32 v55, v174, v175
    buffer_store_dwordx4 v[48:51], v6, s[12:15], s53 offen offset:2048 sc1
    buffer_store_dwordx4 v[52:55], v6, s[12:15], s53 offen offset:3072 sc1
    v_cvt_pk_bf16_f32 v56, v176, v177
    v_cvt_pk_bf16_f32 v57, v178, v179
    v_cvt_pk_bf16_f32 v58, v180, v181
    v_cvt_pk_bf16_f32 v59, v182, v183
    v_cvt_pk_bf16_f32 v60, v184, v185
    v_cvt_pk_bf16_f32 v61, v186, v187
    v_cvt_pk_bf16_f32 v62, v188, v189
    v_cvt_pk_bf16_f32 v63, v190, v191
    buffer_store_dwordx4 v[56:59], v6, s[12:15], s54 offen offset:0 sc1
    buffer_store_dwordx4 v[60:63], v6, s[12:15], s54 offen offset:1024 sc1
    v_cvt_pk_bf16_f32 v64, v192, v193
    v_cvt_pk_bf16_f32 v65, v194, v195
    v_cvt_pk_bf16_f32 v66, v196, v197
    v_cvt_pk_bf16_f32 v67, v198, v199
    v_cvt_pk_bf16_f32 v68, v200, v201
    v_cvt_pk_bf16_f32 v69, v202, v203
    v_cvt_pk_bf16_f32 v70, v204, v205
    v_cvt_pk_bf16_f32 v71, v206, v207
    buffer_store_dwordx4 v[64:67], v6, s[12:15], s54 offen offset:2048 sc1
    buffer_store_dwordx4 v[68:71], v6, s[12:15], s54 offen offset:3072 sc1
    v_cvt_pk_bf16_f32 v72, v208, v209
    v_cvt_pk_bf16_f32 v73, v210, v211
    v_cvt_pk_bf16_f32 v74, v212, v213
    v_cvt_pk_bf16_f32 v75, v214, v215
    v_cvt_pk_bf16_f32 v76, v216, v217
    v_cvt_pk_bf16_f32 v77, v218, v219
    v_cvt_pk_bf16_f32 v78, v220, v221
    v_cvt_pk_bf16_f32 v79, v222, v223
    buffer_store_dwordx4 v[72:75], v6, s[12:15], s55 offen offset:0 sc1
    buffer_store_dwordx4 v[76:79], v6, s[12:15], s55 offen offset:1024 sc1
    v_cvt_pk_bf16_f32 v48, v224, v225
    v_cvt_pk_bf16_f32 v49, v226, v227
    v_cvt_pk_bf16_f32 v50, v228, v229
    v_cvt_pk_bf16_f32 v51, v230, v231
    v_cvt_pk_bf16_f32 v52, v232, v233
    v_cvt_pk_bf16_f32 v53, v234, v235
    v_cvt_pk_bf16_f32 v54, v236, v237
    v_cvt_pk_bf16_f32 v55, v238, v239
    buffer_store_dwordx4 v[48:51], v6, s[12:15], s55 offen offset:2048 sc1
    buffer_store_dwordx4 v[52:55], v6, s[12:15], s55 offen offset:3072 sc1
    v_cvt_pk_bf16_f32 v56, v240, v241
    v_cvt_pk_bf16_f32 v57, v242, v243
    v_cvt_pk_bf16_f32 v58, v244, v245
    v_cvt_pk_bf16_f32 v59, v246, v247
    v_cvt_pk_bf16_f32 v60, v248, v249
    v_cvt_pk_bf16_f32 v61, v250, v251
    v_cvt_pk_bf16_f32 v62, v252, v253
    v_cvt_pk_bf16_f32 v63, v254, v255
    buffer_store_dwordx4 v[56:59], v6, s[12:15], s56 offen offset:0 sc1
    buffer_store_dwordx4 v[60:63], v6, s[12:15], s56 offen offset:1024 sc1
    s_mov_b32 s66, 1
    s_mul_i32 s48, s7, 128
    s_add_u32 s48, s48, 3200
    s_waitcnt vmcnt(0)
    s_barrier
    s_cmp_eq_u32 s8, 0
    s_cbranch_scc0 Lpub_6698
    s_mov_b64 exec, 1
    v_mov_b32 v250, s48
    v_mov_b32 v251, 1
    global_atomic_add v250, v251, s[34:35] sc1
    s_mov_b64 exec, -1
Lpub_6698:
    s_branch K2_final
L3_attn:
    s_sub_u32 s7, s7, 16
    s_lshr_b32 s9, s7, 2
    s_lshl_b32 s10, s6, 2
    s_add_u32 s9, s9, s10
    s_and_b32 s10, s7, 3
    s_lshl_b32 s10, s10, 4
    s_and_b32 s31, s8, 1
    s_lshl_b32 s31, s31, 3
    s_add_u32 s10, s10, s31
    s_lshr_b32 s31, s8, 1
    s_mov_b32 s30, 0
    s_lshr_b32 s48, s9, 3
    s_mul_i32 s48, s48, 128
    s_add_u32 s48, s48, 5760
    s_cmp_eq_u32 s8, 0
    s_cbranch_scc0 Lwait_6722_done
    s_mov_b32 s50, 0x40000
    s_mov_b64 exec, 1
    v_mov_b32 v246, s48
Lwait_6722:
    global_load_dword v250, v246, s[34:35] sc1
    s_waitcnt vmcnt(0)
    s_mov_b32 s51, 1
    v_readfirstlane_b32 s52, v250
    s_cmp_ge_u32 s52, 48
    s_cselect_b32 s51, s51, 0
    s_cmp_eq_u32 s51, 1
    s_cbranch_scc1 Lwait_6722_ok
    s_sub_u32 s50, s50, 1
    s_cmp_lg_u32 s50, 0
    s_cbranch_scc1 Lwait_6722
Lwait_6722_ok:
    s_mov_b64 exec, -1
Lwait_6722_done:
    s_barrier
    v_lshlrev_b32 v1, 4, v0
    v_lshlrev_b32 v2, 2, v0
    v_and_b32 v4, 31, v0
    v_lshlrev_b32 v5, 4, v4
    v_lshrrev_b32 v6, 5, v0
    v_mul_u32_u24 v7, 304, v6
    v_add_u32 v5, v5, v7
    v_cmp_lt_u32 vcc, 18, v4
    v_mov_b32 v7, 0x40000000
    v_lshlrev_b32 v12, 2, v4
    v_cndmask_b32 v3, v5, v7, vcc
    s_lshl_b32 s11, s9, 16
    s_lshl_b32 s24, s9, 13
    s_add_u32 s26, s11, 2359296
    s_add_u32 s27, s24, 4456448
    s_mul_i32 s28, s9, 77824
    s_add_u32 s28, s28, 4718592
    s_lshl_b32 s23, s31, 15
    s_add_u32 s16, s26, s23
    s_lshl_b32 s23, s31, 12
    s_add_u32 s17, s27, s23
    s_mul_i32 s23, s31, 38912
    s_add_u32 s18, s28, s23
    buffer_load_dwordx4 a[0:3], v1, s[12:15], s16 offen sc1
    buffer_load_dwordx4 a[4:7], v1, s[12:15], s16 offen offset:1024 sc1
    buffer_load_dword a24, v2, s[12:15], s17 offen sc1
    buffer_load_dwordx4 a[8:11], v3, s[12:15], s18 offen sc1
    buffer_load_dwordx4 a[12:15], v3, s[12:15], s18 offen offset:608 sc1
    buffer_load_dwordx4 a[16:19], v3, s[12:15], s18 offen offset:1216 sc1
    buffer_load_dwordx4 a[20:23], v3, s[12:15], s18 offen offset:1824 sc1
    s_add_u32 s16, s16, 2048
    s_add_u32 s17, s17, 256
    s_add_u32 s18, s18, 2432
    s_lshl_b32 s23, s31, 2
    s_add_u32 s34, s10, s23
    s_xor_b32 s23, s23, 4
    s_add_u32 s35, s10, s23
    s_lshl_b32 s23, s34, 10
    s_add_u32 s23, s23, s11
    s_add_u32 s23, s23, 0
    buffer_load_dwordx4 a[56:59], v1, s[12:15], s23 offen offset:0 sc1
    buffer_load_dwordx4 a[60:63], v1, s[12:15], s23 offen offset:1024 sc1
    buffer_load_dwordx4 a[64:67], v1, s[12:15], s23 offen offset:2048 sc1
    buffer_load_dwordx4 a[68:71], v1, s[12:15], s23 offen offset:3072 sc1
    s_lshl_b32 s23, s34, 7
    s_add_u32 s23, s23, s24
    s_add_u32 s23, s23, 2097152
    buffer_load_dword a88, v12, s[12:15], s23 offen offset:0 sc1
    buffer_load_dword a90, v12, s[12:15], s23 offen offset:128 sc1
    buffer_load_dword a92, v12, s[12:15], s23 offen offset:256 sc1
    buffer_load_dword a94, v12, s[12:15], s23 offen offset:384 sc1
    s_lshl_b32 s23, s35, 10
    s_add_u32 s23, s23, s11
    s_add_u32 s23, s23, 0
    buffer_load_dwordx4 a[72:75], v1, s[12:15], s23 offen offset:0 sc1
    buffer_load_dwordx4 a[76:79], v1, s[12:15], s23 offen offset:1024 sc1
    buffer_load_dwordx4 a[80:83], v1, s[12:15], s23 offen offset:2048 sc1
    buffer_load_dwordx4 a[84:87], v1, s[12:15], s23 offen offset:3072 sc1
    s_lshl_b32 s23, s35, 7
    s_add_u32 s23, s23, s24
    s_add_u32 s23, s23, 2097152
    buffer_load_dword a96, v12, s[12:15], s23 offen offset:0 sc1
    buffer_load_dword a98, v12, s[12:15], s23 offen offset:128 sc1
    buffer_load_dword a100, v12, s[12:15], s23 offen offset:256 sc1
    buffer_load_dword a102, v12, s[12:15], s23 offen offset:384 sc1
    v_mov_b32 v240, 0
    v_mov_b32 v241, 0
    v_mov_b32 v242, 0
    v_mov_b32 v243, 0
    v_mov_b32 v244, 0
    v_mov_b32 v245, 0
    v_mov_b32 v246, 0
    v_mov_b32 v247, 0
    v_mov_b32 v248, 0
    v_mov_b32 v249, 0
    v_mov_b32 v250, 0
    v_mov_b32 v251, 0
    v_mov_b32 v252, 0
    v_mov_b32 v253, 0
    v_mov_b32 v254, 0
    v_mov_b32 v255, 0
    v_accvgpr_write_b32 a36, 0
    v_accvgpr_write_b32 a37, 0
    v_accvgpr_write_b32 a38, 0
    v_accvgpr_write_b32 a39, 0
    v_accvgpr_write_b32 a40, 0
    v_accvgpr_write_b32 a41, 0
    v_accvgpr_write_b32 a42, 0
    v_accvgpr_write_b32 a43, 0
    v_accvgpr_write_b32 a44, 0
    v_accvgpr_write_b32 a45, 0
    v_accvgpr_write_b32 a46, 0
    v_accvgpr_write_b32 a47, 0
    v_accvgpr_write_b32 a48, 0
    v_accvgpr_write_b32 a49, 0
    v_accvgpr_write_b32 a50, 0
    v_accvgpr_write_b32 a51, 0
    v_accvgpr_write_b32 a25, 0
    v_accvgpr_write_b32 a53, 0
    v_accvgpr_write_b32 a89, 0
    v_accvgpr_write_b32 a91, 0
    v_accvgpr_write_b32 a93, 0
    v_accvgpr_write_b32 a95, 0
    v_accvgpr_write_b32 a97, 0
    v_accvgpr_write_b32 a99, 0
    v_accvgpr_write_b32 a101, 0
    v_accvgpr_write_b32 a103, 0
    v_mfma_f32_32x32x16_bf16 v[32:47], v[240:243], v[240:243], 0
    v_mfma_f32_32x32x16_bf16 v[48:63], v[240:243], v[240:243], 0
    v_mfma_f32_32x32x16_bf16 v[64:79], v[240:243], v[240:243], 0
    v_mfma_f32_32x32x16_bf16 v[80:95], v[240:243], v[240:243], 0
    v_mfma_f32_32x32x16_bf16 v[96:111], v[240:243], v[240:243], 0
    v_mfma_f32_32x32x16_bf16 v[112:127], v[240:243], v[240:243], 0
    v_mfma_f32_32x32x16_bf16 v[128:143], v[240:243], v[240:243], 0
    v_mfma_f32_32x32x16_bf16 v[144:159], v[240:243], v[240:243], 0
    s_waitcnt vmcnt(0)
    v_mfma_f32_32x32x4_2b_bf16 v[160:191], a[24:25], a[88:89], 0
    s_nop 15
    s_nop 1
    v_mfma_f32_32x32x16_bf16 v[160:175], a[0:3], a[56:59], v[160:175]
    v_mfma_f32_32x32x16_bf16 v[176:191], a[4:7], a[56:59], v[176:191]
    s_nop 10
    s_mov_b32 s22, 8
.p2align 6
L3_attn_loop:
    v_mfma_f32_32x32x4_2b_bf16 v[192:223], a[24:25], a[90:91], 0
    buffer_load_dwordx4 a[28:31], v1, s[12:15], s16 offen sc1
    v_exp_f32 v160, v160
    v_exp_f32 v161, v161
    v_exp_f32 v162, v162
    v_exp_f32 v163, v163
    v_cvt_pk_bf16_f32 v224, v160, v161
    v_exp_f32 v164, v164
    v_exp_f32 v165, v165
    v_cvt_pk_bf16_f32 v225, v162, v163
    v_mfma_f32_32x32x16_bf16 v[144:159], a[36:39], v[240:243], v[144:159]
    v_exp_f32 v166, v166
    v_exp_f32 v167, v167
    v_cvt_pk_bf16_f32 v226, v164, v165
    v_exp_f32 v168, v168
    v_exp_f32 v169, v169
    v_cvt_pk_bf16_f32 v227, v166, v167
    v_exp_f32 v170, v170
    v_mfma_f32_32x32x16_bf16 v[144:159], a[40:43], v[244:247], v[144:159]
    v_exp_f32 v171, v171
    v_cvt_pk_bf16_f32 v228, v168, v169
    v_exp_f32 v172, v172
    v_exp_f32 v173, v173
    v_cvt_pk_bf16_f32 v229, v170, v171
    v_exp_f32 v174, v174
    v_exp_f32 v175, v175
    v_mfma_f32_32x32x16_bf16 v[192:207], a[0:3], a[60:63], v[192:207]
    v_cvt_pk_bf16_f32 v230, v172, v173
    v_exp_f32 v176, v176
    v_exp_f32 v177, v177
    v_cvt_pk_bf16_f32 v231, v174, v175
    v_exp_f32 v178, v178
    v_exp_f32 v179, v179
    v_cvt_pk_bf16_f32 v232, v176, v177
    v_mfma_f32_32x32x16_bf16 v[208:223], a[4:7], a[60:63], v[208:223]
    v_exp_f32 v180, v180
    v_exp_f32 v181, v181
    v_cvt_pk_bf16_f32 v233, v178, v179
    v_exp_f32 v182, v182
    v_exp_f32 v183, v183
    v_cvt_pk_bf16_f32 v234, v180, v181
    v_mfma_f32_32x32x16_bf16 v[144:159], a[44:47], v[248:251], v[144:159]
    v_exp_f32 v184, v184
    v_exp_f32 v185, v185
    v_cvt_pk_bf16_f32 v235, v182, v183
    v_exp_f32 v186, v186
    v_exp_f32 v187, v187
    v_cvt_pk_bf16_f32 v236, v184, v185
    v_exp_f32 v188, v188
    v_mfma_f32_32x32x16_bf16 v[144:159], a[48:51], v[252:255], v[144:159]
    v_exp_f32 v189, v189
    v_cvt_pk_bf16_f32 v237, v186, v187
    v_exp_f32 v190, v190
    v_exp_f32 v191, v191
    v_cvt_pk_bf16_f32 v238, v188, v189
    v_cvt_pk_bf16_f32 v239, v190, v191
    v_mfma_f32_32x32x4_2b_bf16 v[160:191], a[24:25], a[92:93], 0
    buffer_load_dwordx4 a[32:35], v1, s[12:15], s16 offen offset:1024 sc1
    v_exp_f32 v192, v192
    v_exp_f32 v193, v193
    v_exp_f32 v194, v194
    v_exp_f32 v195, v195
    v_cvt_pk_bf16_f32 v240, v192, v193
    v_exp_f32 v196, v196
    v_exp_f32 v197, v197
    v_cvt_pk_bf16_f32 v241, v194, v195
    s_waitcnt vmcnt(2)
    v_mfma_f32_32x32x16_bf16 v[32:47], a[8:11], v[224:227], v[32:47]
    v_exp_f32 v198, v198
    v_exp_f32 v199, v199
    v_cvt_pk_bf16_f32 v242, v196, v197
    v_exp_f32 v200, v200
    v_exp_f32 v201, v201
    v_cvt_pk_bf16_f32 v243, v198, v199
    v_exp_f32 v202, v202
    v_mfma_f32_32x32x16_bf16 v[32:47], a[12:15], v[228:231], v[32:47]
    v_exp_f32 v203, v203
    v_cvt_pk_bf16_f32 v244, v200, v201
    v_exp_f32 v204, v204
    v_exp_f32 v205, v205
    v_cvt_pk_bf16_f32 v245, v202, v203
    v_exp_f32 v206, v206
    v_exp_f32 v207, v207
    v_mfma_f32_32x32x16_bf16 v[160:175], a[0:3], a[64:67], v[160:175]
    v_cvt_pk_bf16_f32 v246, v204, v205
    v_exp_f32 v208, v208
    v_exp_f32 v209, v209
    v_cvt_pk_bf16_f32 v247, v206, v207
    v_exp_f32 v210, v210
    v_exp_f32 v211, v211
    v_cvt_pk_bf16_f32 v248, v208, v209
    v_mfma_f32_32x32x16_bf16 v[176:191], a[4:7], a[64:67], v[176:191]
    v_exp_f32 v212, v212
    v_exp_f32 v213, v213
    v_cvt_pk_bf16_f32 v249, v210, v211
    v_exp_f32 v214, v214
    v_exp_f32 v215, v215
    v_cvt_pk_bf16_f32 v250, v212, v213
    v_mfma_f32_32x32x16_bf16 v[32:47], a[16:19], v[232:235], v[32:47]
    v_exp_f32 v216, v216
    v_exp_f32 v217, v217
    v_cvt_pk_bf16_f32 v251, v214, v215
    v_exp_f32 v218, v218
    v_exp_f32 v219, v219
    v_cvt_pk_bf16_f32 v252, v216, v217
    v_exp_f32 v220, v220
    v_mfma_f32_32x32x16_bf16 v[32:47], a[20:23], v[236:239], v[32:47]
    v_exp_f32 v221, v221
    v_cvt_pk_bf16_f32 v253, v218, v219
    v_exp_f32 v222, v222
    v_exp_f32 v223, v223
    v_cvt_pk_bf16_f32 v254, v220, v221
    v_cvt_pk_bf16_f32 v255, v222, v223
    v_mfma_f32_32x32x4_2b_bf16 v[192:223], a[24:25], a[94:95], 0
    buffer_load_dword a52, v2, s[12:15], s17 offen sc1
    v_exp_f32 v160, v160
    v_exp_f32 v161, v161
    v_exp_f32 v162, v162
    v_exp_f32 v163, v163
    v_cvt_pk_bf16_f32 v224, v160, v161
    v_exp_f32 v164, v164
    v_exp_f32 v165, v165
    v_cvt_pk_bf16_f32 v225, v162, v163
    v_mfma_f32_32x32x16_bf16 v[48:63], a[8:11], v[240:243], v[48:63]
    v_exp_f32 v166, v166
    v_exp_f32 v167, v167
    v_cvt_pk_bf16_f32 v226, v164, v165
    v_exp_f32 v168, v168
    v_exp_f32 v169, v169
    v_cvt_pk_bf16_f32 v227, v166, v167
    v_exp_f32 v170, v170
    v_mfma_f32_32x32x16_bf16 v[48:63], a[12:15], v[244:247], v[48:63]
    v_exp_f32 v171, v171
    v_cvt_pk_bf16_f32 v228, v168, v169
    v_exp_f32 v172, v172
    v_exp_f32 v173, v173
    v_cvt_pk_bf16_f32 v229, v170, v171
    v_exp_f32 v174, v174
    v_exp_f32 v175, v175
    v_mfma_f32_32x32x16_bf16 v[192:207], a[0:3], a[68:71], v[192:207]
    v_cvt_pk_bf16_f32 v230, v172, v173
    v_exp_f32 v176, v176
    v_exp_f32 v177, v177
    v_cvt_pk_bf16_f32 v231, v174, v175
    v_exp_f32 v178, v178
    v_exp_f32 v179, v179
    v_cvt_pk_bf16_f32 v232, v176, v177
    v_mfma_f32_32x32x16_bf16 v[208:223], a[4:7], a[68:71], v[208:223]
    v_exp_f32 v180, v180
    v_exp_f32 v181, v181
    v_cvt_pk_bf16_f32 v233, v178, v179
    v_exp_f32 v182, v182
    v_exp_f32 v183, v183
    v_cvt_pk_bf16_f32 v234, v180, v181
    v_mfma_f32_32x32x16_bf16 v[48:63], a[16:19], v[248:251], v[48:63]
    v_exp_f32 v184, v184
    v_exp_f32 v185, v185
    v_cvt_pk_bf16_f32 v235, v182, v183
    v_exp_f32 v186, v186
    v_exp_f32 v187, v187
    v_cvt_pk_bf16_f32 v236, v184, v185
    v_exp_f32 v188, v188
    v_mfma_f32_32x32x16_bf16 v[48:63], a[20:23], v[252:255], v[48:63]
    v_exp_f32 v189, v189
    v_cvt_pk_bf16_f32 v237, v186, v187
    v_exp_f32 v190, v190
    v_exp_f32 v191, v191
    v_cvt_pk_bf16_f32 v238, v188, v189
    v_cvt_pk_bf16_f32 v239, v190, v191
    v_mfma_f32_32x32x4_2b_bf16 v[160:191], a[24:25], a[96:97], 0
    buffer_load_dwordx4 a[36:39], v3, s[12:15], s18 offen sc1
    v_exp_f32 v192, v192
    v_exp_f32 v193, v193
    v_exp_f32 v194, v194
    v_exp_f32 v195, v195
    v_cvt_pk_bf16_f32 v240, v192, v193
    v_exp_f32 v196, v196
    v_exp_f32 v197, v197
    v_cvt_pk_bf16_f32 v241, v194, v195
    v_mfma_f32_32x32x16_bf16 v[64:79], a[8:11], v[224:227], v[64:79]
    v_exp_f32 v198, v198
    v_exp_f32 v199, v199
    v_cvt_pk_bf16_f32 v242, v196, v197
    v_exp_f32 v200, v200
    v_exp_f32 v201, v201
    v_cvt_pk_bf16_f32 v243, v198, v199
    v_exp_f32 v202, v202
    v_mfma_f32_32x32x16_bf16 v[64:79], a[12:15], v[228:231], v[64:79]
    v_exp_f32 v203, v203
    v_cvt_pk_bf16_f32 v244, v200, v201
    v_exp_f32 v204, v204
    v_exp_f32 v205, v205
    v_cvt_pk_bf16_f32 v245, v202, v203
    v_exp_f32 v206, v206
    v_exp_f32 v207, v207
    v_mfma_f32_32x32x16_bf16 v[160:175], a[0:3], a[72:75], v[160:175]
    v_cvt_pk_bf16_f32 v246, v204, v205
    v_exp_f32 v208, v208
    v_exp_f32 v209, v209
    v_cvt_pk_bf16_f32 v247, v206, v207
    v_exp_f32 v210, v210
    v_exp_f32 v211, v211
    v_cvt_pk_bf16_f32 v248, v208, v209
    v_mfma_f32_32x32x16_bf16 v[176:191], a[4:7], a[72:75], v[176:191]
    v_exp_f32 v212, v212
    v_exp_f32 v213, v213
    v_cvt_pk_bf16_f32 v249, v210, v211
    v_exp_f32 v214, v214
    v_exp_f32 v215, v215
    v_cvt_pk_bf16_f32 v250, v212, v213
    v_mfma_f32_32x32x16_bf16 v[64:79], a[16:19], v[232:235], v[64:79]
    v_exp_f32 v216, v216
    v_exp_f32 v217, v217
    v_cvt_pk_bf16_f32 v251, v214, v215
    v_exp_f32 v218, v218
    v_exp_f32 v219, v219
    v_cvt_pk_bf16_f32 v252, v216, v217
    v_exp_f32 v220, v220
    v_mfma_f32_32x32x16_bf16 v[64:79], a[20:23], v[236:239], v[64:79]
    v_exp_f32 v221, v221
    v_cvt_pk_bf16_f32 v253, v218, v219
    v_exp_f32 v222, v222
    v_exp_f32 v223, v223
    v_cvt_pk_bf16_f32 v254, v220, v221
    v_cvt_pk_bf16_f32 v255, v222, v223
    v_mfma_f32_32x32x4_2b_bf16 v[192:223], a[24:25], a[98:99], 0
    buffer_load_dwordx4 a[40:43], v3, s[12:15], s18 offen offset:608 sc1
    v_exp_f32 v160, v160
    v_exp_f32 v161, v161
    v_exp_f32 v162, v162
    v_exp_f32 v163, v163
    v_cvt_pk_bf16_f32 v224, v160, v161
    v_exp_f32 v164, v164
    v_exp_f32 v165, v165
    v_cvt_pk_bf16_f32 v225, v162, v163
    v_mfma_f32_32x32x16_bf16 v[80:95], a[8:11], v[240:243], v[80:95]
    v_exp_f32 v166, v166
    v_exp_f32 v167, v167
    v_cvt_pk_bf16_f32 v226, v164, v165
    v_exp_f32 v168, v168
    v_exp_f32 v169, v169
    v_cvt_pk_bf16_f32 v227, v166, v167
    v_exp_f32 v170, v170
    v_mfma_f32_32x32x16_bf16 v[80:95], a[12:15], v[244:247], v[80:95]
    v_exp_f32 v171, v171
    v_cvt_pk_bf16_f32 v228, v168, v169
    v_exp_f32 v172, v172
    v_exp_f32 v173, v173
    v_cvt_pk_bf16_f32 v229, v170, v171
    v_exp_f32 v174, v174
    v_exp_f32 v175, v175
    v_mfma_f32_32x32x16_bf16 v[192:207], a[0:3], a[76:79], v[192:207]
    v_cvt_pk_bf16_f32 v230, v172, v173
    v_exp_f32 v176, v176
    v_exp_f32 v177, v177
    v_cvt_pk_bf16_f32 v231, v174, v175
    v_exp_f32 v178, v178
    v_exp_f32 v179, v179
    v_cvt_pk_bf16_f32 v232, v176, v177
    v_mfma_f32_32x32x16_bf16 v[208:223], a[4:7], a[76:79], v[208:223]
    v_exp_f32 v180, v180
    v_exp_f32 v181, v181
    v_cvt_pk_bf16_f32 v233, v178, v179
    v_exp_f32 v182, v182
    v_exp_f32 v183, v183
    v_cvt_pk_bf16_f32 v234, v180, v181
    v_mfma_f32_32x32x16_bf16 v[80:95], a[16:19], v[248:251], v[80:95]
    v_exp_f32 v184, v184
    v_exp_f32 v185, v185
    v_cvt_pk_bf16_f32 v235, v182, v183
    v_exp_f32 v186, v186
    v_exp_f32 v187, v187
    v_cvt_pk_bf16_f32 v236, v184, v185
    v_exp_f32 v188, v188
    v_mfma_f32_32x32x16_bf16 v[80:95], a[20:23], v[252:255], v[80:95]
    v_exp_f32 v189, v189
    v_cvt_pk_bf16_f32 v237, v186, v187
    v_exp_f32 v190, v190
    v_exp_f32 v191, v191
    v_cvt_pk_bf16_f32 v238, v188, v189
    v_cvt_pk_bf16_f32 v239, v190, v191
    v_mfma_f32_32x32x4_2b_bf16 v[160:191], a[24:25], a[100:101], 0
    buffer_load_dwordx4 a[44:47], v3, s[12:15], s18 offen offset:1216 sc1
    v_exp_f32 v192, v192
    v_exp_f32 v193, v193
    v_exp_f32 v194, v194
    v_exp_f32 v195, v195
    v_cvt_pk_bf16_f32 v240, v192, v193
    v_exp_f32 v196, v196
    v_exp_f32 v197, v197
    v_cvt_pk_bf16_f32 v241, v194, v195
    v_mfma_f32_32x32x16_bf16 v[96:111], a[8:11], v[224:227], v[96:111]
    v_exp_f32 v198, v198
    v_exp_f32 v199, v199
    v_cvt_pk_bf16_f32 v242, v196, v197
    v_exp_f32 v200, v200
    v_exp_f32 v201, v201
    v_cvt_pk_bf16_f32 v243, v198, v199
    v_exp_f32 v202, v202
    v_mfma_f32_32x32x16_bf16 v[96:111], a[12:15], v[228:231], v[96:111]
    v_exp_f32 v203, v203
    v_cvt_pk_bf16_f32 v244, v200, v201
    v_exp_f32 v204, v204
    v_exp_f32 v205, v205
    v_cvt_pk_bf16_f32 v245, v202, v203
    v_exp_f32 v206, v206
    v_exp_f32 v207, v207
    v_mfma_f32_32x32x16_bf16 v[160:175], a[0:3], a[80:83], v[160:175]
    v_cvt_pk_bf16_f32 v246, v204, v205
    v_exp_f32 v208, v208
    v_exp_f32 v209, v209
    v_cvt_pk_bf16_f32 v247, v206, v207
    v_exp_f32 v210, v210
    v_exp_f32 v211, v211
    v_cvt_pk_bf16_f32 v248, v208, v209
    v_mfma_f32_32x32x16_bf16 v[176:191], a[4:7], a[80:83], v[176:191]
    v_exp_f32 v212, v212
    v_exp_f32 v213, v213
    v_cvt_pk_bf16_f32 v249, v210, v211
    v_exp_f32 v214, v214
    v_exp_f32 v215, v215
    v_cvt_pk_bf16_f32 v250, v212, v213
    v_mfma_f32_32x32x16_bf16 v[96:111], a[16:19], v[232:235], v[96:111]
    v_exp_f32 v216, v216
    v_exp_f32 v217, v217
    v_cvt_pk_bf16_f32 v251, v214, v215
    v_exp_f32 v218, v218
    v_exp_f32 v219, v219
    v_cvt_pk_bf16_f32 v252, v216, v217
    v_exp_f32 v220, v220
    v_mfma_f32_32x32x16_bf16 v[96:111], a[20:23], v[236:239], v[96:111]
    v_exp_f32 v221, v221
    v_cvt_pk_bf16_f32 v253, v218, v219
    v_exp_f32 v222, v222
    v_exp_f32 v223, v223
    v_cvt_pk_bf16_f32 v254, v220, v221
    v_cvt_pk_bf16_f32 v255, v222, v223
    v_mfma_f32_32x32x4_2b_bf16 v[192:223], a[24:25], a[102:103], 0
    buffer_load_dwordx4 a[48:51], v3, s[12:15], s18 offen offset:1824 sc1
    v_exp_f32 v160, v160
    v_exp_f32 v161, v161
    v_exp_f32 v162, v162
    v_exp_f32 v163, v163
    v_cvt_pk_bf16_f32 v224, v160, v161
    v_exp_f32 v164, v164
    v_exp_f32 v165, v165
    v_cvt_pk_bf16_f32 v225, v162, v163
    v_mfma_f32_32x32x16_bf16 v[112:127], a[8:11], v[240:243], v[112:127]
    v_exp_f32 v166, v166
    v_exp_f32 v167, v167
    v_cvt_pk_bf16_f32 v226, v164, v165
    v_exp_f32 v168, v168
    v_exp_f32 v169, v169
    v_cvt_pk_bf16_f32 v227, v166, v167
    v_exp_f32 v170, v170
    v_mfma_f32_32x32x16_bf16 v[112:127], a[12:15], v[244:247], v[112:127]
    v_exp_f32 v171, v171
    v_cvt_pk_bf16_f32 v228, v168, v169
    v_exp_f32 v172, v172
    v_exp_f32 v173, v173
    v_cvt_pk_bf16_f32 v229, v170, v171
    v_exp_f32 v174, v174
    v_exp_f32 v175, v175
    v_mfma_f32_32x32x16_bf16 v[192:207], a[0:3], a[84:87], v[192:207]
    v_cvt_pk_bf16_f32 v230, v172, v173
    v_exp_f32 v176, v176
    v_exp_f32 v177, v177
    v_cvt_pk_bf16_f32 v231, v174, v175
    v_exp_f32 v178, v178
    v_exp_f32 v179, v179
    v_cvt_pk_bf16_f32 v232, v176, v177
    v_mfma_f32_32x32x16_bf16 v[208:223], a[4:7], a[84:87], v[208:223]
    v_exp_f32 v180, v180
    v_exp_f32 v181, v181
    v_cvt_pk_bf16_f32 v233, v178, v179
    v_exp_f32 v182, v182
    v_exp_f32 v183, v183
    v_cvt_pk_bf16_f32 v234, v180, v181
    v_mfma_f32_32x32x16_bf16 v[112:127], a[16:19], v[248:251], v[112:127]
    v_exp_f32 v184, v184
    v_exp_f32 v185, v185
    v_cvt_pk_bf16_f32 v235, v182, v183
    v_exp_f32 v186, v186
    v_exp_f32 v187, v187
    v_cvt_pk_bf16_f32 v236, v184, v185
    v_exp_f32 v188, v188
    v_mfma_f32_32x32x16_bf16 v[112:127], a[20:23], v[252:255], v[112:127]
    v_exp_f32 v189, v189
    v_cvt_pk_bf16_f32 v237, v186, v187
    v_exp_f32 v190, v190
    v_exp_f32 v191, v191
    v_cvt_pk_bf16_f32 v238, v188, v189
    v_cvt_pk_bf16_f32 v239, v190, v191
    s_waitcnt vmcnt(4)
    v_mfma_f32_32x32x4_2b_bf16 v[160:191], a[52:53], a[88:89], 0
    s_add_u32 s16, s16, 2048
    s_add_u32 s17, s17, 256
    v_exp_f32 v192, v192
    v_exp_f32 v193, v193
    v_exp_f32 v194, v194
    v_exp_f32 v195, v195
    v_cvt_pk_bf16_f32 v240, v192, v193
    v_exp_f32 v196, v196
    v_exp_f32 v197, v197
    v_cvt_pk_bf16_f32 v241, v194, v195
    v_exp_f32 v198, v198
    v_mfma_f32_32x32x16_bf16 v[128:143], a[8:11], v[224:227], v[128:143]
    v_exp_f32 v199, v199
    v_cvt_pk_bf16_f32 v242, v196, v197
    v_exp_f32 v200, v200
    v_exp_f32 v201, v201
    v_cvt_pk_bf16_f32 v243, v198, v199
    v_exp_f32 v202, v202
    v_exp_f32 v203, v203
    v_mfma_f32_32x32x16_bf16 v[128:143], a[12:15], v[228:231], v[128:143]
    v_cvt_pk_bf16_f32 v244, v200, v201
    v_exp_f32 v204, v204
    v_exp_f32 v205, v205
    v_cvt_pk_bf16_f32 v245, v202, v203
    v_exp_f32 v206, v206
    v_exp_f32 v207, v207
    v_cvt_pk_bf16_f32 v246, v204, v205
    v_mfma_f32_32x32x16_bf16 v[160:175], a[28:31], a[56:59], v[160:175]
    s_add_u32 s18, s18, 2432
    v_exp_f32 v208, v208
    v_exp_f32 v209, v209
    v_cvt_pk_bf16_f32 v247, v206, v207
    v_exp_f32 v210, v210
    v_exp_f32 v211, v211
    v_cvt_pk_bf16_f32 v248, v208, v209
    v_exp_f32 v212, v212
    v_mfma_f32_32x32x16_bf16 v[176:191], a[32:35], a[56:59], v[176:191]
    v_exp_f32 v213, v213
    v_cvt_pk_bf16_f32 v249, v210, v211
    v_exp_f32 v214, v214
    v_exp_f32 v215, v215
    v_cvt_pk_bf16_f32 v250, v212, v213
    v_exp_f32 v216, v216
    v_mfma_f32_32x32x16_bf16 v[128:143], a[16:19], v[232:235], v[128:143]
    v_exp_f32 v217, v217
    v_cvt_pk_bf16_f32 v251, v214, v215
    v_exp_f32 v218, v218
    v_exp_f32 v219, v219
    v_cvt_pk_bf16_f32 v252, v216, v217
    v_exp_f32 v220, v220
    v_mfma_f32_32x32x16_bf16 v[128:143], a[20:23], v[236:239], v[128:143]
    v_exp_f32 v221, v221
    v_cvt_pk_bf16_f32 v253, v218, v219
    v_exp_f32 v222, v222
    v_exp_f32 v223, v223
    v_cvt_pk_bf16_f32 v254, v220, v221
    v_cvt_pk_bf16_f32 v255, v222, v223
    v_mfma_f32_32x32x4_2b_bf16 v[192:223], a[52:53], a[90:91], 0
    buffer_load_dwordx4 a[0:3], v1, s[12:15], s16 offen sc1
    v_exp_f32 v160, v160
    v_exp_f32 v161, v161
    v_exp_f32 v162, v162
    v_exp_f32 v163, v163
    v_cvt_pk_bf16_f32 v224, v160, v161
    v_exp_f32 v164, v164
    v_exp_f32 v165, v165
    v_cvt_pk_bf16_f32 v225, v162, v163
    v_mfma_f32_32x32x16_bf16 v[144:159], a[8:11], v[240:243], v[144:159]
    v_exp_f32 v166, v166
    v_exp_f32 v167, v167
    v_cvt_pk_bf16_f32 v226, v164, v165
    v_exp_f32 v168, v168
    v_exp_f32 v169, v169
    v_cvt_pk_bf16_f32 v227, v166, v167
    v_exp_f32 v170, v170
    v_mfma_f32_32x32x16_bf16 v[144:159], a[12:15], v[244:247], v[144:159]
    v_exp_f32 v171, v171
    v_cvt_pk_bf16_f32 v228, v168, v169
    v_exp_f32 v172, v172
    v_exp_f32 v173, v173
    v_cvt_pk_bf16_f32 v229, v170, v171
    v_exp_f32 v174, v174
    v_exp_f32 v175, v175
    v_mfma_f32_32x32x16_bf16 v[192:207], a[28:31], a[60:63], v[192:207]
    v_cvt_pk_bf16_f32 v230, v172, v173
    v_exp_f32 v176, v176
    v_exp_f32 v177, v177
    v_cvt_pk_bf16_f32 v231, v174, v175
    v_exp_f32 v178, v178
    v_exp_f32 v179, v179
    v_cvt_pk_bf16_f32 v232, v176, v177
    v_mfma_f32_32x32x16_bf16 v[208:223], a[32:35], a[60:63], v[208:223]
    v_exp_f32 v180, v180
    v_exp_f32 v181, v181
    v_cvt_pk_bf16_f32 v233, v178, v179
    v_exp_f32 v182, v182
    v_exp_f32 v183, v183
    v_cvt_pk_bf16_f32 v234, v180, v181
    v_mfma_f32_32x32x16_bf16 v[144:159], a[16:19], v[248:251], v[144:159]
    v_exp_f32 v184, v184
    v_exp_f32 v185, v185
    v_cvt_pk_bf16_f32 v235, v182, v183
    v_exp_f32 v186, v186
    v_exp_f32 v187, v187
    v_cvt_pk_bf16_f32 v236, v184, v185
    v_exp_f32 v188, v188
    v_mfma_f32_32x32x16_bf16 v[144:159], a[20:23], v[252:255], v[144:159]
    v_exp_f32 v189, v189
    v_cvt_pk_bf16_f32 v237, v186, v187
    v_exp_f32 v190, v190
    v_exp_f32 v191, v191
    v_cvt_pk_bf16_f32 v238, v188, v189
    v_cvt_pk_bf16_f32 v239, v190, v191
    v_mfma_f32_32x32x4_2b_bf16 v[160:191], a[52:53], a[92:93], 0
    buffer_load_dwordx4 a[4:7], v1, s[12:15], s16 offen offset:1024 sc1
    v_exp_f32 v192, v192
    v_exp_f32 v193, v193
    v_exp_f32 v194, v194
    v_exp_f32 v195, v195
    v_cvt_pk_bf16_f32 v240, v192, v193
    v_exp_f32 v196, v196
    v_exp_f32 v197, v197
    v_cvt_pk_bf16_f32 v241, v194, v195
    s_waitcnt vmcnt(2)
    v_mfma_f32_32x32x16_bf16 v[32:47], a[36:39], v[224:227], v[32:47]
    v_exp_f32 v198, v198
    v_exp_f32 v199, v199
    v_cvt_pk_bf16_f32 v242, v196, v197
    v_exp_f32 v200, v200
    v_exp_f32 v201, v201
    v_cvt_pk_bf16_f32 v243, v198, v199
    v_exp_f32 v202, v202
    v_mfma_f32_32x32x16_bf16 v[32:47], a[40:43], v[228:231], v[32:47]
    v_exp_f32 v203, v203
    v_cvt_pk_bf16_f32 v244, v200, v201
    v_exp_f32 v204, v204
    v_exp_f32 v205, v205
    v_cvt_pk_bf16_f32 v245, v202, v203
    v_exp_f32 v206, v206
    v_exp_f32 v207, v207
    v_mfma_f32_32x32x16_bf16 v[160:175], a[28:31], a[64:67], v[160:175]
    v_cvt_pk_bf16_f32 v246, v204, v205
    v_exp_f32 v208, v208
    v_exp_f32 v209, v209
    v_cvt_pk_bf16_f32 v247, v206, v207
    v_exp_f32 v210, v210
    v_exp_f32 v211, v211
    v_cvt_pk_bf16_f32 v248, v208, v209
    v_mfma_f32_32x32x16_bf16 v[176:191], a[32:35], a[64:67], v[176:191]
    v_exp_f32 v212, v212
    v_exp_f32 v213, v213
    v_cvt_pk_bf16_f32 v249, v210, v211
    v_exp_f32 v214, v214
    v_exp_f32 v215, v215
    v_cvt_pk_bf16_f32 v250, v212, v213
    v_mfma_f32_32x32x16_bf16 v[32:47], a[44:47], v[232:235], v[32:47]
    v_exp_f32 v216, v216
    v_exp_f32 v217, v217
    v_cvt_pk_bf16_f32 v251, v214, v215
    v_exp_f32 v218, v218
    v_exp_f32 v219, v219
    v_cvt_pk_bf16_f32 v252, v216, v217
    v_exp_f32 v220, v220
    v_mfma_f32_32x32x16_bf16 v[32:47], a[48:51], v[236:239], v[32:47]
    v_exp_f32 v221, v221
    v_cvt_pk_bf16_f32 v253, v218, v219
    v_exp_f32 v222, v222
    v_exp_f32 v223, v223
    v_cvt_pk_bf16_f32 v254, v220, v221
    v_cvt_pk_bf16_f32 v255, v222, v223
    v_mfma_f32_32x32x4_2b_bf16 v[192:223], a[52:53], a[94:95], 0
    buffer_load_dword a24, v2, s[12:15], s17 offen sc1
    v_exp_f32 v160, v160
    v_exp_f32 v161, v161
    v_exp_f32 v162, v162
    v_exp_f32 v163, v163
    v_cvt_pk_bf16_f32 v224, v160, v161
    v_exp_f32 v164, v164
    v_exp_f32 v165, v165
    v_cvt_pk_bf16_f32 v225, v162, v163
    v_mfma_f32_32x32x16_bf16 v[48:63], a[36:39], v[240:243], v[48:63]
    v_exp_f32 v166, v166
    v_exp_f32 v167, v167
    v_cvt_pk_bf16_f32 v226, v164, v165
    v_exp_f32 v168, v168
    v_exp_f32 v169, v169
    v_cvt_pk_bf16_f32 v227, v166, v167
    v_exp_f32 v170, v170
    v_mfma_f32_32x32x16_bf16 v[48:63], a[40:43], v[244:247], v[48:63]
    v_exp_f32 v171, v171
    v_cvt_pk_bf16_f32 v228, v168, v169
    v_exp_f32 v172, v172
    v_exp_f32 v173, v173
    v_cvt_pk_bf16_f32 v229, v170, v171
    v_exp_f32 v174, v174
    v_exp_f32 v175, v175
    v_mfma_f32_32x32x16_bf16 v[192:207], a[28:31], a[68:71], v[192:207]
    v_cvt_pk_bf16_f32 v230, v172, v173
    v_exp_f32 v176, v176
    v_exp_f32 v177, v177
    v_cvt_pk_bf16_f32 v231, v174, v175
    v_exp_f32 v178, v178
    v_exp_f32 v179, v179
    v_cvt_pk_bf16_f32 v232, v176, v177
    v_mfma_f32_32x32x16_bf16 v[208:223], a[32:35], a[68:71], v[208:223]
    v_exp_f32 v180, v180
    v_exp_f32 v181, v181
    v_cvt_pk_bf16_f32 v233, v178, v179
    v_exp_f32 v182, v182
    v_exp_f32 v183, v183
    v_cvt_pk_bf16_f32 v234, v180, v181
    v_mfma_f32_32x32x16_bf16 v[48:63], a[44:47], v[248:251], v[48:63]
    v_exp_f32 v184, v184
    v_exp_f32 v185, v185
    v_cvt_pk_bf16_f32 v235, v182, v183
    v_exp_f32 v186, v186
    v_exp_f32 v187, v187
    v_cvt_pk_bf16_f32 v236, v184, v185
    v_exp_f32 v188, v188
    v_mfma_f32_32x32x16_bf16 v[48:63], a[48:51], v[252:255], v[48:63]
    v_exp_f32 v189, v189
    v_cvt_pk_bf16_f32 v237, v186, v187
    v_exp_f32 v190, v190
    v_exp_f32 v191, v191
    v_cvt_pk_bf16_f32 v238, v188, v189
    v_cvt_pk_bf16_f32 v239, v190, v191
    v_mfma_f32_32x32x4_2b_bf16 v[160:191], a[52:53], a[96:97], 0
    buffer_load_dwordx4 a[8:11], v3, s[12:15], s18 offen sc1
    v_exp_f32 v192, v192
    v_exp_f32 v193, v193
    v_exp_f32 v194, v194
    v_exp_f32 v195, v195
    v_cvt_pk_bf16_f32 v240, v192, v193
    v_exp_f32 v196, v196
    v_exp_f32 v197, v197
    v_cvt_pk_bf16_f32 v241, v194, v195
    v_mfma_f32_32x32x16_bf16 v[64:79], a[36:39], v[224:227], v[64:79]
    v_exp_f32 v198, v198
    v_exp_f32 v199, v199
    v_cvt_pk_bf16_f32 v242, v196, v197
    v_exp_f32 v200, v200
    v_exp_f32 v201, v201
    v_cvt_pk_bf16_f32 v243, v198, v199
    v_exp_f32 v202, v202
    v_mfma_f32_32x32x16_bf16 v[64:79], a[40:43], v[228:231], v[64:79]
    v_exp_f32 v203, v203
    v_cvt_pk_bf16_f32 v244, v200, v201
    v_exp_f32 v204, v204
    v_exp_f32 v205, v205
    v_cvt_pk_bf16_f32 v245, v202, v203
    v_exp_f32 v206, v206
    v_exp_f32 v207, v207
    v_mfma_f32_32x32x16_bf16 v[160:175], a[28:31], a[72:75], v[160:175]
    v_cvt_pk_bf16_f32 v246, v204, v205
    v_exp_f32 v208, v208
    v_exp_f32 v209, v209
    v_cvt_pk_bf16_f32 v247, v206, v207
    v_exp_f32 v210, v210
    v_exp_f32 v211, v211
    v_cvt_pk_bf16_f32 v248, v208, v209
    v_mfma_f32_32x32x16_bf16 v[176:191], a[32:35], a[72:75], v[176:191]
    v_exp_f32 v212, v212
    v_exp_f32 v213, v213
    v_cvt_pk_bf16_f32 v249, v210, v211
    v_exp_f32 v214, v214
    v_exp_f32 v215, v215
    v_cvt_pk_bf16_f32 v250, v212, v213
    v_mfma_f32_32x32x16_bf16 v[64:79], a[44:47], v[232:235], v[64:79]
    v_exp_f32 v216, v216
    v_exp_f32 v217, v217
    v_cvt_pk_bf16_f32 v251, v214, v215
    v_exp_f32 v218, v218
    v_exp_f32 v219, v219
    v_cvt_pk_bf16_f32 v252, v216, v217
    v_exp_f32 v220, v220
    v_mfma_f32_32x32x16_bf16 v[64:79], a[48:51], v[236:239], v[64:79]
    v_exp_f32 v221, v221
    v_cvt_pk_bf16_f32 v253, v218, v219
    v_exp_f32 v222, v222
    v_exp_f32 v223, v223
    v_cvt_pk_bf16_f32 v254, v220, v221
    v_cvt_pk_bf16_f32 v255, v222, v223
    v_mfma_f32_32x32x4_2b_bf16 v[192:223], a[52:53], a[98:99], 0
    buffer_load_dwordx4 a[12:15], v3, s[12:15], s18 offen offset:608 sc1
    v_exp_f32 v160, v160
    v_exp_f32 v161, v161
    v_exp_f32 v162, v162
    v_exp_f32 v163, v163
    v_cvt_pk_bf16_f32 v224, v160, v161
    v_exp_f32 v164, v164
    v_exp_f32 v165, v165
    v_cvt_pk_bf16_f32 v225, v162, v163
    v_mfma_f32_32x32x16_bf16 v[80:95], a[36:39], v[240:243], v[80:95]
    v_exp_f32 v166, v166
    v_exp_f32 v167, v167
    v_cvt_pk_bf16_f32 v226, v164, v165
    v_exp_f32 v168, v168
    v_exp_f32 v169, v169
    v_cvt_pk_bf16_f32 v227, v166, v167
    v_exp_f32 v170, v170
    v_mfma_f32_32x32x16_bf16 v[80:95], a[40:43], v[244:247], v[80:95]
    v_exp_f32 v171, v171
    v_cvt_pk_bf16_f32 v228, v168, v169
    v_exp_f32 v172, v172
    v_exp_f32 v173, v173
    v_cvt_pk_bf16_f32 v229, v170, v171
    v_exp_f32 v174, v174
    v_exp_f32 v175, v175
    v_mfma_f32_32x32x16_bf16 v[192:207], a[28:31], a[76:79], v[192:207]
    v_cvt_pk_bf16_f32 v230, v172, v173
    v_exp_f32 v176, v176
    v_exp_f32 v177, v177
    v_cvt_pk_bf16_f32 v231, v174, v175
    v_exp_f32 v178, v178
    v_exp_f32 v179, v179
    v_cvt_pk_bf16_f32 v232, v176, v177
    v_mfma_f32_32x32x16_bf16 v[208:223], a[32:35], a[76:79], v[208:223]
    v_exp_f32 v180, v180
    v_exp_f32 v181, v181
    v_cvt_pk_bf16_f32 v233, v178, v179
    v_exp_f32 v182, v182
    v_exp_f32 v183, v183
    v_cvt_pk_bf16_f32 v234, v180, v181
    v_mfma_f32_32x32x16_bf16 v[80:95], a[44:47], v[248:251], v[80:95]
    v_exp_f32 v184, v184
    v_exp_f32 v185, v185
    v_cvt_pk_bf16_f32 v235, v182, v183
    v_exp_f32 v186, v186
    v_exp_f32 v187, v187
    v_cvt_pk_bf16_f32 v236, v184, v185
    v_exp_f32 v188, v188
    v_mfma_f32_32x32x16_bf16 v[80:95], a[48:51], v[252:255], v[80:95]
    v_exp_f32 v189, v189
    v_cvt_pk_bf16_f32 v237, v186, v187
    v_exp_f32 v190, v190
    v_exp_f32 v191, v191
    v_cvt_pk_bf16_f32 v238, v188, v189
    v_cvt_pk_bf16_f32 v239, v190, v191
    v_mfma_f32_32x32x4_2b_bf16 v[160:191], a[52:53], a[100:101], 0
    buffer_load_dwordx4 a[16:19], v3, s[12:15], s18 offen offset:1216 sc1
    v_exp_f32 v192, v192
    v_exp_f32 v193, v193
    v_exp_f32 v194, v194
    v_exp_f32 v195, v195
    v_cvt_pk_bf16_f32 v240, v192, v193
    v_exp_f32 v196, v196
    v_exp_f32 v197, v197
    v_cvt_pk_bf16_f32 v241, v194, v195
    v_mfma_f32_32x32x16_bf16 v[96:111], a[36:39], v[224:227], v[96:111]
    v_exp_f32 v198, v198
    v_exp_f32 v199, v199
    v_cvt_pk_bf16_f32 v242, v196, v197
    v_exp_f32 v200, v200
    v_exp_f32 v201, v201
    v_cvt_pk_bf16_f32 v243, v198, v199
    v_exp_f32 v202, v202
    v_mfma_f32_32x32x16_bf16 v[96:111], a[40:43], v[228:231], v[96:111]
    v_exp_f32 v203, v203
    v_cvt_pk_bf16_f32 v244, v200, v201
    v_exp_f32 v204, v204
    v_exp_f32 v205, v205
    v_cvt_pk_bf16_f32 v245, v202, v203
    v_exp_f32 v206, v206
    v_exp_f32 v207, v207
    v_mfma_f32_32x32x16_bf16 v[160:175], a[28:31], a[80:83], v[160:175]
    v_cvt_pk_bf16_f32 v246, v204, v205
    v_exp_f32 v208, v208
    v_exp_f32 v209, v209
    v_cvt_pk_bf16_f32 v247, v206, v207
    v_exp_f32 v210, v210
    v_exp_f32 v211, v211
    v_cvt_pk_bf16_f32 v248, v208, v209
    v_mfma_f32_32x32x16_bf16 v[176:191], a[32:35], a[80:83], v[176:191]
    v_exp_f32 v212, v212
    v_exp_f32 v213, v213
    v_cvt_pk_bf16_f32 v249, v210, v211
    v_exp_f32 v214, v214
    v_exp_f32 v215, v215
    v_cvt_pk_bf16_f32 v250, v212, v213
    v_mfma_f32_32x32x16_bf16 v[96:111], a[44:47], v[232:235], v[96:111]
    v_exp_f32 v216, v216
    v_exp_f32 v217, v217
    v_cvt_pk_bf16_f32 v251, v214, v215
    v_exp_f32 v218, v218
    v_exp_f32 v219, v219
    v_cvt_pk_bf16_f32 v252, v216, v217
    v_exp_f32 v220, v220
    v_mfma_f32_32x32x16_bf16 v[96:111], a[48:51], v[236:239], v[96:111]
    v_exp_f32 v221, v221
    v_cvt_pk_bf16_f32 v253, v218, v219
    v_exp_f32 v222, v222
    v_exp_f32 v223, v223
    v_cvt_pk_bf16_f32 v254, v220, v221
    v_cvt_pk_bf16_f32 v255, v222, v223
    v_mfma_f32_32x32x4_2b_bf16 v[192:223], a[52:53], a[102:103], 0
    buffer_load_dwordx4 a[20:23], v3, s[12:15], s18 offen offset:1824 sc1
    v_exp_f32 v160, v160
    v_exp_f32 v161, v161
    v_exp_f32 v162, v162
    v_exp_f32 v163, v163
    v_cvt_pk_bf16_f32 v224, v160, v161
    v_exp_f32 v164, v164
    v_exp_f32 v165, v165
    v_cvt_pk_bf16_f32 v225, v162, v163
    v_mfma_f32_32x32x16_bf16 v[112:127], a[36:39], v[240:243], v[112:127]
    v_exp_f32 v166, v166
    v_exp_f32 v167, v167
    v_cvt_pk_bf16_f32 v226, v164, v165
    v_exp_f32 v168, v168
    v_exp_f32 v169, v169
    v_cvt_pk_bf16_f32 v227, v166, v167
    v_exp_f32 v170, v170
    v_mfma_f32_32x32x16_bf16 v[112:127], a[40:43], v[244:247], v[112:127]
    v_exp_f32 v171, v171
    v_cvt_pk_bf16_f32 v228, v168, v169
    v_exp_f32 v172, v172
    v_exp_f32 v173, v173
    v_cvt_pk_bf16_f32 v229, v170, v171
    v_exp_f32 v174, v174
    v_exp_f32 v175, v175
    v_mfma_f32_32x32x16_bf16 v[192:207], a[28:31], a[84:87], v[192:207]
    v_cvt_pk_bf16_f32 v230, v172, v173
    v_exp_f32 v176, v176
    v_exp_f32 v177, v177
    v_cvt_pk_bf16_f32 v231, v174, v175
    v_exp_f32 v178, v178
    v_exp_f32 v179, v179
    v_cvt_pk_bf16_f32 v232, v176, v177
    v_mfma_f32_32x32x16_bf16 v[208:223], a[32:35], a[84:87], v[208:223]
    v_exp_f32 v180, v180
    v_exp_f32 v181, v181
    v_cvt_pk_bf16_f32 v233, v178, v179
    v_exp_f32 v182, v182
    v_exp_f32 v183, v183
    v_cvt_pk_bf16_f32 v234, v180, v181
    v_mfma_f32_32x32x16_bf16 v[112:127], a[44:47], v[248:251], v[112:127]
    v_exp_f32 v184, v184
    v_exp_f32 v185, v185
    v_cvt_pk_bf16_f32 v235, v182, v183
    v_exp_f32 v186, v186
    v_exp_f32 v187, v187
    v_cvt_pk_bf16_f32 v236, v184, v185
    v_exp_f32 v188, v188
    v_mfma_f32_32x32x16_bf16 v[112:127], a[48:51], v[252:255], v[112:127]
    v_exp_f32 v189, v189
    v_cvt_pk_bf16_f32 v237, v186, v187
    v_exp_f32 v190, v190
    v_exp_f32 v191, v191
    v_cvt_pk_bf16_f32 v238, v188, v189
    v_cvt_pk_bf16_f32 v239, v190, v191
    s_waitcnt vmcnt(4)
    v_mfma_f32_32x32x4_2b_bf16 v[160:191], a[24:25], a[88:89], 0
    s_add_u32 s16, s16, 2048
    s_add_u32 s17, s17, 256
    v_exp_f32 v192, v192
    v_exp_f32 v193, v193
    v_exp_f32 v194, v194
    v_exp_f32 v195, v195
    v_cvt_pk_bf16_f32 v240, v192, v193
    v_exp_f32 v196, v196
    v_exp_f32 v197, v197
    v_cvt_pk_bf16_f32 v241, v194, v195
    v_exp_f32 v198, v198
    v_mfma_f32_32x32x16_bf16 v[128:143], a[36:39], v[224:227], v[128:143]
    v_exp_f32 v199, v199
    v_cvt_pk_bf16_f32 v242, v196, v197
    v_exp_f32 v200, v200
    v_exp_f32 v201, v201
    v_cvt_pk_bf16_f32 v243, v198, v199
    v_exp_f32 v202, v202
    v_exp_f32 v203, v203
    v_mfma_f32_32x32x16_bf16 v[128:143], a[40:43], v[228:231], v[128:143]
    v_cvt_pk_bf16_f32 v244, v200, v201
    v_exp_f32 v204, v204
    v_exp_f32 v205, v205
    v_cvt_pk_bf16_f32 v245, v202, v203
    v_exp_f32 v206, v206
    v_exp_f32 v207, v207
    v_cvt_pk_bf16_f32 v246, v204, v205
    v_mfma_f32_32x32x16_bf16 v[160:175], a[0:3], a[56:59], v[160:175]
    s_add_u32 s18, s18, 2432
    v_exp_f32 v208, v208
    v_exp_f32 v209, v209
    v_cvt_pk_bf16_f32 v247, v206, v207
    v_exp_f32 v210, v210
    v_exp_f32 v211, v211
    v_cvt_pk_bf16_f32 v248, v208, v209
    v_exp_f32 v212, v212
    v_mfma_f32_32x32x16_bf16 v[176:191], a[4:7], a[56:59], v[176:191]
    v_exp_f32 v213, v213
    v_cvt_pk_bf16_f32 v249, v210, v211
    v_exp_f32 v214, v214
    v_exp_f32 v215, v215
    v_cvt_pk_bf16_f32 v250, v212, v213
    v_exp_f32 v216, v216
    v_mfma_f32_32x32x16_bf16 v[128:143], a[44:47], v[232:235], v[128:143]
    v_exp_f32 v217, v217
    v_cvt_pk_bf16_f32 v251, v214, v215
    v_exp_f32 v218, v218
    v_exp_f32 v219, v219
    v_cvt_pk_bf16_f32 v252, v216, v217
    v_exp_f32 v220, v220
    v_mfma_f32_32x32x16_bf16 v[128:143], a[48:51], v[236:239], v[128:143]
    v_exp_f32 v221, v221
    v_cvt_pk_bf16_f32 v253, v218, v219
    v_exp_f32 v222, v222
    v_exp_f32 v223, v223
    v_cvt_pk_bf16_f32 v254, v220, v221
    v_cvt_pk_bf16_f32 v255, v222, v223
    s_sub_u32 s22, s22, 1
    s_cmp_lg_u32 s22, 0
    s_cbranch_scc1 L3_attn_loop
    s_nop 1
    v_mfma_f32_32x32x16_bf16 v[144:159], a[36:39], v[240:243], v[144:159]
    v_mfma_f32_32x32x16_bf16 v[144:159], a[40:43], v[244:247], v[144:159]
    v_mfma_f32_32x32x16_bf16 v[144:159], a[44:47], v[248:251], v[144:159]
    v_mfma_f32_32x32x16_bf16 v[144:159], a[48:51], v[252:255], v[144:159]
    s_nop 15
    s_mul_i32 s23, s8, 12288
    v_add_u32 v4, s23, v1
    ds_write_b128 v4, v[96:99] offset:0
    ds_write_b128 v4, v[100:103] offset:1024
    ds_write_b128 v4, v[104:107] offset:2048
    ds_write_b128 v4, v[112:115] offset:3072
    ds_write_b128 v4, v[116:119] offset:4096
    ds_write_b128 v4, v[120:123] offset:5120
    ds_write_b128 v4, v[128:131] offset:6144
    ds_write_b128 v4, v[132:135] offset:7168
    ds_write_b128 v4, v[136:139] offset:8192
    ds_write_b128 v4, v[144:147] offset:9216
    ds_write_b128 v4, v[148:151] offset:10240
    ds_write_b128 v4, v[152:155] offset:11264
    s_xor_b32 s23, s8, 2
    s_mul_i32 s23, s23, 12288
    v_add_u32 v4, s23, v1
    s_waitcnt lgkmcnt(0)
    s_barrier
    ds_read_b128 v[160:163], v4 offset:0
    ds_read_b128 v[164:167], v4 offset:1024
    ds_read_b128 v[168:171], v4 offset:2048
    ds_read_b128 v[172:175], v4 offset:3072
    ds_read_b128 v[176:179], v4 offset:4096
    ds_read_b128 v[180:183], v4 offset:5120
    ds_read_b128 v[184:187], v4 offset:6144
    ds_read_b128 v[188:191], v4 offset:7168
    ds_read_b128 v[192:195], v4 offset:8192
    ds_read_b128 v[196:199], v4 offset:9216
    ds_read_b128 v[200:203], v4 offset:10240
    ds_read_b128 v[204:207], v4 offset:11264
    s_waitcnt lgkmcnt(0)
    v_add_f32 v32, v32, v160
    v_add_f32 v33, v33, v161
    v_add_f32 v34, v34, v162
    v_add_f32 v35, v35, v163
    v_add_f32 v36, v36, v164
    v_add_f32 v37, v37, v165
    v_add_f32 v38, v38, v166
    v_add_f32 v39, v39, v167
    v_add_f32 v40, v40, v168
    v_add_f32 v41, v41, v169
    v_add_f32 v42, v42, v170
    v_add_f32 v48, v48, v172
    v_add_f32 v49, v49, v173
    v_add_f32 v50, v50, v174
    v_add_f32 v51, v51, v175
    v_add_f32 v52, v52, v176
    v_add_f32 v53, v53, v177
    v_add_f32 v54, v54, v178
    v_add_f32 v55, v55, v179
    v_add_f32 v56, v56, v180
    v_add_f32 v57, v57, v181
    v_add_f32 v58, v58, v182
    v_add_f32 v64, v64, v184
    v_add_f32 v65, v65, v185
    v_add_f32 v66, v66, v186
    v_add_f32 v67, v67, v187
    v_add_f32 v68, v68, v188
    v_add_f32 v69, v69, v189
    v_add_f32 v70, v70, v190
    v_add_f32 v71, v71, v191
    v_add_f32 v72, v72, v192
    v_add_f32 v73, v73, v193
    v_add_f32 v74, v74, v194
    v_add_f32 v80, v80, v196
    v_add_f32 v81, v81, v197
    v_add_f32 v82, v82, v198
    v_add_f32 v83, v83, v199
    v_add_f32 v84, v84, v200
    v_add_f32 v85, v85, v201
    v_add_f32 v86, v86, v202
    v_add_f32 v87, v87, v203
    v_add_f32 v88, v88, v204
    v_add_f32 v89, v89, v205
    v_add_f32 v90, v90, v206
L3_attn_fin:
    s_mul_i32 s23, s34, 36864
    s_add_u32 s23, s23, 18374656
    s_lshl_b32 s24, s9, 10
    s_add_u32 s24, s24, s23
    s_lshr_b32 s25, s9, 3
    s_add_u32 s25, s25, 32
    s_lshl_b32 s25, s25, 10
    s_add_u32 s25, s25, s23
    s_lshr_b32 s29, s9, 2
    s_and_b32 s29, s29, 1
    s_lshl_b32 s29, s29, 9
    s_add_u32 s25, s25, s29
    s_and_b32 s29, s9, 3
    s_lshl_b32 s29, s29, 2
    s_add_u32 s25, s25, s29
    s_mov_b64 s[32:33], -1
    v_mov_b32 v4, v42
    v_mov_b32 v5, v42
    s_nop 1
    v_permlane32_swap_b32 v4, v5
    v_cmp_le_f32 vcc, 0x21800000, v4
    s_and_b64 s[32:33], s[32:33], vcc
    v_cmp_ge_f32 vcc, 0x71800000, v4
    s_and_b64 s[32:33], s[32:33], vcc
    v_rcp_f32 v5, v4
    v_mov_b32 v6, 0
    v_mul_f32 v32, v32, v5
    v_mul_f32 v33, v33, v5
    v_mul_f32 v34, v34, v5
    v_mul_f32 v35, v35, v5
    v_mul_f32 v36, v36, v5
    v_mul_f32 v37, v37, v5
    v_mul_f32 v38, v38, v5
    v_mul_f32 v39, v39, v5
    v_mul_f32 v40, v40, v5
    v_mul_f32 v41, v41, v5
    v_fmac_f32 v6, 0, v32
    v_fmac_f32 v6, 0, v33
    v_fmac_f32 v6, 0, v34
    v_fmac_f32 v6, 0, v35
    v_fmac_f32 v6, 0, v36
    v_fmac_f32 v6, 0, v37
    v_fmac_f32 v6, 0, v38
    v_fmac_f32 v6, 0, v39
    v_fmac_f32 v6, 0, v40
    v_fmac_f32 v6, 0, v41
    v_cmp_o_f32 vcc, v6, v6
    s_and_b64 s[32:33], s[32:33], vcc
    v_mov_b32 v4, v58
    v_mov_b32 v5, v58
    s_nop 1
    v_permlane32_swap_b32 v4, v5
    v_cmp_le_f32 vcc, 0x21800000, v4
    s_and_b64 s[32:33], s[32:33], vcc
    v_cmp_ge_f32 vcc, 0x71800000, v4
    s_and_b64 s[32:33], s[32:33], vcc
    v_rcp_f32 v5, v4
    v_mov_b32 v6, 0
    v_mul_f32 v48, v48, v5
    v_mul_f32 v49, v49, v5
    v_mul_f32 v50, v50, v5
    v_mul_f32 v51, v51, v5
    v_mul_f32 v52, v52, v5
    v_mul_f32 v53, v53, v5
    v_mul_f32 v54, v54, v5
    v_mul_f32 v55, v55, v5
    v_mul_f32 v56, v56, v5
    v_mul_f32 v57, v57, v5
    v_fmac_f32 v6, 0, v48
    v_fmac_f32 v6, 0, v49
    v_fmac_f32 v6, 0, v50
    v_fmac_f32 v6, 0, v51
    v_fmac_f32 v6, 0, v52
    v_fmac_f32 v6, 0, v53
    v_fmac_f32 v6, 0, v54
    v_fmac_f32 v6, 0, v55
    v_fmac_f32 v6, 0, v56
    v_fmac_f32 v6, 0, v57
    v_cmp_o_f32 vcc, v6, v6
    s_and_b64 s[32:33], s[32:33], vcc
    v_mov_b32 v4, v74
    v_mov_b32 v5, v74
    s_nop 1
    v_permlane32_swap_b32 v4, v5
    v_cmp_le_f32 vcc, 0x21800000, v4
    s_and_b64 s[32:33], s[32:33], vcc
    v_cmp_ge_f32 vcc, 0x71800000, v4
    s_and_b64 s[32:33], s[32:33], vcc
    v_rcp_f32 v5, v4
    v_mov_b32 v6, 0
    v_mul_f32 v64, v64, v5
    v_mul_f32 v65, v65, v5
    v_mul_f32 v66, v66, v5
    v_mul_f32 v67, v67, v5
    v_mul_f32 v68, v68, v5
    v_mul_f32 v69, v69, v5
    v_mul_f32 v70, v70, v5
    v_mul_f32 v71, v71, v5
    v_mul_f32 v72, v72, v5
    v_mul_f32 v73, v73, v5
    v_fmac_f32 v6, 0, v64
    v_fmac_f32 v6, 0, v65
    v_fmac_f32 v6, 0, v66
    v_fmac_f32 v6, 0, v67
    v_fmac_f32 v6, 0, v68
    v_fmac_f32 v6, 0, v69
    v_fmac_f32 v6, 0, v70
    v_fmac_f32 v6, 0, v71
    v_fmac_f32 v6, 0, v72
    v_fmac_f32 v6, 0, v73
    v_cmp_o_f32 vcc, v6, v6
    s_and_b64 s[32:33], s[32:33], vcc
    v_mov_b32 v4, v90
    v_mov_b32 v5, v90
    s_nop 1
    v_permlane32_swap_b32 v4, v5
    v_cmp_le_f32 vcc, 0x21800000, v4
    s_and_b64 s[32:33], s[32:33], vcc
    v_cmp_ge_f32 vcc, 0x71800000, v4
    s_and_b64 s[32:33], s[32:33], vcc
    v_rcp_f32 v5, v4
    v_mov_b32 v6, 0
    v_mul_f32 v80, v80, v5
    v_mul_f32 v81, v81, v5
    v_mul_f32 v82, v82, v5
    v_mul_f32 v83, v83, v5
    v_mul_f32 v84, v84, v5
    v_mul_f32 v85, v85, v5
    v_mul_f32 v86, v86, v5
    v_mul_f32 v87, v87, v5
    v_mul_f32 v88, v88, v5
    v_mul_f32 v89, v89, v5
    v_fmac_f32 v6, 0, v80
    v_fmac_f32 v6, 0, v81
    v_fmac_f32 v6, 0, v82
    v_fmac_f32 v6, 0, v83
    v_fmac_f32 v6, 0, v84
    v_fmac_f32 v6, 0, v85
    v_fmac_f32 v6, 0, v86
    v_fmac_f32 v6, 0, v87
    v_fmac_f32 v6, 0, v88
    v_fmac_f32 v6, 0, v89
    v_cmp_o_f32 vcc, v6, v6
    s_and_b64 s[32:33], s[32:33], vcc
    s_cmp_eq_u32 s30, 0
    s_cbranch_scc0 L3_attn_store
    s_cmp_eq_u64 s[32:33], exec
    s_cbranch_scc0 L3_attn_slow
L3_attn_store:
    v_and_b32 v4, 31, v0
    v_lshlrev_b32 v4, 4, v4
    v_cvt_pk_bf16_f32 v224, v32, v33
    v_cvt_pk_bf16_f32 v225, v34, v35
    v_cvt_pk_bf16_f32 v226, v36, v37
    v_cvt_pk_bf16_f32 v227, v38, v39
    v_cvt_pk_bf16_f32 v228, v40, v41
    buffer_store_dwordx4 v[224:227], v1, s[12:15], s24 offen sc1
    s_mov_b64 exec, 0xffffffff
    buffer_store_dword v228, v4, s[12:15], s25 offen sc1
    s_mov_b64 exec, -1
    s_add_u32 s24, s24, 36864
    s_add_u32 s25, s25, 36864
    v_cvt_pk_bf16_f32 v232, v48, v49
    v_cvt_pk_bf16_f32 v233, v50, v51
    v_cvt_pk_bf16_f32 v234, v52, v53
    v_cvt_pk_bf16_f32 v235, v54, v55
    v_cvt_pk_bf16_f32 v236, v56, v57
    buffer_store_dwordx4 v[232:235], v1, s[12:15], s24 offen sc1
    s_mov_b64 exec, 0xffffffff
    buffer_store_dword v236, v4, s[12:15], s25 offen sc1
    s_mov_b64 exec, -1
    s_add_u32 s24, s24, 36864
    s_add_u32 s25, s25, 36864
    v_cvt_pk_bf16_f32 v240, v64, v65
    v_cvt_pk_bf16_f32 v241, v66, v67
    v_cvt_pk_bf16_f32 v242, v68, v69
    v_cvt_pk_bf16_f32 v243, v70, v71
    v_cvt_pk_bf16_f32 v244, v72, v73
    buffer_store_dwordx4 v[240:243], v1, s[12:15], s24 offen sc1
    s_mov_b64 exec, 0xffffffff
    buffer_store_dword v244, v4, s[12:15], s25 offen sc1
    s_mov_b64 exec, -1
    s_add_u32 s24, s24, 36864
    s_add_u32 s25, s25, 36864
    v_cvt_pk_bf16_f32 v248, v80, v81
    v_cvt_pk_bf16_f32 v249, v82, v83
    v_cvt_pk_bf16_f32 v250, v84, v85
    v_cvt_pk_bf16_f32 v251, v86, v87
    v_cvt_pk_bf16_f32 v252, v88, v89
    buffer_store_dwordx4 v[248:251], v1, s[12:15], s24 offen sc1
    s_mov_b64 exec, 0xffffffff
    buffer_store_dword v252, v4, s[12:15], s25 offen sc1
    s_mov_b64 exec, -1
    s_add_u32 s34, s4, 39608320
    s_addc_u32 s35, s5, 0
    s_lshr_b32 s48, s2, 3
    s_and_b32 s48, s48, 3
    s_mul_i32 s48, s48, 128
    s_add_u32 s48, s48, 5248
    s_waitcnt vmcnt(0)
    s_barrier
    s_cmp_eq_u32 s8, 0
    s_cbranch_scc0 Lpub_8059
    s_mov_b64 exec, 1
    v_mov_b32 v250, s48
    v_mov_b32 v251, 1
    global_atomic_add v250, v251, s[34:35] sc1
    s_mov_b64 exec, -1
Lpub_8059:
    s_mov_b32 s66, 0
    s_branch K2_final
L3_attn_slow:
    s_mov_b32 s30, 1
    s_mov_b32 s16, s26
    s_mov_b32 s17, s27
    s_mov_b32 s18, s28
    v_mov_b32 v32, 0
    v_mov_b32 v33, 0
    v_mov_b32 v34, 0
    v_mov_b32 v35, 0
    v_mov_b32 v36, 0
    v_mov_b32 v37, 0
    v_mov_b32 v38, 0
    v_mov_b32 v39, 0
    v_mov_b32 v40, 0
    v_mov_b32 v41, 0
    v_mov_b32 v42, 0
    v_mov_b32 v43, 0
    v_mov_b32 v44, 0
    v_mov_b32 v45, 0
    v_mov_b32 v46, 0
    v_mov_b32 v47, 0
    v_mov_b32 v48, 0
    v_mov_b32 v49, 0
    v_mov_b32 v50, 0
    v_mov_b32 v51, 0
    v_mov_b32 v52, 0
    v_mov_b32 v53, 0
    v_mov_b32 v54, 0
    v_mov_b32 v55, 0
    v_mov_b32 v56, 0
    v_mov_b32 v57, 0
    v_mov_b32 v58, 0
    v_mov_b32 v59, 0
    v_mov_b32 v60, 0
    v_mov_b32 v61, 0
    v_mov_b32 v62, 0
    v_mov_b32 v63, 0
    v_mov_b32 v64, 0
    v_mov_b32 v65, 0
    v_mov_b32 v66, 0
    v_mov_b32 v67, 0
    v_mov_b32 v68, 0
    v_mov_b32 v69, 0
    v_mov_b32 v70, 0
    v_mov_b32 v71, 0
    v_mov_b32 v72, 0
    v_mov_b32 v73, 0
    v_mov_b32 v74, 0
    v_mov_b32 v75, 0
    v_mov_b32 v76, 0
    v_mov_b32 v77, 0
    v_mov_b32 v78, 0
    v_mov_b32 v79, 0
    v_mov_b32 v80, 0
    v_mov_b32 v81, 0
    v_mov_b32 v82, 0
    v_mov_b32 v83, 0
    v_mov_b32 v84, 0
    v_mov_b32 v85, 0
    v_mov_b32 v86, 0
    v_mov_b32 v87, 0
    v_mov_b32 v88, 0
    v_mov_b32 v89, 0
    v_mov_b32 v90, 0
    v_mov_b32 v91, 0
    v_mov_b32 v92, 0
    v_mov_b32 v93, 0
    v_mov_b32 v94, 0
    v_mov_b32 v95, 0
    v_mov_b32 v8, 0xff800000
    v_mov_b32 v9, 0xff800000
    v_mov_b32 v10, 0xff800000
    v_mov_b32 v11, 0xff800000
    s_mov_b32 s22, 32
L3_attn_slow_loop:
    s_waitcnt vmcnt(0)
    buffer_load_dwordx4 a[0:3], v1, s[12:15], s16 offen sc1
    buffer_load_dwordx4 a[4:7], v1, s[12:15], s16 offen offset:1024 sc1
    buffer_load_dword a24, v2, s[12:15], s17 offen sc1
    buffer_load_dwordx4 a[8:11], v3, s[12:15], s18 offen sc1
    buffer_load_dwordx4 a[12:15], v3, s[12:15], s18 offen offset:608 sc1
    buffer_load_dwordx4 a[16:19], v3, s[12:15], s18 offen offset:1216 sc1
    buffer_load_dwordx4 a[20:23], v3, s[12:15], s18 offen offset:1824 sc1
    s_add_u32 s16, s16, 2048
    s_add_u32 s17, s17, 256
    s_add_u32 s18, s18, 2432
    s_waitcnt vmcnt(0)
    v_mfma_f32_32x32x4_2b_bf16 v[160:191], a[24:25], a[88:89], 0
    s_nop 15
    s_nop 1
    v_mfma_f32_32x32x16_bf16 v[160:175], a[0:3], a[56:59], v[160:175]
    v_mfma_f32_32x32x16_bf16 v[176:191], a[4:7], a[56:59], v[176:191]
    s_nop 11
    v_max3_f32 v4, v160, v161, v162
    v_max3_f32 v4, v4, v163, v164
    v_max3_f32 v4, v4, v165, v166
    v_max3_f32 v4, v4, v167, v168
    v_max3_f32 v4, v4, v169, v170
    v_max3_f32 v4, v4, v171, v172
    v_max3_f32 v4, v4, v173, v174
    v_max3_f32 v4, v4, v175, v176
    v_max3_f32 v4, v4, v177, v178
    v_max3_f32 v4, v4, v179, v180
    v_max3_f32 v4, v4, v181, v182
    v_max3_f32 v4, v4, v183, v184
    v_max3_f32 v4, v4, v185, v186
    v_max3_f32 v4, v4, v187, v188
    v_max3_f32 v4, v4, v189, v190
    v_max_f32 v4, v4, v191
    v_mov_b32 v5, v4
    s_nop 1
    v_permlane32_swap_b32 v4, v5
    v_max_f32 v4, v4, v5
    v_max_f32 v4, v4, v8
    v_sub_f32 v5, v8, v4
    v_exp_f32 v5, v5
    v_mov_b32 v8, v4
    v_sub_f32 v160, v160, v4
    v_sub_f32 v161, v161, v4
    v_sub_f32 v162, v162, v4
    v_sub_f32 v163, v163, v4
    v_sub_f32 v164, v164, v4
    v_sub_f32 v165, v165, v4
    v_sub_f32 v166, v166, v4
    v_sub_f32 v167, v167, v4
    v_sub_f32 v168, v168, v4
    v_sub_f32 v169, v169, v4
    v_sub_f32 v170, v170, v4
    v_sub_f32 v171, v171, v4
    v_sub_f32 v172, v172, v4
    v_sub_f32 v173, v173, v4
    v_sub_f32 v174, v174, v4
    v_sub_f32 v175, v175, v4
    v_sub_f32 v176, v176, v4
    v_sub_f32 v177, v177, v4
    v_sub_f32 v178, v178, v4
    v_sub_f32 v179, v179, v4
    v_sub_f32 v180, v180, v4
    v_sub_f32 v181, v181, v4
    v_sub_f32 v182, v182, v4
    v_sub_f32 v183, v183, v4
    v_sub_f32 v184, v184, v4
    v_sub_f32 v185, v185, v4
    v_sub_f32 v186, v186, v4
    v_sub_f32 v187, v187, v4
    v_sub_f32 v188, v188, v4
    v_sub_f32 v189, v189, v4
    v_sub_f32 v190, v190, v4
    v_sub_f32 v191, v191, v4
    v_exp_f32 v160, v160
    v_exp_f32 v161, v161
    v_exp_f32 v162, v162
    v_exp_f32 v163, v163
    v_exp_f32 v164, v164
    v_exp_f32 v165, v165
    v_exp_f32 v166, v166
    v_exp_f32 v167, v167
    v_exp_f32 v168, v168
    v_exp_f32 v169, v169
    v_exp_f32 v170, v170
    v_exp_f32 v171, v171
    v_exp_f32 v172, v172
    v_exp_f32 v173, v173
    v_exp_f32 v174, v174
    v_exp_f32 v175, v175
    v_exp_f32 v176, v176
    v_exp_f32 v177, v177
    v_exp_f32 v178, v178
    v_exp_f32 v179, v179
    v_exp_f32 v180, v180
    v_exp_f32 v181, v181
    v_exp_f32 v182, v182
    v_exp_f32 v183, v183
    v_exp_f32 v184, v184
    v_exp_f32 v185, v185
    v_exp_f32 v186, v186
    v_exp_f32 v187, v187
    v_exp_f32 v188, v188
    v_exp_f32 v189, v189
    v_exp_f32 v190, v190
    v_exp_f32 v191, v191
    v_mul_f32 v32, v32, v5
    v_mul_f32 v33, v33, v5
    v_mul_f32 v34, v34, v5
    v_mul_f32 v35, v35, v5
    v_mul_f32 v36, v36, v5
    v_mul_f32 v37, v37, v5
    v_mul_f32 v38, v38, v5
    v_mul_f32 v39, v39, v5
    v_mul_f32 v40, v40, v5
    v_mul_f32 v41, v41, v5
    v_mul_f32 v42, v42, v5
    v_mul_f32 v43, v43, v5
    v_mul_f32 v44, v44, v5
    v_mul_f32 v45, v45, v5
    v_mul_f32 v46, v46, v5
    v_mul_f32 v47, v47, v5
    v_cvt_pk_bf16_f32 v224, v160, v161
    v_cvt_pk_bf16_f32 v225, v162, v163
    v_cvt_pk_bf16_f32 v226, v164, v165
    v_cvt_pk_bf16_f32 v227, v166, v167
    v_cvt_pk_bf16_f32 v228, v168, v169
    v_cvt_pk_bf16_f32 v229, v170, v171
    v_cvt_pk_bf16_f32 v230, v172, v173
    v_cvt_pk_bf16_f32 v231, v174, v175
    v_cvt_pk_bf16_f32 v232, v176, v177
    v_cvt_pk_bf16_f32 v233, v178, v179
    v_cvt_pk_bf16_f32 v234, v180, v181
    v_cvt_pk_bf16_f32 v235, v182, v183
    v_cvt_pk_bf16_f32 v236, v184, v185
    v_cvt_pk_bf16_f32 v237, v186, v187
    v_cvt_pk_bf16_f32 v238, v188, v189
    v_cvt_pk_bf16_f32 v239, v190, v191
    s_nop 1
    v_mfma_f32_32x32x16_bf16 v[32:47], a[8:11], v[224:227], v[32:47]
    v_mfma_f32_32x32x16_bf16 v[32:47], a[12:15], v[228:231], v[32:47]
    v_mfma_f32_32x32x16_bf16 v[32:47], a[16:19], v[232:235], v[32:47]
    v_mfma_f32_32x32x16_bf16 v[32:47], a[20:23], v[236:239], v[32:47]
    s_nop 11
    v_mfma_f32_32x32x4_2b_bf16 v[160:191], a[24:25], a[90:91], 0
    s_nop 15
    s_nop 1
    v_mfma_f32_32x32x16_bf16 v[160:175], a[0:3], a[60:63], v[160:175]
    v_mfma_f32_32x32x16_bf16 v[176:191], a[4:7], a[60:63], v[176:191]
    s_nop 11
    v_max3_f32 v4, v160, v161, v162
    v_max3_f32 v4, v4, v163, v164
    v_max3_f32 v4, v4, v165, v166
    v_max3_f32 v4, v4, v167, v168
    v_max3_f32 v4, v4, v169, v170
    v_max3_f32 v4, v4, v171, v172
    v_max3_f32 v4, v4, v173, v174
    v_max3_f32 v4, v4, v175, v176
    v_max3_f32 v4, v4, v177, v178
    v_max3_f32 v4, v4, v179, v180
    v_max3_f32 v4, v4, v181, v182
    v_max3_f32 v4, v4, v183, v184
    v_max3_f32 v4, v4, v185, v186
    v_max3_f32 v4, v4, v187, v188
    v_max3_f32 v4, v4, v189, v190
    v_max_f32 v4, v4, v191
    v_mov_b32 v5, v4
    s_nop 1
    v_permlane32_swap_b32 v4, v5
    v_max_f32 v4, v4, v5
    v_max_f32 v4, v4, v9
    v_sub_f32 v5, v9, v4
    v_exp_f32 v5, v5
    v_mov_b32 v9, v4
    v_sub_f32 v160, v160, v4
    v_sub_f32 v161, v161, v4
    v_sub_f32 v162, v162, v4
    v_sub_f32 v163, v163, v4
    v_sub_f32 v164, v164, v4
    v_sub_f32 v165, v165, v4
    v_sub_f32 v166, v166, v4
    v_sub_f32 v167, v167, v4
    v_sub_f32 v168, v168, v4
    v_sub_f32 v169, v169, v4
    v_sub_f32 v170, v170, v4
    v_sub_f32 v171, v171, v4
    v_sub_f32 v172, v172, v4
    v_sub_f32 v173, v173, v4
    v_sub_f32 v174, v174, v4
    v_sub_f32 v175, v175, v4
    v_sub_f32 v176, v176, v4
    v_sub_f32 v177, v177, v4
    v_sub_f32 v178, v178, v4
    v_sub_f32 v179, v179, v4
    v_sub_f32 v180, v180, v4
    v_sub_f32 v181, v181, v4
    v_sub_f32 v182, v182, v4
    v_sub_f32 v183, v183, v4
    v_sub_f32 v184, v184, v4
    v_sub_f32 v185, v185, v4
    v_sub_f32 v186, v186, v4
    v_sub_f32 v187, v187, v4
    v_sub_f32 v188, v188, v4
    v_sub_f32 v189, v189, v4
    v_sub_f32 v190, v190, v4
    v_sub_f32 v191, v191, v4
    v_exp_f32 v160, v160
    v_exp_f32 v161, v161
    v_exp_f32 v162, v162
    v_exp_f32 v163, v163
    v_exp_f32 v164, v164
    v_exp_f32 v165, v165
    v_exp_f32 v166, v166
    v_exp_f32 v167, v167
    v_exp_f32 v168, v168
    v_exp_f32 v169, v169
    v_exp_f32 v170, v170
    v_exp_f32 v171, v171
    v_exp_f32 v172, v172
    v_exp_f32 v173, v173
    v_exp_f32 v174, v174
    v_exp_f32 v175, v175
    v_exp_f32 v176, v176
    v_exp_f32 v177, v177
    v_exp_f32 v178, v178
    v_exp_f32 v179, v179
    v_exp_f32 v180, v180
    v_exp_f32 v181, v181
    v_exp_f32 v182, v182
    v_exp_f32 v183, v183
    v_exp_f32 v184, v184
    v_exp_f32 v185, v185
    v_exp_f32 v186, v186
    v_exp_f32 v187, v187
    v_exp_f32 v188, v188
    v_exp_f32 v189, v189
    v_exp_f32 v190, v190
    v_exp_f32 v191, v191
    v_mul_f32 v48, v48, v5
    v_mul_f32 v49, v49, v5
    v_mul_f32 v50, v50, v5
    v_mul_f32 v51, v51, v5
    v_mul_f32 v52, v52, v5
    v_mul_f32 v53, v53, v5
    v_mul_f32 v54, v54, v5
    v_mul_f32 v55, v55, v5
    v_mul_f32 v56, v56, v5
    v_mul_f32 v57, v57, v5
    v_mul_f32 v58, v58, v5
    v_mul_f32 v59, v59, v5
    v_mul_f32 v60, v60, v5
    v_mul_f32 v61, v61, v5
    v_mul_f32 v62, v62, v5
    v_mul_f32 v63, v63, v5
    v_cvt_pk_bf16_f32 v224, v160, v161
    v_cvt_pk_bf16_f32 v225, v162, v163
    v_cvt_pk_bf16_f32 v226, v164, v165
    v_cvt_pk_bf16_f32 v227, v166, v167
    v_cvt_pk_bf16_f32 v228, v168, v169
    v_cvt_pk_bf16_f32 v229, v170, v171
    v_cvt_pk_bf16_f32 v230, v172, v173
    v_cvt_pk_bf16_f32 v231, v174, v175
    v_cvt_pk_bf16_f32 v232, v176, v177
    v_cvt_pk_bf16_f32 v233, v178, v179
    v_cvt_pk_bf16_f32 v234, v180, v181
    v_cvt_pk_bf16_f32 v235, v182, v183
    v_cvt_pk_bf16_f32 v236, v184, v185
    v_cvt_pk_bf16_f32 v237, v186, v187
    v_cvt_pk_bf16_f32 v238, v188, v189
    v_cvt_pk_bf16_f32 v239, v190, v191
    s_nop 1
    v_mfma_f32_32x32x16_bf16 v[48:63], a[8:11], v[224:227], v[48:63]
    v_mfma_f32_32x32x16_bf16 v[48:63], a[12:15], v[228:231], v[48:63]
    v_mfma_f32_32x32x16_bf16 v[48:63], a[16:19], v[232:235], v[48:63]
    v_mfma_f32_32x32x16_bf16 v[48:63], a[20:23], v[236:239], v[48:63]
    s_nop 11
    v_mfma_f32_32x32x4_2b_bf16 v[160:191], a[24:25], a[92:93], 0
    s_nop 15
    s_nop 1
    v_mfma_f32_32x32x16_bf16 v[160:175], a[0:3], a[64:67], v[160:175]
    v_mfma_f32_32x32x16_bf16 v[176:191], a[4:7], a[64:67], v[176:191]
    s_nop 11
    v_max3_f32 v4, v160, v161, v162
    v_max3_f32 v4, v4, v163, v164
    v_max3_f32 v4, v4, v165, v166
    v_max3_f32 v4, v4, v167, v168
    v_max3_f32 v4, v4, v169, v170
    v_max3_f32 v4, v4, v171, v172
    v_max3_f32 v4, v4, v173, v174
    v_max3_f32 v4, v4, v175, v176
    v_max3_f32 v4, v4, v177, v178
    v_max3_f32 v4, v4, v179, v180
    v_max3_f32 v4, v4, v181, v182
    v_max3_f32 v4, v4, v183, v184
    v_max3_f32 v4, v4, v185, v186
    v_max3_f32 v4, v4, v187, v188
    v_max3_f32 v4, v4, v189, v190
    v_max_f32 v4, v4, v191
    v_mov_b32 v5, v4
    s_nop 1
    v_permlane32_swap_b32 v4, v5
    v_max_f32 v4, v4, v5
    v_max_f32 v4, v4, v10
    v_sub_f32 v5, v10, v4
    v_exp_f32 v5, v5
    v_mov_b32 v10, v4
    v_sub_f32 v160, v160, v4
    v_sub_f32 v161, v161, v4
    v_sub_f32 v162, v162, v4
    v_sub_f32 v163, v163, v4
    v_sub_f32 v164, v164, v4
    v_sub_f32 v165, v165, v4
    v_sub_f32 v166, v166, v4
    v_sub_f32 v167, v167, v4
    v_sub_f32 v168, v168, v4
    v_sub_f32 v169, v169, v4
    v_sub_f32 v170, v170, v4
    v_sub_f32 v171, v171, v4
    v_sub_f32 v172, v172, v4
    v_sub_f32 v173, v173, v4
    v_sub_f32 v174, v174, v4
    v_sub_f32 v175, v175, v4
    v_sub_f32 v176, v176, v4
    v_sub_f32 v177, v177, v4
    v_sub_f32 v178, v178, v4
    v_sub_f32 v179, v179, v4
    v_sub_f32 v180, v180, v4
    v_sub_f32 v181, v181, v4
    v_sub_f32 v182, v182, v4
    v_sub_f32 v183, v183, v4
    v_sub_f32 v184, v184, v4
    v_sub_f32 v185, v185, v4
    v_sub_f32 v186, v186, v4
    v_sub_f32 v187, v187, v4
    v_sub_f32 v188, v188, v4
    v_sub_f32 v189, v189, v4
    v_sub_f32 v190, v190, v4
    v_sub_f32 v191, v191, v4
    v_exp_f32 v160, v160
    v_exp_f32 v161, v161
    v_exp_f32 v162, v162
    v_exp_f32 v163, v163
    v_exp_f32 v164, v164
    v_exp_f32 v165, v165
    v_exp_f32 v166, v166
    v_exp_f32 v167, v167
    v_exp_f32 v168, v168
    v_exp_f32 v169, v169
    v_exp_f32 v170, v170
    v_exp_f32 v171, v171
    v_exp_f32 v172, v172
    v_exp_f32 v173, v173
    v_exp_f32 v174, v174
    v_exp_f32 v175, v175
    v_exp_f32 v176, v176
    v_exp_f32 v177, v177
    v_exp_f32 v178, v178
    v_exp_f32 v179, v179
    v_exp_f32 v180, v180
    v_exp_f32 v181, v181
    v_exp_f32 v182, v182
    v_exp_f32 v183, v183
    v_exp_f32 v184, v184
    v_exp_f32 v185, v185
    v_exp_f32 v186, v186
    v_exp_f32 v187, v187
    v_exp_f32 v188, v188
    v_exp_f32 v189, v189
    v_exp_f32 v190, v190
    v_exp_f32 v191, v191
    v_mul_f32 v64, v64, v5
    v_mul_f32 v65, v65, v5
    v_mul_f32 v66, v66, v5
    v_mul_f32 v67, v67, v5
    v_mul_f32 v68, v68, v5
    v_mul_f32 v69, v69, v5
    v_mul_f32 v70, v70, v5
    v_mul_f32 v71, v71, v5
    v_mul_f32 v72, v72, v5
    v_mul_f32 v73, v73, v5
    v_mul_f32 v74, v74, v5
    v_mul_f32 v75, v75, v5
    v_mul_f32 v76, v76, v5
    v_mul_f32 v77, v77, v5
    v_mul_f32 v78, v78, v5
    v_mul_f32 v79, v79, v5
    v_cvt_pk_bf16_f32 v224, v160, v161
    v_cvt_pk_bf16_f32 v225, v162, v163
    v_cvt_pk_bf16_f32 v226, v164, v165
    v_cvt_pk_bf16_f32 v227, v166, v167
    v_cvt_pk_bf16_f32 v228, v168, v169
    v_cvt_pk_bf16_f32 v229, v170, v171
    v_cvt_pk_bf16_f32 v230, v172, v173
    v_cvt_pk_bf16_f32 v231, v174, v175
    v_cvt_pk_bf16_f32 v232, v176, v177
    v_cvt_pk_bf16_f32 v233, v178, v179
    v_cvt_pk_bf16_f32 v234, v180, v181
    v_cvt_pk_bf16_f32 v235, v182, v183
    v_cvt_pk_bf16_f32 v236, v184, v185
    v_cvt_pk_bf16_f32 v237, v186, v187
    v_cvt_pk_bf16_f32 v238, v188, v189
    v_cvt_pk_bf16_f32 v239, v190, v191
    s_nop 1
    v_mfma_f32_32x32x16_bf16 v[64:79], a[8:11], v[224:227], v[64:79]
    v_mfma_f32_32x32x16_bf16 v[64:79], a[12:15], v[228:231], v[64:79]
    v_mfma_f32_32x32x16_bf16 v[64:79], a[16:19], v[232:235], v[64:79]
    v_mfma_f32_32x32x16_bf16 v[64:79], a[20:23], v[236:239], v[64:79]
    s_nop 11
    v_mfma_f32_32x32x4_2b_bf16 v[160:191], a[24:25], a[94:95], 0
    s_nop 15
    s_nop 1
    v_mfma_f32_32x32x16_bf16 v[160:175], a[0:3], a[68:71], v[160:175]
    v_mfma_f32_32x32x16_bf16 v[176:191], a[4:7], a[68:71], v[176:191]
    s_nop 11
    v_max3_f32 v4, v160, v161, v162
    v_max3_f32 v4, v4, v163, v164
    v_max3_f32 v4, v4, v165, v166
    v_max3_f32 v4, v4, v167, v168
    v_max3_f32 v4, v4, v169, v170
    v_max3_f32 v4, v4, v171, v172
    v_max3_f32 v4, v4, v173, v174
    v_max3_f32 v4, v4, v175, v176
    v_max3_f32 v4, v4, v177, v178
    v_max3_f32 v4, v4, v179, v180
    v_max3_f32 v4, v4, v181, v182
    v_max3_f32 v4, v4, v183, v184
    v_max3_f32 v4, v4, v185, v186
    v_max3_f32 v4, v4, v187, v188
    v_max3_f32 v4, v4, v189, v190
    v_max_f32 v4, v4, v191
    v_mov_b32 v5, v4
    s_nop 1
    v_permlane32_swap_b32 v4, v5
    v_max_f32 v4, v4, v5
    v_max_f32 v4, v4, v11
    v_sub_f32 v5, v11, v4
    v_exp_f32 v5, v5
    v_mov_b32 v11, v4
    v_sub_f32 v160, v160, v4
    v_sub_f32 v161, v161, v4
    v_sub_f32 v162, v162, v4
    v_sub_f32 v163, v163, v4
    v_sub_f32 v164, v164, v4
    v_sub_f32 v165, v165, v4
    v_sub_f32 v166, v166, v4
    v_sub_f32 v167, v167, v4
    v_sub_f32 v168, v168, v4
    v_sub_f32 v169, v169, v4
    v_sub_f32 v170, v170, v4
    v_sub_f32 v171, v171, v4
    v_sub_f32 v172, v172, v4
    v_sub_f32 v173, v173, v4
    v_sub_f32 v174, v174, v4
    v_sub_f32 v175, v175, v4
    v_sub_f32 v176, v176, v4
    v_sub_f32 v177, v177, v4
    v_sub_f32 v178, v178, v4
    v_sub_f32 v179, v179, v4
    v_sub_f32 v180, v180, v4
    v_sub_f32 v181, v181, v4
    v_sub_f32 v182, v182, v4
    v_sub_f32 v183, v183, v4
    v_sub_f32 v184, v184, v4
    v_sub_f32 v185, v185, v4
    v_sub_f32 v186, v186, v4
    v_sub_f32 v187, v187, v4
    v_sub_f32 v188, v188, v4
    v_sub_f32 v189, v189, v4
    v_sub_f32 v190, v190, v4
    v_sub_f32 v191, v191, v4
    v_exp_f32 v160, v160
    v_exp_f32 v161, v161
    v_exp_f32 v162, v162
    v_exp_f32 v163, v163
    v_exp_f32 v164, v164
    v_exp_f32 v165, v165
    v_exp_f32 v166, v166
    v_exp_f32 v167, v167
    v_exp_f32 v168, v168
    v_exp_f32 v169, v169
    v_exp_f32 v170, v170
    v_exp_f32 v171, v171
    v_exp_f32 v172, v172
    v_exp_f32 v173, v173
    v_exp_f32 v174, v174
    v_exp_f32 v175, v175
    v_exp_f32 v176, v176
    v_exp_f32 v177, v177
    v_exp_f32 v178, v178
    v_exp_f32 v179, v179
    v_exp_f32 v180, v180
    v_exp_f32 v181, v181
    v_exp_f32 v182, v182
    v_exp_f32 v183, v183
    v_exp_f32 v184, v184
    v_exp_f32 v185, v185
    v_exp_f32 v186, v186
    v_exp_f32 v187, v187
    v_exp_f32 v188, v188
    v_exp_f32 v189, v189
    v_exp_f32 v190, v190
    v_exp_f32 v191, v191
    v_mul_f32 v80, v80, v5
    v_mul_f32 v81, v81, v5
    v_mul_f32 v82, v82, v5
    v_mul_f32 v83, v83, v5
    v_mul_f32 v84, v84, v5
    v_mul_f32 v85, v85, v5
    v_mul_f32 v86, v86, v5
    v_mul_f32 v87, v87, v5
    v_mul_f32 v88, v88, v5
    v_mul_f32 v89, v89, v5
    v_mul_f32 v90, v90, v5
    v_mul_f32 v91, v91, v5
    v_mul_f32 v92, v92, v5
    v_mul_f32 v93, v93, v5
    v_mul_f32 v94, v94, v5
    v_mul_f32 v95, v95, v5
    v_cvt_pk_bf16_f32 v224, v160, v161
    v_cvt_pk_bf16_f32 v225, v162, v163
    v_cvt_pk_bf16_f32 v226, v164, v165
    v_cvt_pk_bf16_f32 v227, v166, v167
    v_cvt_pk_bf16_f32 v228, v168, v169
    v_cvt_pk_bf16_f32 v229, v170, v171
    v_cvt_pk_bf16_f32 v230, v172, v173
    v_cvt_pk_bf16_f32 v231, v174, v175
    v_cvt_pk_bf16_f32 v232, v176, v177
    v_cvt_pk_bf16_f32 v233, v178, v179
    v_cvt_pk_bf16_f32 v234, v180, v181
    v_cvt_pk_bf16_f32 v235, v182, v183
    v_cvt_pk_bf16_f32 v236, v184, v185
    v_cvt_pk_bf16_f32 v237, v186, v187
    v_cvt_pk_bf16_f32 v238, v188, v189
    v_cvt_pk_bf16_f32 v239, v190, v191
    s_nop 1
    v_mfma_f32_32x32x16_bf16 v[80:95], a[8:11], v[224:227], v[80:95]
    v_mfma_f32_32x32x16_bf16 v[80:95], a[12:15], v[228:231], v[80:95]
    v_mfma_f32_32x32x16_bf16 v[80:95], a[16:19], v[232:235], v[80:95]
    v_mfma_f32_32x32x16_bf16 v[80:95], a[20:23], v[236:239], v[80:95]
    s_nop 11
    s_sub_u32 s22, s22, 1
    s_cmp_lg_u32 s22, 0
    s_cbranch_scc1 L3_attn_slow_loop
    s_nop 7
    s_branch L3_attn_fin
K2_final:
    s_mov_b64 exec, -1
    s_load_dwordx2 s[6:7], s[0:1], 72
    s_add_u32 s34, s4, 39608320
    s_addc_u32 s35, s5, 0
    v_mbcnt_lo_u32_b32 v0, -1, 0
    v_mbcnt_hi_u32_b32 v0, -1, v0
    s_lshr_b32 s9, s2, 5
    s_lshl_b32 s9, s9, 3
    s_and_b32 s10, s2, 7
    s_add_u32 s9, s9, s10
    s_lshr_b32 s10, s2, 3
    s_and_b32 s10, s10, 3
    v_lshlrev_b32 v1, 4, v0
    s_waitcnt lgkmcnt(0)
    s_mov_b32 s16, s6
    s_and_b32 s17, s7, 0xffff
    s_mov_b32 s18, 2359296
    s_mov_b32 s19, 0x20000
    s_mul_i32 s21, s8, 9
    s_cmp_eq_u32 s66, 1
    s_cbranch_scc1 K2_f_havew
    s_movk_i32 s48, 3072
    s_cmp_eq_u32 s8, 0
    s_cbranch_scc0 Lwait_8712_done
    s_mov_b32 s50, 0x40000
    s_mov_b64 exec, 1
    v_mov_b32 v246, s48
Lwait_8712:
    global_load_dword v250, v246, s[34:35] sc1
    s_waitcnt vmcnt(0)
    s_mov_b32 s51, 1
    v_readfirstlane_b32 s52, v250
    s_cmp_ge_u32 s52, 12
    s_cselect_b32 s51, s51, 0
    s_cmp_eq_u32 s51, 1
    s_cbranch_scc1 Lwait_8712_ok
    s_sub_u32 s50, s50, 1
    s_cmp_lg_u32 s50, 0
    s_cbranch_scc1 Lwait_8712
Lwait_8712_ok:
    s_mov_b64 exec, -1
Lwait_8712_done:
    s_barrier
    s_mul_i32 s23, s10, 180
    s_add_u32 s23, s23, s21
    s_lshl_b32 s23, s23, 10
    s_add_u32 s23, s23, 17637376
    s_add_u32 s24, s23, 0
    s_add_u32 s25, s23, 36864
    s_add_u32 s26, s23, 73728
    s_add_u32 s27, s23, 110592
    s_add_u32 s28, s23, 147456
    buffer_load_dwordx4 a[0:3], v1, s[12:15], s24 offen offset:0 sc1
    buffer_load_dwordx4 a[36:39], v1, s[12:15], s25 offen offset:0 sc1
    buffer_load_dwordx4 a[72:75], v1, s[12:15], s26 offen offset:0 sc1
    buffer_load_dwordx4 a[108:111], v1, s[12:15], s27 offen offset:0 sc1
    buffer_load_dwordx4 a[144:147], v1, s[12:15], s28 offen offset:0 sc1
    buffer_load_dwordx4 a[4:7], v1, s[12:15], s24 offen offset:1024 sc1
    buffer_load_dwordx4 a[40:43], v1, s[12:15], s25 offen offset:1024 sc1
    buffer_load_dwordx4 a[76:79], v1, s[12:15], s26 offen offset:1024 sc1
    buffer_load_dwordx4 a[112:115], v1, s[12:15], s27 offen offset:1024 sc1
    buffer_load_dwordx4 a[148:151], v1, s[12:15], s28 offen offset:1024 sc1
    buffer_load_dwordx4 a[8:11], v1, s[12:15], s24 offen offset:2048 sc1
    buffer_load_dwordx4 a[44:47], v1, s[12:15], s25 offen offset:2048 sc1
    buffer_load_dwordx4 a[80:83], v1, s[12:15], s26 offen offset:2048 sc1
    buffer_load_dwordx4 a[116:119], v1, s[12:15], s27 offen offset:2048 sc1
    buffer_load_dwordx4 a[152:155], v1, s[12:15], s28 offen offset:2048 sc1
    buffer_load_dwordx4 a[12:15], v1, s[12:15], s24 offen offset:3072 sc1
    buffer_load_dwordx4 a[48:51], v1, s[12:15], s25 offen offset:3072 sc1
    buffer_load_dwordx4 a[84:87], v1, s[12:15], s26 offen offset:3072 sc1
    buffer_load_dwordx4 a[120:123], v1, s[12:15], s27 offen offset:3072 sc1
    buffer_load_dwordx4 a[156:159], v1, s[12:15], s28 offen offset:3072 sc1
    s_add_u32 s24, s24, 4096
    s_add_u32 s25, s25, 4096
    s_add_u32 s26, s26, 4096
    s_add_u32 s27, s27, 4096
    s_add_u32 s28, s28, 4096
    buffer_load_dwordx4 a[16:19], v1, s[12:15], s24 offen offset:0 sc1
    buffer_load_dwordx4 a[52:55], v1, s[12:15], s25 offen offset:0 sc1
    buffer_load_dwordx4 a[88:91], v1, s[12:15], s26 offen offset:0 sc1
    buffer_load_dwordx4 a[124:127], v1, s[12:15], s27 offen offset:0 sc1
    buffer_load_dwordx4 a[160:163], v1, s[12:15], s28 offen offset:0 sc1
    buffer_load_dwordx4 a[20:23], v1, s[12:15], s24 offen offset:1024 sc1
    buffer_load_dwordx4 a[56:59], v1, s[12:15], s25 offen offset:1024 sc1
    buffer_load_dwordx4 a[92:95], v1, s[12:15], s26 offen offset:1024 sc1
    buffer_load_dwordx4 a[128:131], v1, s[12:15], s27 offen offset:1024 sc1
    buffer_load_dwordx4 a[164:167], v1, s[12:15], s28 offen offset:1024 sc1
    buffer_load_dwordx4 a[24:27], v1, s[12:15], s24 offen offset:2048 sc1
    buffer_load_dwordx4 a[60:63], v1, s[12:15], s25 offen offset:2048 sc1
    buffer_load_dwordx4 a[96:99], v1, s[12:15], s26 offen offset:2048 sc1
    buffer_load_dwordx4 a[132:135], v1, s[12:15], s27 offen offset:2048 sc1
    buffer_load_dwordx4 a[168:171], v1, s[12:15], s28 offen offset:2048 sc1
    buffer_load_dwordx4 a[28:31], v1, s[12:15], s24 offen offset:3072 sc1
    buffer_load_dwordx4 a[64:67], v1, s[12:15], s25 offen offset:3072 sc1
    buffer_load_dwordx4 a[100:103], v1, s[12:15], s26 offen offset:3072 sc1
    buffer_load_dwordx4 a[136:139], v1, s[12:15], s27 offen offset:3072 sc1
    buffer_load_dwordx4 a[172:175], v1, s[12:15], s28 offen offset:3072 sc1
    s_add_u32 s24, s24, 4096
    s_add_u32 s25, s25, 4096
    s_add_u32 s26, s26, 4096
    s_add_u32 s27, s27, 4096
    s_add_u32 s28, s28, 4096
    buffer_load_dwordx4 a[32:35], v1, s[12:15], s24 offen offset:0 sc1
    buffer_load_dwordx4 a[68:71], v1, s[12:15], s25 offen offset:0 sc1
    buffer_load_dwordx4 a[104:107], v1, s[12:15], s26 offen offset:0 sc1
    buffer_load_dwordx4 a[140:143], v1, s[12:15], s27 offen offset:0 sc1
    buffer_load_dwordx4 a[176:179], v1, s[12:15], s28 offen offset:0 sc1
K2_f_havew:
    v_and_b32 v3, 31, v0
    v_lshlrev_b32 v4, 2, v3
    s_lshl_b32 s29, s9, 7
    s_add_u32 s29, s29, 9568256
    buffer_load_dword v2, v4, s[12:15], s29 offen sc1
    s_mul_i32 s30, s9, 36
    s_mul_i32 s31, s10, 9
    s_add_u32 s30, s30, s31
    s_add_u32 s30, s30, s8
    s_lshl_b32 s30, s30, 10
    v_and_b32 v5, 31, v0
    v_lshrrev_b32 v6, 5, v0
    v_bfe_u32 v7, v5, 2, 1
    v_cmp_eq_u32 vcc, v6, v7
    v_cmp_gt_u32 s[40:41], 16, v5
    v_and_b32 v6, 3, v5
    v_bfe_u32 v7, v5, 3, 1
    v_lshlrev_b32 v7, 2, v7
    v_add_u32 v6, v6, v7
    s_and_b64 s[40:41], s[40:41], vcc
    v_lshrrev_b32 v7, 1, v6
    v_and_b32 v6, 1, v6
    v_lshlrev_b32 v6, 4, v6
    v_mov_b32 v5, 0x3f80
    v_lshlrev_b32 v5, v6, v5
    v_cndmask_b32 v5, 0, v5, s[40:41]
    v_cmp_eq_u32 vcc, 0, v7
    s_nop 1
    v_cndmask_b32 v240, 0, v5, vcc
    v_cmp_eq_u32 vcc, 1, v7
    s_nop 1
    v_cndmask_b32 v241, 0, v5, vcc
    v_cmp_eq_u32 vcc, 2, v7
    s_nop 1
    v_cndmask_b32 v242, 0, v5, vcc
    v_cmp_eq_u32 vcc, 3, v7
    s_nop 1
    v_cndmask_b32 v243, 0, v5, vcc
    s_lshr_b32 s48, s9, 2
    s_mul_i32 s48, s48, 128
    s_add_u32 s48, s48, 3200
    s_lshr_b32 s49, s9, 4
    s_mul_i32 s49, s49, 128
    s_add_u32 s49, s49, 5248
    s_cmp_eq_u32 s8, 0
    s_cbranch_scc0 Lwait_8842_done
    s_mov_b32 s50, 0x40000
    s_mov_b64 exec, 1
    v_mov_b32 v246, s49
Lwait_8842:
    global_load_dword v250, v246, s[34:35] sc1
    s_waitcnt vmcnt(0)
    s_mov_b32 s51, 1
    v_readfirstlane_b32 s52, v250
    s_cmp_ge_u32 s52, 32
    s_cselect_b32 s51, s51, 0
    s_cmp_eq_u32 s51, 1
    s_cbranch_scc1 Lwait_8842_ok
    s_sub_u32 s50, s50, 1
    s_cmp_lg_u32 s50, 0
    s_cbranch_scc1 Lwait_8842
Lwait_8842_ok:
    s_mov_b64 exec, -1
Lwait_8842_done:
    s_barrier
    s_mul_i32 s20, s9, 36
    s_add_u32 s20, s20, s21
    s_lshl_b32 s20, s20, 10
    s_add_u32 s22, s20, 18374656
    buffer_load_dwordx4 v[8:11], v1, s[12:15], s22 offen offset:0 sc1
    buffer_load_dwordx4 v[12:15], v1, s[12:15], s22 offen offset:1024 sc1
    buffer_load_dwordx4 v[16:19], v1, s[12:15], s22 offen offset:2048 sc1
    buffer_load_dwordx4 v[20:23], v1, s[12:15], s22 offen offset:3072 sc1
    s_add_u32 s22, s22, 4096
    buffer_load_dwordx4 v[24:27], v1, s[12:15], s22 offen offset:0 sc1
    buffer_load_dwordx4 v[28:31], v1, s[12:15], s22 offen offset:1024 sc1
    buffer_load_dwordx4 v[32:35], v1, s[12:15], s22 offen offset:2048 sc1
    buffer_load_dwordx4 v[36:39], v1, s[12:15], s22 offen offset:3072 sc1
    s_add_u32 s22, s22, 4096
    buffer_load_dwordx4 v[40:43], v1, s[12:15], s22 offen offset:0 sc1
    s_waitcnt vmcnt(8)
    v_mfma_f32_32x32x16_bf16 v[44:59], a[0:3], v[8:11], 0
    v_mfma_f32_32x32x16_bf16 v[60:75], a[36:39], v[8:11], 0
    v_mfma_f32_32x32x16_bf16 v[76:91], a[72:75], v[8:11], 0
    v_mfma_f32_32x32x16_bf16 v[92:107], a[108:111], v[8:11], 0
    v_mfma_f32_32x32x16_bf16 v[108:123], a[144:147], v[8:11], 0
    s_waitcnt vmcnt(7)
    v_mfma_f32_32x32x16_bf16 v[44:59], a[4:7], v[12:15], v[44:59]
    v_mfma_f32_32x32x16_bf16 v[60:75], a[40:43], v[12:15], v[60:75]
    v_mfma_f32_32x32x16_bf16 v[76:91], a[76:79], v[12:15], v[76:91]
    v_mfma_f32_32x32x16_bf16 v[92:107], a[112:115], v[12:15], v[92:107]
    v_mfma_f32_32x32x16_bf16 v[108:123], a[148:151], v[12:15], v[108:123]
    s_waitcnt vmcnt(6)
    v_mfma_f32_32x32x16_bf16 v[44:59], a[8:11], v[16:19], v[44:59]
    v_mfma_f32_32x32x16_bf16 v[60:75], a[44:47], v[16:19], v[60:75]
    v_mfma_f32_32x32x16_bf16 v[76:91], a[80:83], v[16:19], v[76:91]
    v_mfma_f32_32x32x16_bf16 v[92:107], a[116:119], v[16:19], v[92:107]
    v_mfma_f32_32x32x16_bf16 v[108:123], a[152:155], v[16:19], v[108:123]
    s_waitcnt vmcnt(5)
    v_mfma_f32_32x32x16_bf16 v[44:59], a[12:15], v[20:23], v[44:59]
    v_mfma_f32_32x32x16_bf16 v[60:75], a[48:51], v[20:23], v[60:75]
    v_mfma_f32_32x32x16_bf16 v[76:91], a[84:87], v[20:23], v[76:91]
    v_mfma_f32_32x32x16_bf16 v[92:107], a[120:123], v[20:23], v[92:107]
    v_mfma_f32_32x32x16_bf16 v[108:123], a[156:159], v[20:23], v[108:123]
    s_waitcnt vmcnt(4)
    v_mfma_f32_32x32x16_bf16 v[44:59], a[16:19], v[24:27], v[44:59]
    v_mfma_f32_32x32x16_bf16 v[60:75], a[52:55], v[24:27], v[60:75]
    v_mfma_f32_32x32x16_bf16 v[76:91], a[88:91], v[24:27], v[76:91]
    v_mfma_f32_32x32x16_bf16 v[92:107], a[124:127], v[24:27], v[92:107]
    v_mfma_f32_32x32x16_bf16 v[108:123], a[160:163], v[24:27], v[108:123]
    s_waitcnt vmcnt(3)
    v_mfma_f32_32x32x16_bf16 v[44:59], a[20:23], v[28:31], v[44:59]
    v_mfma_f32_32x32x16_bf16 v[60:75], a[56:59], v[28:31], v[60:75]
    v_mfma_f32_32x32x16_bf16 v[76:91], a[92:95], v[28:31], v[76:91]
    v_mfma_f32_32x32x16_bf16 v[92:107], a[128:131], v[28:31], v[92:107]
    v_mfma_f32_32x32x16_bf16 v[108:123], a[164:167], v[28:31], v[108:123]
    s_waitcnt vmcnt(2)
    v_mfma_f32_32x32x16_bf16 v[44:59], a[24:27], v[32:35], v[44:59]
    v_mfma_f32_32x32x16_bf16 v[60:75], a[60:63], v[32:35], v[60:75]
    v_mfma_f32_32x32x16_bf16 v[76:91], a[96:99], v[32:35], v[76:91]
    v_mfma_f32_32x32x16_bf16 v[92:107], a[132:135], v[32:35], v[92:107]
    v_mfma_f32_32x32x16_bf16 v[108:123], a[168:171], v[32:35], v[108:123]
    s_waitcnt vmcnt(1)
    v_mfma_f32_32x32x16_bf16 v[44:59], a[28:31], v[36:39], v[44:59]
    v_mfma_f32_32x32x16_bf16 v[60:75], a[64:67], v[36:39], v[60:75]
    v_mfma_f32_32x32x16_bf16 v[76:91], a[100:103], v[36:39], v[76:91]
    v_mfma_f32_32x32x16_bf16 v[92:107], a[136:139], v[36:39], v[92:107]
    v_mfma_f32_32x32x16_bf16 v[108:123], a[172:175], v[36:39], v[108:123]
    s_waitcnt vmcnt(0)
    v_mfma_f32_32x32x16_bf16 v[44:59], a[32:35], v[40:43], v[44:59]
    v_mfma_f32_32x32x16_bf16 v[60:75], a[68:71], v[40:43], v[60:75]
    v_mfma_f32_32x32x16_bf16 v[76:91], a[104:107], v[40:43], v[76:91]
    v_mfma_f32_32x32x16_bf16 v[92:107], a[140:143], v[40:43], v[92:107]
    v_mfma_f32_32x32x16_bf16 v[108:123], a[176:179], v[40:43], v[108:123]
    s_mul_i32 s33, s8, 18432
    v_add_u32 v5, s33, v1
    s_nop 9
    ds_write_b128 v5, v[44:47] offset:0
    ds_write_b128 v5, v[48:51] offset:1024
    ds_write_b128 v5, v[52:55] offset:2048
    ds_write_b128 v5, v[56:59] offset:3072
    ds_write_b128 v5, v[60:63] offset:4096
    ds_write_b128 v5, v[64:67] offset:5120
    ds_write_b128 v5, v[68:71] offset:6144
    ds_write_b128 v5, v[72:75] offset:7168
    ds_write_b128 v5, v[76:79] offset:8192
    ds_write_b128 v5, v[80:83] offset:9216
    ds_write_b128 v5, v[84:87] offset:10240
    ds_write_b128 v5, v[88:91] offset:11264
    ds_write_b128 v5, v[92:95] offset:12288
    ds_write_b128 v5, v[96:99] offset:13312
    ds_write_b128 v5, v[100:103] offset:14336
    ds_write_b128 v5, v[104:107] offset:15360
    ds_write_b128 v5, v[108:111] offset:16384
    ds_write_b128 v5, v[112:115] offset:17408
    s_cmp_eq_u32 s8, 0
    s_cbranch_scc0 Lwait_8953_done
    s_mov_b32 s50, 0x40000
    s_mov_b64 exec, 1
    v_mov_b32 v246, s48
Lwait_8953:
    global_load_dword v250, v246, s[34:35] sc1
    s_waitcnt vmcnt(0)
    s_mov_b32 s51, 1
    v_readfirstlane_b32 s52, v250
    s_cmp_ge_u32 s52, 8
    s_cselect_b32 s51, s51, 0
    s_cmp_eq_u32 s51, 1
    s_cbranch_scc1 Lwait_8953_ok
    s_sub_u32 s50, s50, 1
    s_cmp_lg_u32 s50, 0
    s_cbranch_scc1 Lwait_8953
Lwait_8953_ok:
    s_mov_b64 exec, -1
Lwait_8953_done:
    s_waitcnt lgkmcnt(0)
    s_barrier
    s_add_u32 s32, s30, 9576448
    buffer_load_dwordx4 v[124:127], v1, s[12:15], s32 offen sc1
    s_add_u32 s32, s30, 20733952
    buffer_load_dwordx4 v[128:131], v1, s[12:15], s32 offen sc1
    s_add_u32 s32, s30, 23093248
    buffer_load_dwordx4 v[132:135], v1, s[12:15], s32 offen sc1
    s_add_u32 s32, s30, 25452544
    buffer_load_dwordx4 v[136:139], v1, s[12:15], s32 offen sc1
    s_add_u32 s32, s30, 27811840
    buffer_load_dwordx4 v[140:143], v1, s[12:15], s32 offen sc1
    s_add_u32 s32, s30, 30171136
    buffer_load_dwordx4 v[144:147], v1, s[12:15], s32 offen sc1
    s_add_u32 s32, s30, 32530432
    buffer_load_dwordx4 v[148:151], v1, s[12:15], s32 offen sc1
    s_add_u32 s32, s30, 34889728
    buffer_load_dwordx4 v[152:155], v1, s[12:15], s32 offen sc1
    s_add_u32 s32, s30, 37249024
    buffer_load_dwordx4 v[156:159], v1, s[12:15], s32 offen sc1
    s_add_u32 s32, s30, 9580544
    buffer_load_dwordx4 v[160:163], v1, s[12:15], s32 offen sc1
    s_add_u32 s32, s30, 20738048
    buffer_load_dwordx4 v[164:167], v1, s[12:15], s32 offen sc1
    s_add_u32 s32, s30, 23097344
    buffer_load_dwordx4 v[168:171], v1, s[12:15], s32 offen sc1
    s_add_u32 s32, s30, 25456640
    buffer_load_dwordx4 v[172:175], v1, s[12:15], s32 offen sc1
    s_add_u32 s32, s30, 27815936
    buffer_load_dwordx4 v[176:179], v1, s[12:15], s32 offen sc1
    s_add_u32 s32, s30, 30175232
    buffer_load_dwordx4 v[180:183], v1, s[12:15], s32 offen sc1
    s_add_u32 s32, s30, 32534528
    buffer_load_dwordx4 v[184:187], v1, s[12:15], s32 offen sc1
    s_add_u32 s32, s30, 34893824
    buffer_load_dwordx4 v[188:191], v1, s[12:15], s32 offen sc1
    s_add_u32 s32, s30, 37253120
    buffer_load_dwordx4 v[192:195], v1, s[12:15], s32 offen sc1
    s_cmp_eq_u32 s8, 0
    s_cbranch_scc0 K2_f_no3s
    s_add_u32 s32, s30, 9584640
    buffer_load_dwordx4 v[196:199], v1, s[12:15], s32 offen sc1
    s_add_u32 s32, s30, 20742144
    buffer_load_dwordx4 v[200:203], v1, s[12:15], s32 offen sc1
    s_add_u32 s32, s30, 23101440
    buffer_load_dwordx4 v[204:207], v1, s[12:15], s32 offen sc1
    s_add_u32 s32, s30, 25460736
    buffer_load_dwordx4 v[208:211], v1, s[12:15], s32 offen sc1
    s_add_u32 s32, s30, 27820032
    buffer_load_dwordx4 v[212:215], v1, s[12:15], s32 offen sc1
    s_add_u32 s32, s30, 30179328
    buffer_load_dwordx4 v[216:219], v1, s[12:15], s32 offen sc1
    s_add_u32 s32, s30, 32538624
    buffer_load_dwordx4 v[220:223], v1, s[12:15], s32 offen sc1
    s_add_u32 s32, s30, 34897920
    buffer_load_dwordx4 v[224:227], v1, s[12:15], s32 offen sc1
    s_add_u32 s32, s30, 37257216
    buffer_load_dwordx4 v[228:231], v1, s[12:15], s32 offen sc1
K2_f_no3s:
    s_lshl_b32 s33, s8, 11
    v_add_u32 v5, s33, v1
    v_add_u32 v9, 36864, v5
    s_mov_b32 s36, 0x00003f80
    s_mov_b32 s37, 0x3f800000
    v_lshrrev_b32 v6, 5, v0
    v_lshlrev_b32 v6, 4, v6
    s_movk_i32 s38, 1152
    v_mul_lo_u32 v7, v3, s38
    v_add_u32 v7, v7, v6
    s_mul_i32 s39, s9, 36864
    s_mul_i32 s40, s10, 288
    s_add_u32 s39, s39, s40
    s_lshl_b32 s40, s8, 5
    s_add_u32 s39, s39, s40
    s_cmp_eq_u32 s8, 0
    s_cbranch_scc0 K2_f_two
    ds_read_b128 v[44:47], v5 offset:0
    ds_read_b128 v[48:51], v5 offset:1024
    ds_read_b128 v[52:55], v5 offset:18432
    ds_read_b128 v[56:59], v5 offset:19456
    ds_read_b128 v[60:63], v9 offset:0
    ds_read_b128 v[64:67], v9 offset:1024
    ds_read_b128 v[68:71], v9 offset:18432
    ds_read_b128 v[72:75], v9 offset:19456
    s_waitcnt vmcnt(18)
    v_mfma_f32_32x32x16_bf16 v[80:95], v[240:243], v[124:127], 0
    v_mfma_f32_32x32x16_bf16 v[80:95], v[240:243], v[128:131], v[80:95]
    v_mfma_f32_32x32x16_bf16 v[80:95], v[240:243], v[132:135], v[80:95]
    v_mfma_f32_32x32x16_bf16 v[80:95], v[240:243], v[136:139], v[80:95]
    v_mfma_f32_32x32x16_bf16 v[80:95], v[240:243], v[140:143], v[80:95]
    v_mfma_f32_32x32x16_bf16 v[80:95], v[240:243], v[144:147], v[80:95]
    v_mfma_f32_32x32x16_bf16 v[80:95], v[240:243], v[148:151], v[80:95]
    v_mfma_f32_32x32x16_bf16 v[80:95], v[240:243], v[152:155], v[80:95]
    v_mfma_f32_32x32x16_bf16 v[80:95], v[240:243], v[156:159], v[80:95]
    s_waitcnt lgkmcnt(0)
    v_add_f32 v44, v44, v52
    v_add_f32 v60, v60, v68
    v_add_f32 v45, v45, v53
    v_add_f32 v61, v61, v69
    v_add_f32 v46, v46, v54
    v_add_f32 v62, v62, v70
    v_add_f32 v47, v47, v55
    v_add_f32 v63, v63, v71
    v_add_f32 v48, v48, v56
    v_add_f32 v64, v64, v72
    v_add_f32 v49, v49, v57
    v_add_f32 v65, v65, v73
    v_add_f32 v50, v50, v58
    v_add_f32 v66, v66, v74
    v_add_f32 v51, v51, v59
    v_add_f32 v67, v67, v75
    v_add_f32 v44, v44, v60
    v_add_f32 v45, v45, v61
    v_add_f32 v46, v46, v62
    v_add_f32 v47, v47, v63
    v_add_f32 v48, v48, v64
    v_add_f32 v49, v49, v65
    v_add_f32 v50, v50, v66
    v_add_f32 v51, v51, v67
    v_sub_f32 v44, v44, v80
    v_sub_f32 v45, v45, v81
    v_sub_f32 v46, v46, v82
    v_sub_f32 v47, v47, v83
    v_sub_f32 v48, v48, v84
    v_sub_f32 v49, v49, v85
    v_sub_f32 v50, v50, v86
    v_sub_f32 v51, v51, v87
    v_fma_f32 v44, v44, v2, v80
    v_fma_f32 v45, v45, v2, v81
    v_fma_f32 v46, v46, v2, v82
    v_fma_f32 v47, v47, v2, v83
    v_fma_f32 v48, v48, v2, v84
    v_fma_f32 v49, v49, v2, v85
    v_fma_f32 v50, v50, v2, v86
    v_fma_f32 v51, v51, v2, v87
    v_cvt_pk_bf16_f32 v96, v44, v45
    v_cvt_pk_bf16_f32 v97, v46, v47
    v_cvt_pk_bf16_f32 v98, v48, v49
    v_cvt_pk_bf16_f32 v99, v50, v51
    buffer_store_dwordx4 v[96:99], v7, s[16:19], s39 offen offset:0 sc1
    ds_read_b128 v[44:47], v5 offset:8192
    ds_read_b128 v[48:51], v5 offset:9216
    ds_read_b128 v[52:55], v5 offset:26624
    ds_read_b128 v[56:59], v5 offset:27648
    ds_read_b128 v[60:63], v9 offset:8192
    ds_read_b128 v[64:67], v9 offset:9216
    ds_read_b128 v[68:71], v9 offset:26624
    ds_read_b128 v[72:75], v9 offset:27648
    s_waitcnt vmcnt(10)
    v_mfma_f32_32x32x16_bf16 v[80:95], v[240:243], v[160:163], 0
    v_mfma_f32_32x32x16_bf16 v[80:95], v[240:243], v[164:167], v[80:95]
    v_mfma_f32_32x32x16_bf16 v[80:95], v[240:243], v[168:171], v[80:95]
    v_mfma_f32_32x32x16_bf16 v[80:95], v[240:243], v[172:175], v[80:95]
    v_mfma_f32_32x32x16_bf16 v[80:95], v[240:243], v[176:179], v[80:95]
    v_mfma_f32_32x32x16_bf16 v[80:95], v[240:243], v[180:183], v[80:95]
    v_mfma_f32_32x32x16_bf16 v[80:95], v[240:243], v[184:187], v[80:95]
    v_mfma_f32_32x32x16_bf16 v[80:95], v[240:243], v[188:191], v[80:95]
    v_mfma_f32_32x32x16_bf16 v[80:95], v[240:243], v[192:195], v[80:95]
    s_waitcnt lgkmcnt(0)
    v_add_f32 v44, v44, v52
    v_add_f32 v60, v60, v68
    v_add_f32 v45, v45, v53
    v_add_f32 v61, v61, v69
    v_add_f32 v46, v46, v54
    v_add_f32 v62, v62, v70
    v_add_f32 v47, v47, v55
    v_add_f32 v63, v63, v71
    v_add_f32 v48, v48, v56
    v_add_f32 v64, v64, v72
    v_add_f32 v49, v49, v57
    v_add_f32 v65, v65, v73
    v_add_f32 v50, v50, v58
    v_add_f32 v66, v66, v74
    v_add_f32 v51, v51, v59
    v_add_f32 v67, v67, v75
    v_add_f32 v44, v44, v60
    v_add_f32 v45, v45, v61
    v_add_f32 v46, v46, v62
    v_add_f32 v47, v47, v63
    v_add_f32 v48, v48, v64
    v_add_f32 v49, v49, v65
    v_add_f32 v50, v50, v66
    v_add_f32 v51, v51, v67
    v_sub_f32 v44, v44, v80
    v_sub_f32 v45, v45, v81
    v_sub_f32 v46, v46, v82
    v_sub_f32 v47, v47, v83
    v_sub_f32 v48, v48, v84
    v_sub_f32 v49, v49, v85
    v_sub_f32 v50, v50, v86
    v_sub_f32 v51, v51, v87
    v_fma_f32 v44, v44, v2, v80
    v_fma_f32 v45, v45, v2, v81
    v_fma_f32 v46, v46, v2, v82
    v_fma_f32 v47, v47, v2, v83
    v_fma_f32 v48, v48, v2, v84
    v_fma_f32 v49, v49, v2, v85
    v_fma_f32 v50, v50, v2, v86
    v_fma_f32 v51, v51, v2, v87
    v_cvt_pk_bf16_f32 v96, v44, v45
    v_cvt_pk_bf16_f32 v97, v46, v47
    v_cvt_pk_bf16_f32 v98, v48, v49
    v_cvt_pk_bf16_f32 v99, v50, v51
    buffer_store_dwordx4 v[96:99], v7, s[16:19], s39 offen offset:128 sc1
    ds_read_b128 v[44:47], v5 offset:16384
    ds_read_b128 v[48:51], v5 offset:17408
    ds_read_b128 v[52:55], v5 offset:34816
    ds_read_b128 v[56:59], v5 offset:35840
    ds_read_b128 v[60:63], v9 offset:16384
    ds_read_b128 v[64:67], v9 offset:17408
    ds_read_b128 v[68:71], v9 offset:34816
    ds_read_b128 v[72:75], v9 offset:35840
    s_waitcnt vmcnt(2)
    v_mfma_f32_32x32x16_bf16 v[80:95], v[240:243], v[196:199], 0
    v_mfma_f32_32x32x16_bf16 v[80:95], v[240:243], v[200:203], v[80:95]
    v_mfma_f32_32x32x16_bf16 v[80:95], v[240:243], v[204:207], v[80:95]
    v_mfma_f32_32x32x16_bf16 v[80:95], v[240:243], v[208:211], v[80:95]
    v_mfma_f32_32x32x16_bf16 v[80:95], v[240:243], v[212:215], v[80:95]
    v_mfma_f32_32x32x16_bf16 v[80:95], v[240:243], v[216:219], v[80:95]
    v_mfma_f32_32x32x16_bf16 v[80:95], v[240:243], v[220:223], v[80:95]
    v_mfma_f32_32x32x16_bf16 v[80:95], v[240:243], v[224:227], v[80:95]
    v_mfma_f32_32x32x16_bf16 v[80:95], v[240:243], v[228:231], v[80:95]
    s_waitcnt lgkmcnt(0)
    v_add_f32 v44, v44, v52
    v_add_f32 v60, v60, v68
    v_add_f32 v45, v45, v53
    v_add_f32 v61, v61, v69
    v_add_f32 v46, v46, v54
    v_add_f32 v62, v62, v70
    v_add_f32 v47, v47, v55
    v_add_f32 v63, v63, v71
    v_add_f32 v48, v48, v56
    v_add_f32 v64, v64, v72
    v_add_f32 v49, v49, v57
    v_add_f32 v65, v65, v73
    v_add_f32 v50, v50, v58
    v_add_f32 v66, v66, v74
    v_add_f32 v51, v51, v59
    v_add_f32 v67, v67, v75
    v_add_f32 v44, v44, v60
    v_add_f32 v45, v45, v61
    v_add_f32 v46, v46, v62
    v_add_f32 v47, v47, v63
    v_add_f32 v48, v48, v64
    v_add_f32 v49, v49, v65
    v_add_f32 v50, v50, v66
    v_add_f32 v51, v51, v67
    v_sub_f32 v44, v44, v80
    v_sub_f32 v45, v45, v81
    v_sub_f32 v46, v46, v82
    v_sub_f32 v47, v47, v83
    v_sub_f32 v48, v48, v84
    v_sub_f32 v49, v49, v85
    v_sub_f32 v50, v50, v86
    v_sub_f32 v51, v51, v87
    v_fma_f32 v44, v44, v2, v80
    v_fma_f32 v45, v45, v2, v81
    v_fma_f32 v46, v46, v2, v82
    v_fma_f32 v47, v47, v2, v83
    v_fma_f32 v48, v48, v2, v84
    v_fma_f32 v49, v49, v2, v85
    v_fma_f32 v50, v50, v2, v86
    v_fma_f32 v51, v51, v2, v87
    v_cvt_pk_bf16_f32 v96, v44, v45
    v_cvt_pk_bf16_f32 v97, v46, v47
    v_cvt_pk_bf16_f32 v98, v48, v49
    v_cvt_pk_bf16_f32 v99, v50, v51
    buffer_store_dwordx4 v[96:99], v7, s[16:19], s39 offen offset:256 sc1
    s_endpgm
K2_f_two:
    ds_read_b128 v[44:47], v5 offset:0
    ds_read_b128 v[48:51], v5 offset:1024
    ds_read_b128 v[52:55], v5 offset:18432
    ds_read_b128 v[56:59], v5 offset:19456
    ds_read_b128 v[60:63], v9 offset:0
    ds_read_b128 v[64:67], v9 offset:1024
    ds_read_b128 v[68:71], v9 offset:18432
    ds_read_b128 v[72:75], v9 offset:19456
    s_waitcnt vmcnt(9)
    v_mfma_f32_32x32x16_bf16 v[80:95], v[240:243], v[124:127], 0
    v_mfma_f32_32x32x16_bf16 v[80:95], v[240:243], v[128:131], v[80:95]
    v_mfma_f32_32x32x16_bf16 v[80:95], v[240:243], v[132:135], v[80:95]
    v_mfma_f32_32x32x16_bf16 v[80:95], v[240:243], v[136:139], v[80:95]
    v_mfma_f32_32x32x16_bf16 v[80:95], v[240:243], v[140:143], v[80:95]
    v_mfma_f32_32x32x16_bf16 v[80:95], v[240:243], v[144:147], v[80:95]
    v_mfma_f32_32x32x16_bf16 v[80:95], v[240:243], v[148:151], v[80:95]
    v_mfma_f32_32x32x16_bf16 v[80:95], v[240:243], v[152:155], v[80:95]
    v_mfma_f32_32x32x16_bf16 v[80:95], v[240:243], v[156:159], v[80:95]
    s_waitcnt lgkmcnt(0)
    v_add_f32 v44, v44, v52
    v_add_f32 v60, v60, v68
    v_add_f32 v45, v45, v53
    v_add_f32 v61, v61, v69
    v_add_f32 v46, v46, v54
    v_add_f32 v62, v62, v70
    v_add_f32 v47, v47, v55
    v_add_f32 v63, v63, v71
    v_add_f32 v48, v48, v56
    v_add_f32 v64, v64, v72
    v_add_f32 v49, v49, v57
    v_add_f32 v65, v65, v73
    v_add_f32 v50, v50, v58
    v_add_f32 v66, v66, v74
    v_add_f32 v51, v51, v59
    v_add_f32 v67, v67, v75
    v_add_f32 v44, v44, v60
    v_add_f32 v45, v45, v61
    v_add_f32 v46, v46, v62
    v_add_f32 v47, v47, v63
    v_add_f32 v48, v48, v64
    v_add_f32 v49, v49, v65
    v_add_f32 v50, v50, v66
    v_add_f32 v51, v51, v67
    v_sub_f32 v44, v44, v80
    v_sub_f32 v45, v45, v81
    v_sub_f32 v46, v46, v82
    v_sub_f32 v47, v47, v83
    v_sub_f32 v48, v48, v84
    v_sub_f32 v49, v49, v85
    v_sub_f32 v50, v50, v86
    v_sub_f32 v51, v51, v87
    v_fma_f32 v44, v44, v2, v80
    v_fma_f32 v45, v45, v2, v81
    v_fma_f32 v46, v46, v2, v82
    v_fma_f32 v47, v47, v2, v83
    v_fma_f32 v48, v48, v2, v84
    v_fma_f32 v49, v49, v2, v85
    v_fma_f32 v50, v50, v2, v86
    v_fma_f32 v51, v51, v2, v87
    v_cvt_pk_bf16_f32 v96, v44, v45
    v_cvt_pk_bf16_f32 v97, v46, v47
    v_cvt_pk_bf16_f32 v98, v48, v49
    v_cvt_pk_bf16_f32 v99, v50, v51
    buffer_store_dwordx4 v[96:99], v7, s[16:19], s39 offen offset:0 sc1
    ds_read_b128 v[44:47], v5 offset:8192
    ds_read_b128 v[48:51], v5 offset:9216
    ds_read_b128 v[52:55], v5 offset:26624
    ds_read_b128 v[56:59], v5 offset:27648
    ds_read_b128 v[60:63], v9 offset:8192
    ds_read_b128 v[64:67], v9 offset:9216
    ds_read_b128 v[68:71], v9 offset:26624
    ds_read_b128 v[72:75], v9 offset:27648
    s_waitcnt vmcnt(1)
    v_mfma_f32_32x32x16_bf16 v[80:95], v[240:243], v[160:163], 0
    v_mfma_f32_32x32x16_bf16 v[80:95], v[240:243], v[164:167], v[80:95]
    v_mfma_f32_32x32x16_bf16 v[80:95], v[240:243], v[168:171], v[80:95]
    v_mfma_f32_32x32x16_bf16 v[80:95], v[240:243], v[172:175], v[80:95]
    v_mfma_f32_32x32x16_bf16 v[80:95], v[240:243], v[176:179], v[80:95]
    v_mfma_f32_32x32x16_bf16 v[80:95], v[240:243], v[180:183], v[80:95]
    v_mfma_f32_32x32x16_bf16 v[80:95], v[240:243], v[184:187], v[80:95]
    v_mfma_f32_32x32x16_bf16 v[80:95], v[240:243], v[188:191], v[80:95]
    v_mfma_f32_32x32x16_bf16 v[80:95], v[240:243], v[192:195], v[80:95]
    s_waitcnt lgkmcnt(0)
    v_add_f32 v44, v44, v52
    v_add_f32 v60, v60, v68
    v_add_f32 v45, v45, v53
    v_add_f32 v61, v61, v69
    v_add_f32 v46, v46, v54
    v_add_f32 v62, v62, v70
    v_add_f32 v47, v47, v55
    v_add_f32 v63, v63, v71
    v_add_f32 v48, v48, v56
    v_add_f32 v64, v64, v72
    v_add_f32 v49, v49, v57
    v_add_f32 v65, v65, v73
    v_add_f32 v50, v50, v58
    v_add_f32 v66, v66, v74
    v_add_f32 v51, v51, v59
    v_add_f32 v67, v67, v75
    v_add_f32 v44, v44, v60
    v_add_f32 v45, v45, v61
    v_add_f32 v46, v46, v62
    v_add_f32 v47, v47, v63
    v_add_f32 v48, v48, v64
    v_add_f32 v49, v49, v65
    v_add_f32 v50, v50, v66
    v_add_f32 v51, v51, v67
    v_sub_f32 v44, v44, v80
    v_sub_f32 v45, v45, v81
    v_sub_f32 v46, v46, v82
    v_sub_f32 v47, v47, v83
    v_sub_f32 v48, v48, v84
    v_sub_f32 v49, v49, v85
    v_sub_f32 v50, v50, v86
    v_sub_f32 v51, v51, v87
    v_fma_f32 v44, v44, v2, v80
    v_fma_f32 v45, v45, v2, v81
    v_fma_f32 v46, v46, v2, v82
    v_fma_f32 v47, v47, v2, v83
    v_fma_f32 v48, v48, v2, v84
    v_fma_f32 v49, v49, v2, v85
    v_fma_f32 v50, v50, v2, v86
    v_fma_f32 v51, v51, v2, v87
    v_cvt_pk_bf16_f32 v96, v44, v45
    v_cvt_pk_bf16_f32 v97, v46, v47
    v_cvt_pk_bf16_f32 v98, v48, v49
    v_cvt_pk_bf16_f32 v99, v50, v51
    buffer_store_dwordx4 v[96:99], v7, s[16:19], s39 offen offset:128 sc1
    s_endpgm
L3_exit:
    s_endpgm
.section .rodata,"a"
.p2align 6
.amdhsa_kernel gated_mix__softmax_full_mha__mixer_s_mlp__prompt_kernel
  .amdhsa_next_free_vgpr 512
  .amdhsa_next_free_sgpr 102
  .amdhsa_accum_offset 256
  .amdhsa_group_segment_fixed_size 0
  .amdhsa_kernarg_size 96
  .amdhsa_user_sgpr_count 2
  .amdhsa_user_sgpr_kernarg_segment_ptr 1
  .amdhsa_system_sgpr_workgroup_id_x 1
  .amdhsa_float_denorm_mode_32 3
.end_amdhsa_kernel
```
